```python
import torch

def _softmax(x, axis=-1):
    return torch.softmax(x, dim=axis)
def _gelu(x):
    return torch.nn.functional.gelu(x, approximate="tanh")
def _silu(x):
    return torch.nn.functional.silu(x)
def _sigmoid(x):
    return torch.sigmoid(x)
def _layernorm(x, axis=-1, eps=1e-5):
    m = x.mean(dim=axis, keepdim=True)
    v = x.var(dim=axis, keepdim=True, unbiased=False)
    return (x - m) / torch.sqrt(v + eps)
def _scatter_add(tgt, idx, src, axis=0):
    return tgt.clone().index_add_(axis, idx, src)
def _segment_sum(src, seg, n):
    out = torch.zeros((n,) + src.shape[1:], dtype=src.dtype)
    return out.index_add_(0, seg, src)
def _pad(x, pw):
    flat = tuple(v for pair in reversed(pw) for v in pair)
    return torch.nn.functional.pad(x, flat)

kernel_name = 'parallel_sum__linear_attn_block__geglu_ffn__prompt'

def setup_inputs():

    _w = (lambda a: (lambda t: t.to(torch.bfloat16) if t.is_floating_point() else t)(torch.as_tensor(a)))
    def _A_setup():
        B, S, D = 1, 2048, 576
        return {
            "x": _w((lambda *s: torch.randn(*s, dtype=torch.bfloat16) * 0.05)(B, S, D)),
            "wqkv": _w((lambda *s: torch.randn(*s, dtype=torch.bfloat16) * 0.4)(D, 3 * D)),
            "wo": _w((lambda *s: torch.randn(*s, dtype=torch.bfloat16) * 0.2)(D, D)),
        }
    _A_in = _A_setup()

    def _B_setup():
        B, S, D, F = 1, 2048, 576, 4608
        return {
            "x": _w((lambda *s: torch.randn(*s, dtype=torch.bfloat16) * 0.05)(B, S, D)),
            "w_gate": _w((lambda *s: torch.randn(*s, dtype=torch.bfloat16) * 0.05)(D, F)),
            "w_up": _w((lambda *s: torch.randn(*s, dtype=torch.bfloat16) * 0.05)(D, F)),
            "w_down": _w((lambda *s: torch.randn(*s, dtype=torch.bfloat16) * 0.05)(F, D)),
        }
    _B_in = _B_setup()

    return {
        "A_x": _A_in["x"],
        "A_wqkv": _A_in["wqkv"],
        "A_wo": _A_in["wo"],
        "B_x": _B_in["x"],
        "B_w_gate": _B_in["w_gate"],
        "B_w_up": _B_in["w_up"],
        "B_w_down": _B_in["w_down"],
    }

def reference(A_x, A_wqkv, A_wo, B_x, B_w_gate, B_w_up, B_w_down):
    def _A_ref(x, wqkv, wo):
        B, S, D = x.shape
        H = 32; Dh = D // H
        qkv = (lambda x, *d: x.permute(*d))((x @ wqkv).reshape(B, S, 3, H, Dh), 2, 0, 3, 1, 4)
        q, k, v = qkv[0], qkv[1], qkv[2]
        phi = lambda t: torch.where(t > 0, t + 1, torch.exp(t)) + 1e-6
        pq, pk = phi(q), phi(k)
        kv = torch.einsum("bhsd,bhse->bhde", pk, v)
        z = torch.einsum("bhsd->bhd", pk)
        num = torch.einsum("bhqd,bhde->bhqe", pq, kv)
        den = torch.einsum("bhqd,bhd->bhq", pq, z)[..., None] + 1e-6
        o = num / den
        return (lambda x, *d: x.permute(*d))(o, 0, 2, 1, 3).reshape(B, S, D) @ wo

    def _B_ref(x, w_gate, w_up, w_down):
        return (_gelu(x @ w_gate) * (x @ w_up)) @ w_down

    x = A_x
    xn = _layernorm(x, axis=-1)
    return x + _A_ref(xn, A_wqkv, A_wo) + _B_ref(xn, B_w_gate, B_w_up, B_w_down)
```

```asm
; @launch grid=(256,1,1) block=(512,1,1) lds=163840
.amdgcn_target "amdgcn-amd-amdhsa--gfx950"
.text
.globl parallel_sum__linear_attn_block__geglu_ffn__prompt_kernel
.p2align 8
.type parallel_sum__linear_attn_block__geglu_ffn__prompt_kernel,@function
parallel_sum__linear_attn_block__geglu_ffn__prompt_kernel:
    s_cmp_ge_u32 s2, 256
    s_cbranch_scc1 L_done
    s_load_dwordx2 s[16:17], s[0:1], 0
    s_load_dwordx4 s[76:79], s[0:1], 32
    s_getpc_b64 s[24:25]
    s_mov_b32 s26, L_done - L_cp
L_cp:
    s_mov_b32 s27, 0x20000
    s_and_b32 s30, s2, 0xf8
    s_lshl_b32 s30, s30, 8
    v_lshlrev_b32 v38, 2, v0
    buffer_load_dword v39, v38, s[24:27], s30 offen
    v_lshrrev_b32 v8, 6, v0
    v_bfe_u32 v34, v0, 4, 2
    v_readfirstlane_b32 s39, v8
    s_bfe_u32 s27, s2, 0x30003
    s_and_b32 s25, s2, 4
    s_lshr_b32 s26, s2, 6
    s_add_u32 s84, s25, s26
    v_bfe_u32 v36, v0, 3, 3
    v_xor_b32 v9, v0, v34
    v_and_b32 v9, 7, v9
    v_mul_u32_u24 v11, 72, v36
    v_add_lshl_u32 v12, v9, v11, 4
    v_xor_b32 v13, 64, v12
    v_add_u32 v13, 9216, v13
    s_lshl_b32 s24, s84, 3
    s_add_u32 s24, s24, s39
    s_mul_i32 s59, s24, 36864
    s_mul_i32 s61, s39, 10240
    s_add_u32 s61, s61, 73728
    s_add_u32 s25, s27, s84
    s_lshl_b32 s25, s25, 2
    s_mov_b32 s86, 0x30630630
    s_mov_b32 s87, 0x6306306
    s_lshr_b64 s[86:87], s[86:87], s25
    s_and_b32 s44, s86, 15
    s_lshl_b32 s86, s44, 7
    s_add_u32 s59, s59, s86
    s_mov_b32 s18, 2359296
    s_mov_b32 s19, 0x20000
    s_mov_b32 s31, s27
    s_waitcnt lgkmcnt(0)
    s_add_u32 m0, s61, 0
    s_add_u32 s25, s59, 0
    buffer_load_dwordx4 v12, s[16:19], s25 offen lds
    s_add_u32 m0, s61, 1024
    s_add_u32 s26, s59, 0
    buffer_load_dwordx4 v13, s[16:19], s26 offen lds
    s_and_b32 s26, s2, 3
    s_lshl3_add_u32 s85, s26, s31
    s_mul_i32 s87, s44, 589824
    s_mov_b32 s6, 5308416
    s_mov_b32 s7, 0x20000
    s_lshl_b32 s32, s39, 10
    v_lshrrev_b32 v8, 3, v0
    v_and_b32 v11, 0x13, v8
    v_lshrrev_b32 v9, 2, v0
    v_and_or_b32 v11, v9, 8, v11
    v_lshrrev_b32 v9, 4, v0
    v_and_or_b32 v11, v9, 4, v11
    v_mul_u32_u24 v11, 576, v11
    v_xor_b32 v8, v8, v0
    v_and_b32 v8, 6, v8
    v_and_or_b32 v8, v0, 1, v8
    s_cmp_eq_u32 s31, 3
    s_cselect_b32 s30, 31, 0
    s_add_u32 s30, s30, s85
    s_lshl_b32 s30, s30, 3
    v_add3_u32 v6, v11, v8, s30
    v_lshlrev_b32 v6, 4, v6
    s_cmp_ge_u32 s39, 4
    s_cselect_b32 s4, s78, s76
    s_cselect_b32 s5, s79, s77
    s_add_u32 m0, s32, 0
    s_add_u32 s27, s87, 0
    buffer_load_dwordx4 v6, s[4:7], s27 offen  lds
    s_add_u32 m0, s61, 2048
    s_add_u32 s28, s59, 18432
    buffer_load_dwordx4 v12, s[16:19], s28 offen lds
    s_add_u32 m0, s61, 3072
    s_add_u32 s29, s59, 18432
    buffer_load_dwordx4 v13, s[16:19], s29 offen lds
    s_add_u32 m0, s32, 8192
    s_add_u32 s24, s87, 294912
    buffer_load_dwordx4 v6, s[4:7], s24 offen  lds
    s_load_dwordx2 s[20:21], s[0:1], 64
    s_load_dwordx2 s[8:9], s[0:1], 72
    s_load_dwordx2 s[72:73], s[0:1], 8
    s_load_dwordx2 s[48:49], s[0:1], 16
    s_load_dwordx2 s[46:47], s[0:1], 48
    s_load_dwordx2 s[70:71], s[0:1], 56
    s_memrealtime s[28:29]
    v_and_b32 v32, 63, v0
    s_mov_b32 s38, 1073741824
    v_mov_b32 v33, s38
    v_lshlrev_b32 v4, 4, v32
    s_lshl_b32 s26, s84, 5
    s_add_u32 s26, s26, s85
    s_lshl3_add_u32 s31, s26, s39
    s_mul_i32 s45, s31, 1152
    s_lshl_b32 s86, s44, 12
    s_add_u32 s86, s86, s32
    s_mov_b32 s22, 256
    s_mov_b32 s23, 0x20000
    v_cmp_eq_u32 vcc, 0, v0
    s_nop 1
    v_cndmask_b32 v10, v33, 0, vcc
    s_waitcnt lgkmcnt(0)
    s_lshl_b32 s28, s28, 3
    s_or_b32 s28, s28, 0x80000000
    v_mov_b32 v11, s28
    s_cmp_eq_u32 s2, 0
    s_cselect_b32 s29, 0, s38
    buffer_store_dword v11, v10, s[20:23], s29 offen sc1
    v_and_b32 v8, 3, v32
    v_lshlrev_b32 v48, 4, v8
    v_cmp_gt_u32 vcc, 2, v8
    s_nop 1
    v_cndmask_b32 v48, v33, v48, vcc
    v_mov_b32 v49, 2336
    v_cmp_eq_u32 vcc, 1, v8
    s_nop 1
    v_cndmask_b32 v49, v49, 32, vcc
    v_mov_b32 v9, 1184
    v_cmp_eq_u32 vcc, 2, v8
    s_nop 1
    v_cndmask_b32 v49, v49, v9, vcc
    v_cmp_eq_u32 vcc, 3, v8
    s_nop 1
    v_cndmask_b32 v49, v49, v33, vcc
    v_bfe_u32 v9, v32, 2, 2
    v_lshl_add_u32 v50, v34, 3, v9
    s_and_b32 s54, s2, 3
    s_lshl_b32 s54, s54, 3
    s_add_u32 s54, s54, s39
    s_lshr_b32 s24, s2, 2
    s_add_u32 s24, s24, 0
    s_sub_u32 s25, s24, 36
    s_lshr_b32 s26, s25, 2
    s_mul_i32 s26, s26, 110592
    s_and_b32 s25, s25, 3
    s_mul_i32 s27, s54, 36
    s_add_u32 s26, s26, s27
    s_mul_i32 s27, s25, 1152
    s_cmp_eq_u32 s25, 3
    s_cselect_b32 s27, 0, s27
    s_cselect_b64 s[42:43], -1, 0
    s_add_u32 s62, s26, s27
    s_lshr_b32 s26, s24, 1
    s_mul_i32 s26, s26, 294912
    s_lshl_b32 s27, s54, 5
    s_add_u32 s26, s26, s27
    s_add_u32 s26, s26, 8192
    s_bitcmp1_b32 s24, 0
    s_cselect_b32 s76, s78, s76
    s_cselect_b32 s77, s79, s77
    s_mov_b32 s28, 1990656
    s_mov_b32 s29, 3456
    s_cmp_lt_u32 s24, 36
    s_cselect_b32 s76, s76, s72
    s_cselect_b32 s77, s77, s73
    s_cselect_b32 s78, 5308416, s28
    s_mov_b32 s79, 0x20000
    s_cselect_b32 s62, s26, s62
    s_cselect_b32 s64, 9216, s29
    s_cselect_b64 s[42:43], 0, s[42:43]
    s_cselect_b32 s30, 0, 4
    s_mov_b32 s27, s64
    s_lshl_b32 s64, s64, 2
    s_and_b32 s65, s42, 1
    s_add_u32 s65, s65, 3
    v_cndmask_b32 v8, v48, v49, s[42:43]
    v_mul_lo_u32 v11, v50, s27
    v_add_u32 v104, v8, v11
    s_mul_i32 s26, s54, 112
    s_add_u32 s26, s26, s24
    s_add_u32 s26, s26, s30
    s_lshl_b32 s26, s26, 10
    s_add_u32 s26, s26, 2359296
    s_cmp_lt_u32 s24, 108
    s_cselect_b32 s68, s26, s38
    s_lshr_b32 s24, s2, 2
    s_add_u32 s24, s24, 64
    s_sub_u32 s25, s24, 36
    s_lshr_b32 s26, s25, 2
    s_mul_i32 s26, s26, 110592
    s_and_b32 s25, s25, 3
    s_mul_i32 s27, s54, 36
    s_add_u32 s26, s26, s27
    s_mul_i32 s27, s25, 1152
    s_cmp_eq_u32 s25, 3
    s_cselect_b32 s27, 0, s27
    s_cselect_b64 s[42:43], -1, 0
    s_add_u32 s63, s26, s27
    s_mov_b32 s27, 3456
    s_mov_b32 s30, 4
    s_and_b32 s66, s42, 1
    s_add_u32 s66, s66, 3
    v_cndmask_b32 v8, v48, v49, s[42:43]
    v_mul_lo_u32 v11, v50, s27
    v_add_u32 v105, v8, v11
    s_mul_i32 s26, s54, 112
    s_add_u32 s26, s26, s24
    s_add_u32 s26, s26, s30
    s_lshl_b32 s26, s26, 10
    s_add_u32 s26, s26, 2359296
    s_cmp_lt_u32 s24, 108
    s_cselect_b32 s69, s26, s38
    s_cselect_b32 s74, 1990656, 0
    s_mov_b32 s75, 0x20000
    s_mov_b32 s10, 46137344
    s_mov_b32 s11, 0x20000
    s_lshl_b32 s58, s31, 7
    v_lshrrev_b32 v8, 5, v32
    v_lshlrev_b32 v8, 11, v8
    v_bfe_u32 v11, v32, 2, 3
    v_lshl_add_u32 v8, v11, 7, v8
    v_bfe_u32 v11, v32, 3, 2
    v_lshl_add_u32 v8, v11, 5, v8
    v_and_b32 v11, 3, v32
    v_lshl_add_u32 v0, v11, 3, v8
    v_xor_b32 v1, 32, v0
    v_xor_b32 v2, 64, v0
    v_xor_b32 v3, 96, v0
    s_and_b32 s24, s39, 3
    s_lshl_b32 s24, s24, 5
    s_and_b32 s25, s32, 0x1000
    s_or_b32 s24, s24, s25
    v_xor_b32 v5, s24, v0
    v_and_b32 v9, 15, v32
    v_lshrrev_b32 v11, 1, v9
    v_xor_b32 v11, v11, v34
    v_lshlrev_b32 v11, 4, v11
    v_lshl_add_u32 v11, v9, 7, v11
    v_add_u32 v14, s61, v11
    v_xor_b32 v15, 64, v14
    v_mov_b32 v96, 0x3f803f80
    v_mov_b32 v97, 0x3f803f80
    v_mov_b32 v98, 0x3f803f80
    v_mov_b32 v99, 0x3f803f80
    s_add_u32 m0, s61, 4096
    s_add_u32 s25, s59, 128
    buffer_load_dwordx4 v12, s[16:19], s25 offen lds
    s_add_u32 m0, s61, 5120
    s_add_u32 s26, s59, 128
    buffer_load_dwordx4 v13, s[16:19], s26 offen lds
    s_add_u32 m0, s32, 16384
    s_add_u32 s27, s87, 589824
    buffer_load_dwordx4 v6, s[4:7], s27 offen  lds
    s_add_u32 m0, s61, 6144
    s_add_u32 s28, s59, 18560
    buffer_load_dwordx4 v12, s[16:19], s28 offen lds
    s_add_u32 m0, s61, 7168
    s_add_u32 s29, s59, 18560
    buffer_load_dwordx4 v13, s[16:19], s29 offen lds
    s_add_u32 m0, s32, 24576
    s_add_u32 s24, s87, 884736
    buffer_load_dwordx4 v6, s[4:7], s24 offen  lds
    s_waitcnt vmcnt(11)
    ds_read_b128 v[112:115], v14 offset:0
    ds_read_b128 v[120:123], v15 offset:0
    s_waitcnt vmcnt(8)
    ds_read_b128 v[116:119], v14 offset:2048
    ds_read_b128 v[124:127], v15 offset:2048
    s_waitcnt vmcnt(7)
    s_barrier
    ds_read_b64_tr_b16 v[16:17], v5 offset:0
    ds_read_b64_tr_b16 v[18:19], v5 offset:1024
    ds_read_b64_tr_b16 v[20:21], v0 offset:0
    ds_read_b64_tr_b16 v[22:23], v0 offset:1024
    ds_read_b64_tr_b16 v[24:25], v0 offset:4096
    ds_read_b64_tr_b16 v[26:27], v0 offset:5120
    s_waitcnt lgkmcnt(4)
    v_mfma_f32_16x16x32_bf16 v[100:103], v[96:99], v[16:19], 0
    s_waitcnt lgkmcnt(2)
    ds_read_b64_tr_b16 v[28:29], v1 offset:0
    ds_read_b64_tr_b16 v[30:31], v1 offset:1024
    buffer_load_dwordx4 v[248:251], v4, s[16:19], s45 offen
    v_mfma_f32_16x16x32_bf16 v[32:35], v[20:23], v[112:115], 0
    v_lshlrev_b32 v244, 21, v4
    v_and_b32 v244, s38, v244
    ds_read_b64_tr_b16 v[16:17], v1 offset:4096
    v_mfma_f32_16x16x32_bf16 v[36:39], v[20:23], v[116:119], 0
    s_waitcnt lgkmcnt(3)
    v_lshrrev_b32 v246, 2, v4
    v_or_b32 v244, v244, v246
    s_add_u32 m0, s61, 8192
    s_add_u32 s25, s59, 256
    ds_read_b64_tr_b16 v[18:19], v1 offset:5120
    v_mfma_f32_16x16x32_bf16 v[40:43], v[24:27], v[112:115], 0
    ds_read_b64_tr_b16 v[20:21], v2 offset:0
    ds_read_b64_tr_b16 v[22:23], v2 offset:1024
    buffer_load_dwordx4 v12, s[16:19], s25 offen lds
    v_mfma_f32_16x16x32_bf16 v[44:47], v[24:27], v[116:119], 0
    buffer_load_dword v252, v244, s[16:19], s45 offen offset:1024
    s_waitcnt lgkmcnt(4)
    v_mfma_f32_16x16x32_bf16 v[48:51], v[28:31], v[112:115], 0
    ds_read_b64_tr_b16 v[24:25], v2 offset:4096
    buffer_load_dword v245, off, s[20:23], 0 sc1
    v_mfma_f32_16x16x32_bf16 v[52:55], v[28:31], v[116:119], 0
    s_waitcnt lgkmcnt(3)
    v_cmp_gt_u32 vcc, 0x80, v4
    v_mov_b32 v244, s38
    ds_read_b64_tr_b16 v[26:27], v2 offset:5120
    v_mfma_f32_16x16x32_bf16 v[56:59], v[16:19], v[112:115], 0
    v_cndmask_b32 v244, v244, v4, vcc
    ds_read_b64_tr_b16 v[28:29], v3 offset:0
    s_lshl_b32 s30, s2, 2
    s_and_b32 s31, s39, 3
    s_add_u32 s30, s30, s31
    s_mul_i32 s30, s30, 2
    v_mfma_f32_16x16x32_bf16 v[60:63], v[16:19], v[116:119], 0
    s_waitcnt lgkmcnt(3)
    v_lshrrev_b32 v7, 4, v4
    v_min_u32 v7, 1, v7
    ds_read_b64_tr_b16 v[30:31], v3 offset:1024
    v_mfma_f32_16x16x32_bf16 v[64:67], v[20:23], v[112:115], 0
    v_add_u32 v7, s30, v7
    v_and_b32 v9, 7, v7
    ds_read_b64_tr_b16 v[16:17], v3 offset:4096
    v_mfma_f32_16x16x32_bf16 v[68:71], v[20:23], v[116:119], 0
    s_waitcnt lgkmcnt(3)
    v_cmp_eq_u32 vcc, 2, v9
    v_lshrrev_b32 v8, 5, v7
    s_add_u32 m0, s61, 9216
    s_add_u32 s26, s59, 256
    ds_read_b64_tr_b16 v[18:19], v3 offset:5120
    v_mfma_f32_16x16x32_bf16 v[72:75], v[24:27], v[112:115], 0
    ds_read_b64_tr_b16 v[20:21], v5 offset:8192
    ds_read_b64_tr_b16 v[22:23], v5 offset:9216
    buffer_load_dwordx4 v13, s[16:19], s26 offen lds
    v_mfma_f32_16x16x32_bf16 v[76:79], v[24:27], v[116:119], 0
    v_mul_u32_u24 v8, 5120, v8
    v_cndmask_b32 v9, 32, 1, vcc
    s_nop 0
    s_waitcnt lgkmcnt(4)
    v_mfma_f32_16x16x32_bf16 v[80:83], v[28:31], v[112:115], 0
    v_add_u32 v7, v7, v9
    v_lshl_add_u32 v7, v7, 7, v8
    ds_read_b64_tr_b16 v[24:25], v0 offset:8192
    v_mfma_f32_16x16x32_bf16 v[84:87], v[28:31], v[116:119], 0
    ds_read_b64_tr_b16 v[26:27], v0 offset:9216
    s_waitcnt vmcnt(9)
    ds_read_b128 v[128:131], v14 offset:4096
    s_nop 0
    s_waitcnt lgkmcnt(5)
    v_mfma_f32_16x16x32_bf16 v[88:91], v[16:19], v[112:115], 0
    s_add_u32 m0, s32, 32768
    s_add_u32 s27, s87, 1179648
    ds_read_b64_tr_b16 v[28:29], v0 offset:12288
    ds_read_b64_tr_b16 v[30:31], v0 offset:13312
    s_nop 0
    s_waitcnt vmcnt(8)
    v_mfma_f32_16x16x32_bf16 v[92:95], v[16:19], v[116:119], 0
    s_barrier
    s_waitcnt lgkmcnt(5)
    v_mfma_f32_16x16x32_bf16 v[100:103], v[96:99], v[20:23], v[100:103]
    ds_read_b64_tr_b16 v[16:17], v1 offset:8192
    ds_read_b64_tr_b16 v[18:19], v1 offset:9216
    s_nop 0
    s_waitcnt lgkmcnt(5)
    v_mfma_f32_16x16x32_bf16 v[32:35], v[24:27], v[120:123], v[32:35]
    ds_read_b64_tr_b16 v[20:21], v1 offset:12288
    ds_read_b64_tr_b16 v[22:23], v1 offset:13312
    buffer_load_dwordx4 v6, s[4:7], s27 offen  lds
    v_mfma_f32_16x16x32_bf16 v[36:39], v[24:27], v[124:127], v[36:39]
    ds_read_b128 v[136:139], v15 offset:4096
    s_nop 0
    s_waitcnt lgkmcnt(5)
    v_mfma_f32_16x16x32_bf16 v[40:43], v[28:31], v[120:123], v[40:43]
    ds_read_b64_tr_b16 v[24:25], v2 offset:8192
    s_waitcnt vmcnt(7)
    ds_read_b128 v[132:135], v14 offset:6144
    s_nop 0
    v_mfma_f32_16x16x32_bf16 v[44:47], v[28:31], v[124:127], v[44:47]
    ds_read_b64_tr_b16 v[26:27], v2 offset:9216
    ds_read_b128 v[140:143], v15 offset:6144
    s_waitcnt lgkmcnt(7)
    v_mfma_f32_16x16x32_bf16 v[48:51], v[16:19], v[120:123], v[48:51]
    s_add_u32 m0, s61, 0
    s_add_u32 s28, s59, 18688
    ds_read_b64_tr_b16 v[28:29], v2 offset:12288
    s_nop 0
    v_mfma_f32_16x16x32_bf16 v[52:55], v[16:19], v[124:127], v[52:55]
    ds_read_b64_tr_b16 v[30:31], v2 offset:13312
    s_nop 0
    s_waitcnt lgkmcnt(7)
    v_mfma_f32_16x16x32_bf16 v[56:59], v[20:23], v[120:123], v[56:59]
    ds_read_b64_tr_b16 v[16:17], v3 offset:8192
    ds_read_b64_tr_b16 v[18:19], v3 offset:9216
    buffer_load_dwordx4 v12, s[16:19], s28 offen lds
    v_mfma_f32_16x16x32_bf16 v[60:63], v[20:23], v[124:127], v[60:63]
    s_add_u32 m0, s61, 1024
    s_add_u32 s29, s59, 18688
    s_nop 0
    s_waitcnt lgkmcnt(5)
    v_mfma_f32_16x16x32_bf16 v[64:67], v[24:27], v[120:123], v[64:67]
    ds_read_b64_tr_b16 v[20:21], v3 offset:12288
    ds_read_b64_tr_b16 v[22:23], v3 offset:13312
    buffer_load_dwordx4 v13, s[16:19], s29 offen lds
    v_mfma_f32_16x16x32_bf16 v[68:71], v[24:27], v[124:127], v[68:71]
    s_waitcnt lgkmcnt(4)
    s_cmp_eq_u32 s44, 6
    s_cselect_b32 s24, 1152, 0
    s_sub_u32 s59, s59, s24
    v_mfma_f32_16x16x32_bf16 v[72:75], v[28:31], v[120:123], v[72:75]
    s_add_u32 m0, s32, 40960
    s_add_u32 s25, s87, 1474560
    ds_read_b64_tr_b16 v[24:25], v5 offset:16384
    s_nop 0
    v_mfma_f32_16x16x32_bf16 v[76:79], v[28:31], v[124:127], v[76:79]
    ds_read_b64_tr_b16 v[26:27], v5 offset:17408
    s_nop 0
    s_waitcnt lgkmcnt(4)
    v_mfma_f32_16x16x32_bf16 v[80:83], v[16:19], v[120:123], v[80:83]
    ds_read_b64_tr_b16 v[28:29], v0 offset:16384
    ds_read_b64_tr_b16 v[30:31], v0 offset:17408
    buffer_load_dwordx4 v6, s[4:7], s25 offen  lds
    v_mfma_f32_16x16x32_bf16 v[84:87], v[16:19], v[124:127], v[84:87]
    s_waitcnt lgkmcnt(4)
    s_cmp_eq_u32 s44, 6
    s_cselect_b32 s26, 5308416, 0
    s_sub_u32 s87, s87, s26
    v_mfma_f32_16x16x32_bf16 v[88:91], v[20:23], v[120:123], v[88:91]
    s_add_u32 m0, s61, 2048
    s_add_u32 s27, s59, 384
    ds_read_b64_tr_b16 v[16:17], v0 offset:20480
    ds_read_b64_tr_b16 v[18:19], v0 offset:21504
    s_waitcnt vmcnt(9)
    v_mfma_f32_16x16x32_bf16 v[92:95], v[20:23], v[124:127], v[92:95]
    s_barrier
    s_waitcnt lgkmcnt(4)
    v_mfma_f32_16x16x32_bf16 v[100:103], v[96:99], v[24:27], v[100:103]
    ds_read_b64_tr_b16 v[20:21], v1 offset:16384
    ds_read_b64_tr_b16 v[22:23], v1 offset:17408
    s_waitcnt lgkmcnt(4)
    v_mfma_f32_16x16x32_bf16 v[32:35], v[28:31], v[128:131], v[32:35]
    ds_read_b64_tr_b16 v[24:25], v1 offset:20480
    ds_read_b64_tr_b16 v[26:27], v1 offset:21504
    buffer_load_dwordx4 v12, s[16:19], s27 offen lds
    v_mfma_f32_16x16x32_bf16 v[36:39], v[28:31], v[132:135], v[36:39]
    s_add_u32 m0, s61, 3072
    s_add_u32 s28, s59, 384
    s_nop 0
    s_waitcnt lgkmcnt(4)
    v_mfma_f32_16x16x32_bf16 v[40:43], v[16:19], v[128:131], v[40:43]
    ds_read_b64_tr_b16 v[28:29], v2 offset:16384
    ds_read_b64_tr_b16 v[30:31], v2 offset:17408
    buffer_load_dwordx4 v13, s[16:19], s28 offen lds
    v_mfma_f32_16x16x32_bf16 v[44:47], v[16:19], v[132:135], v[44:47]
    s_add_u32 m0, s32, 0
    s_add_u32 s29, s87, 1769472
    s_nop 0
    s_waitcnt lgkmcnt(4)
    v_mfma_f32_16x16x32_bf16 v[48:51], v[20:23], v[128:131], v[48:51]
    ds_read_b64_tr_b16 v[16:17], v2 offset:20480
    ds_read_b64_tr_b16 v[18:19], v2 offset:21504
    buffer_load_dwordx4 v6, s[4:7], s29 offen  lds
    v_mfma_f32_16x16x32_bf16 v[52:55], v[20:23], v[132:135], v[52:55]
    s_nop 2
    s_waitcnt lgkmcnt(4)
    v_mfma_f32_16x16x32_bf16 v[56:59], v[24:27], v[128:131], v[56:59]
    ds_read_b64_tr_b16 v[20:21], v3 offset:16384
    s_nop 1
    v_mfma_f32_16x16x32_bf16 v[60:63], v[24:27], v[132:135], v[60:63]
    s_waitcnt lgkmcnt(3)
    s_add_u32 m0, s61, 4096
    s_add_u32 s24, s59, 18816
    ds_read_b64_tr_b16 v[22:23], v3 offset:17408
    v_mfma_f32_16x16x32_bf16 v[64:67], v[28:31], v[128:131], v[64:67]
    ds_read_b64_tr_b16 v[24:25], v3 offset:20480
    ds_read_b64_tr_b16 v[26:27], v3 offset:21504
    buffer_load_dwordx4 v12, s[16:19], s24 offen lds
    v_mfma_f32_16x16x32_bf16 v[68:71], v[28:31], v[132:135], v[68:71]
    s_nop 2
    s_waitcnt lgkmcnt(4)
    v_mfma_f32_16x16x32_bf16 v[72:75], v[16:19], v[128:131], v[72:75]
    s_waitcnt vmcnt(9)
    v_cmp_eq_u32 vcc, 0, v245
    ds_read_b64_tr_b16 v[28:29], v5 offset:24576
    v_mfma_f32_16x16x32_bf16 v[76:79], v[16:19], v[132:135], v[76:79]
    s_waitcnt lgkmcnt(3)
    s_add_u32 m0, s61, 5120
    s_add_u32 s25, s59, 18816
    ds_read_b64_tr_b16 v[30:31], v5 offset:25600
    s_cbranch_vccnz L_sl6
L_bk6:
    v_mfma_f32_16x16x32_bf16 v[80:83], v[20:23], v[128:131], v[80:83]
    ds_read_b64_tr_b16 v[16:17], v0 offset:24576
    ds_read_b64_tr_b16 v[18:19], v0 offset:25600
    buffer_load_dwordx4 v13, s[16:19], s25 offen lds
    v_mfma_f32_16x16x32_bf16 v[84:87], v[20:23], v[132:135], v[84:87]
    v_readfirstlane_b32 s54, v245
    s_mov_b32 s20, s70
    s_mov_b32 s21, s71
    s_waitcnt lgkmcnt(4)
    v_mfma_f32_16x16x32_bf16 v[88:91], v[24:27], v[128:131], v[88:91]
    ds_read_b64_tr_b16 v[20:21], v0 offset:28672
    ds_read_b64_tr_b16 v[22:23], v0 offset:29696
    s_nop 1
    s_waitcnt vmcnt(8)
    v_mfma_f32_16x16x32_bf16 v[92:95], v[24:27], v[132:135], v[92:95]
    s_barrier
    s_waitcnt lgkmcnt(4)
    v_mfma_f32_16x16x32_bf16 v[100:103], v[96:99], v[28:31], v[100:103]
    s_waitcnt lgkmcnt(2)
    s_add_u32 m0, s32, 8192
    s_add_u32 s26, s87, 2064384
    ds_read_b64_tr_b16 v[24:25], v1 offset:24576
    ds_read_b64_tr_b16 v[26:27], v1 offset:25600
    v_mfma_f32_16x16x32_bf16 v[32:35], v[16:19], v[136:139], v[32:35]
    ds_read_b64_tr_b16 v[28:29], v1 offset:28672
    ds_read_b64_tr_b16 v[30:31], v1 offset:29696
    buffer_load_dwordx4 v6, s[4:7], s26 offen  lds
    v_mfma_f32_16x16x32_bf16 v[36:39], v[16:19], v[140:143], v[36:39]
    ds_read_b128 v[144:147], v14 offset:8192
    s_nop 1
    s_waitcnt lgkmcnt(5)
    v_mfma_f32_16x16x32_bf16 v[40:43], v[20:23], v[136:139], v[40:43]
    ds_read_b64_tr_b16 v[16:17], v2 offset:24576
    ds_read_b128 v[152:155], v15 offset:8192
    s_nop 0
    v_mfma_f32_16x16x32_bf16 v[44:47], v[20:23], v[140:143], v[44:47]
    ds_read_b64_tr_b16 v[18:19], v2 offset:25600
    s_waitcnt vmcnt(7)
    ds_read_b128 v[148:151], v14 offset:0
    s_waitcnt lgkmcnt(7)
    v_mfma_f32_16x16x32_bf16 v[48:51], v[24:27], v[136:139], v[48:51]
    ds_read_b64_tr_b16 v[20:21], v2 offset:28672
    ds_read_b128 v[156:159], v15 offset:0
    s_nop 0
    v_mfma_f32_16x16x32_bf16 v[52:55], v[24:27], v[140:143], v[52:55]
    s_waitcnt lgkmcnt(7)
    s_mov_b32 s22, 2359296
    s_add_u32 m0, s61, 6144
    s_add_u32 s27, s59, 512
    ds_read_b64_tr_b16 v[22:23], v2 offset:29696
    v_mfma_f32_16x16x32_bf16 v[56:59], v[28:31], v[136:139], v[56:59]
    ds_read_b64_tr_b16 v[24:25], v3 offset:24576
    ds_read_b64_tr_b16 v[26:27], v3 offset:25600
    buffer_load_dwordx4 v12, s[16:19], s27 offen lds
    v_mfma_f32_16x16x32_bf16 v[60:63], v[28:31], v[140:143], v[60:63]
    s_waitcnt lgkmcnt(6)
    v_lshlrev_b32 v246, 16, v248
    v_and_b32 v247, 0xffff0000, v248
    s_add_u32 m0, s61, 7168
    s_add_u32 s28, s59, 512
    v_mfma_f32_16x16x32_bf16 v[64:67], v[16:19], v[136:139], v[64:67]
    ds_read_b64_tr_b16 v[28:29], v3 offset:28672
    ds_read_b64_tr_b16 v[30:31], v3 offset:29696
    buffer_load_dwordx4 v13, s[16:19], s28 offen lds
    v_mfma_f32_16x16x32_bf16 v[68:71], v[16:19], v[140:143], v[68:71]
    s_waitcnt lgkmcnt(4)
    v_add_f32 v240, v246, v247
    v_mul_f32 v242, v246, v246
    s_add_u32 m0, s32, 16384
    s_add_u32 s29, s87, 2359296
    v_mfma_f32_16x16x32_bf16 v[72:75], v[20:23], v[136:139], v[72:75]
    ds_read_b64_tr_b16 v[16:17], v5 offset:32768
    ds_read_b64_tr_b16 v[18:19], v5 offset:33792
    buffer_load_dwordx4 v6, s[4:7], s29 offen  lds
    v_mfma_f32_16x16x32_bf16 v[76:79], v[20:23], v[140:143], v[76:79]
    v_fmac_f32 v242, v247, v247
    v_lshlrev_b32 v246, 16, v249
    s_nop 0
    s_waitcnt lgkmcnt(4)
    v_mfma_f32_16x16x32_bf16 v[80:83], v[24:27], v[136:139], v[80:83]
    v_and_b32 v247, 0xffff0000, v249
    v_add_f32 v240, v240, v246
    ds_read_b64_tr_b16 v[20:21], v0 offset:32768
    v_mfma_f32_16x16x32_bf16 v[84:87], v[24:27], v[140:143], v[84:87]
    s_waitcnt lgkmcnt(3)
    v_fmac_f32 v242, v246, v246
    v_add_f32 v240, v240, v247
    s_add_u32 m0, s32, 49152
    s_add_u32 s24, s62, 0
    ds_read_b64_tr_b16 v[22:23], v0 offset:33792
    v_mfma_f32_16x16x32_bf16 v[88:91], v[28:31], v[136:139], v[88:91]
    ds_read_b64_tr_b16 v[24:25], v0 offset:36864
    ds_read_b64_tr_b16 v[26:27], v0 offset:37888
    buffer_load_dwordx4 v104, s[76:79], s24 offen  lds
    s_waitcnt vmcnt(10)
    v_mfma_f32_16x16x32_bf16 v[92:95], v[28:31], v[140:143], v[92:95]
    s_barrier
    s_waitcnt lgkmcnt(4)
    v_mfma_f32_16x16x32_bf16 v[100:103], v[96:99], v[16:19], v[100:103]
    ds_read_b64_tr_b16 v[28:29], v1 offset:32768
    ds_read_b64_tr_b16 v[30:31], v1 offset:33792
    s_nop 0
    s_waitcnt lgkmcnt(4)
    v_mfma_f32_16x16x32_bf16 v[32:35], v[20:23], v[144:147], v[32:35]
    s_add_u32 m0, s32, 57344
    v_fmac_f32 v242, v247, v247
    v_lshlrev_b32 v246, 16, v250
    s_add_u32 s25, s62, s64
    ds_read_b64_tr_b16 v[16:17], v1 offset:36864
    v_mfma_f32_16x16x32_bf16 v[36:39], v[20:23], v[148:151], v[36:39]
    s_waitcnt lgkmcnt(3)
    v_and_b32 v247, 0xffff0000, v250
    v_add_f32 v240, v240, v246
    ds_read_b64_tr_b16 v[18:19], v1 offset:37888
    v_mfma_f32_16x16x32_bf16 v[40:43], v[24:27], v[144:147], v[40:43]
    ds_read_b64_tr_b16 v[20:21], v2 offset:32768
    ds_read_b64_tr_b16 v[22:23], v2 offset:33792
    buffer_load_dwordx4 v104, s[76:79], s25 offen  lds
    v_mfma_f32_16x16x32_bf16 v[44:47], v[24:27], v[148:151], v[44:47]
    v_fmac_f32 v242, v246, v246
    v_add_f32 v240, v240, v247
    s_nop 0
    s_waitcnt lgkmcnt(4)
    v_mfma_f32_16x16x32_bf16 v[48:51], v[28:31], v[144:147], v[48:51]
    s_add_u32 m0, s61, 8192
    v_fmac_f32 v242, v247, v247
    v_lshlrev_b32 v246, 16, v251
    s_add_u32 s26, s59, 18944
    ds_read_b64_tr_b16 v[24:25], v2 offset:36864
    v_mfma_f32_16x16x32_bf16 v[52:55], v[28:31], v[148:151], v[52:55]
    s_waitcnt lgkmcnt(3)
    v_and_b32 v247, 0xffff0000, v251
    v_add_f32 v240, v240, v246
    ds_read_b64_tr_b16 v[26:27], v2 offset:37888
    v_mfma_f32_16x16x32_bf16 v[56:59], v[16:19], v[144:147], v[56:59]
    ds_read_b64_tr_b16 v[28:29], v3 offset:32768
    ds_read_b64_tr_b16 v[30:31], v3 offset:33792
    buffer_load_dwordx4 v12, s[16:19], s26 offen lds
    v_mfma_f32_16x16x32_bf16 v[60:63], v[16:19], v[148:151], v[60:63]
    s_waitcnt lgkmcnt(4)
    v_fmac_f32 v242, v246, v246
    v_add_f32 v240, v240, v247
    s_add_u32 m0, s61, 9216
    s_add_u32 s27, s59, 18944
    v_mfma_f32_16x16x32_bf16 v[64:67], v[20:23], v[144:147], v[64:67]
    ds_read_b64_tr_b16 v[16:17], v3 offset:36864
    ds_read_b64_tr_b16 v[18:19], v3 offset:37888
    buffer_load_dwordx4 v13, s[16:19], s27 offen lds
    v_mfma_f32_16x16x32_bf16 v[68:71], v[20:23], v[148:151], v[68:71]
    v_fmac_f32 v242, v247, v247
    v_lshlrev_b32 v246, 16, v252
    s_nop 0
    s_waitcnt lgkmcnt(4)
    v_mfma_f32_16x16x32_bf16 v[72:75], v[24:27], v[144:147], v[72:75]
    v_and_b32 v247, 0xffff0000, v252
    v_add_f32 v240, v240, v246
    ds_read_b64_tr_b16 v[20:21], v5 offset:40960
    v_mfma_f32_16x16x32_bf16 v[76:79], v[24:27], v[148:151], v[76:79]
    s_waitcnt lgkmcnt(3)
    v_fmac_f32 v242, v246, v246
    v_add_f32 v240, v240, v247
    s_add_u32 m0, s32, 24576
    s_add_u32 s28, s87, 2654208
    ds_read_b64_tr_b16 v[22:23], v5 offset:41984
    v_mfma_f32_16x16x32_bf16 v[80:83], v[28:31], v[144:147], v[80:83]
    ds_read_b64_tr_b16 v[24:25], v0 offset:40960
    ds_read_b64_tr_b16 v[26:27], v0 offset:41984
    buffer_load_dwordx4 v6, s[4:7], s28 offen  lds
    v_mfma_f32_16x16x32_bf16 v[84:87], v[28:31], v[148:151], v[84:87]
    s_waitcnt lgkmcnt(4)
    v_fmac_f32 v242, v247, v247
    s_waitcnt vmcnt(12)
    ds_read_b128 v[160:163], v14 offset:2048
    v_mfma_f32_16x16x32_bf16 v[88:91], v[16:19], v[144:147], v[88:91]
    ds_read_b64_tr_b16 v[28:29], v0 offset:45056
    ds_read_b64_tr_b16 v[30:31], v0 offset:46080
    s_nop 1
    s_waitcnt vmcnt(11)
    v_mfma_f32_16x16x32_bf16 v[92:95], v[16:19], v[148:151], v[92:95]
    s_barrier
    s_waitcnt lgkmcnt(5)
    v_mfma_f32_16x16x32_bf16 v[100:103], v[96:99], v[20:23], v[100:103]
    s_waitcnt lgkmcnt(3)
    s_add_u32 m0, s32, 65536
    s_add_u32 s29, s63, 0
    ds_read_b64_tr_b16 v[16:17], v1 offset:40960
    ds_read_b64_tr_b16 v[18:19], v1 offset:41984
    v_mfma_f32_16x16x32_bf16 v[32:35], v[24:27], v[152:155], v[32:35]
    ds_read_b64_tr_b16 v[20:21], v1 offset:45056
    ds_read_b64_tr_b16 v[22:23], v1 offset:46080
    buffer_load_dwordx4 v105, s[72:75], s29 offen  lds
    v_mfma_f32_16x16x32_bf16 v[36:39], v[24:27], v[156:159], v[36:39]
    s_waitcnt lgkmcnt(4)
    v_add_f32_dpp v240, v240, v240 row_shr:1 row_mask:0xf bank_mask:0xf bound_ctrl:0
    v_add_f32_dpp v242, v242, v242 row_shr:1 row_mask:0xf bank_mask:0xf bound_ctrl:0
    ds_read_b128 v[168:171], v15 offset:2048
    v_mfma_f32_16x16x32_bf16 v[40:43], v[28:31], v[152:155], v[40:43]
    ds_read_b64_tr_b16 v[24:25], v2 offset:40960
    s_waitcnt vmcnt(10)
    ds_read_b128 v[164:167], v14 offset:4096
    s_nop 1
    v_mfma_f32_16x16x32_bf16 v[44:47], v[28:31], v[156:159], v[44:47]
    ds_read_b64_tr_b16 v[26:27], v2 offset:41984
    ds_read_b128 v[172:175], v15 offset:4096
    s_nop 0
    s_waitcnt lgkmcnt(7)
    v_mfma_f32_16x16x32_bf16 v[48:51], v[16:19], v[152:155], v[48:51]
    s_add_u32 m0, s32, 155648
    v_add_f32_dpp v240, v240, v240 row_shr:2 row_mask:0xf bank_mask:0xf bound_ctrl:0
    v_add_f32_dpp v242, v242, v242 row_shr:2 row_mask:0xf bank_mask:0xf bound_ctrl:0
    s_add_u32 s24, s63, 13824
    ds_read_b64_tr_b16 v[28:29], v2 offset:45056
    v_mfma_f32_16x16x32_bf16 v[52:55], v[16:19], v[156:159], v[52:55]
    s_waitcnt lgkmcnt(6)
    v_add_f32_dpp v240, v240, v240 row_shr:4 row_mask:0xf bank_mask:0xf bound_ctrl:0
    v_add_f32_dpp v242, v242, v242 row_shr:4 row_mask:0xf bank_mask:0xf bound_ctrl:0
    ds_read_b64_tr_b16 v[30:31], v2 offset:46080
    v_mfma_f32_16x16x32_bf16 v[56:59], v[20:23], v[152:155], v[56:59]
    ds_read_b64_tr_b16 v[16:17], v3 offset:40960
    ds_read_b64_tr_b16 v[18:19], v3 offset:41984
    buffer_load_dwordx4 v105, s[72:75], s24 offen  lds
    v_mfma_f32_16x16x32_bf16 v[60:63], v[20:23], v[156:159], v[60:63]
    s_waitcnt lgkmcnt(5)
    v_add_f32_dpp v240, v240, v240 row_shr:8 row_mask:0xf bank_mask:0xf bound_ctrl:0
    v_add_f32_dpp v242, v242, v242 row_shr:8 row_mask:0xf bank_mask:0xf bound_ctrl:0
    s_add_u32 m0, s61, 0
    s_add_u32 s25, s59, 640
    v_mfma_f32_16x16x32_bf16 v[64:67], v[24:27], v[152:155], v[64:67]
    ds_read_b64_tr_b16 v[20:21], v3 offset:45056
    ds_read_b64_tr_b16 v[22:23], v3 offset:46080
    buffer_load_dwordx4 v12, s[16:19], s25 offen lds
    v_mfma_f32_16x16x32_bf16 v[68:71], v[24:27], v[156:159], v[68:71]
    s_waitcnt lgkmcnt(4)
    v_add_f32_dpp v240, v240, v240 row_bcast:15 row_mask:0xa bank_mask:0xf
    v_add_f32_dpp v242, v242, v242 row_bcast:15 row_mask:0xa bank_mask:0xf
    s_add_u32 m0, s61, 1024
    s_add_u32 s26, s59, 640
    v_mfma_f32_16x16x32_bf16 v[72:75], v[28:31], v[152:155], v[72:75]
    ds_read_b64_tr_b16 v[24:25], v5 offset:0
    ds_read_b64_tr_b16 v[26:27], v5 offset:1024
    buffer_load_dwordx4 v13, s[16:19], s26 offen lds
    v_mfma_f32_16x16x32_bf16 v[76:79], v[28:31], v[156:159], v[76:79]
    s_waitcnt lgkmcnt(4)
    v_add_f32_dpp v240, v240, v240 row_bcast:31 row_mask:0xc bank_mask:0xf
    v_add_f32_dpp v242, v242, v242 row_bcast:31 row_mask:0xc bank_mask:0xf
    s_mul_i32 s60, s85, 114688
    s_add_u32 s60, s60, 2359296
    v_mfma_f32_16x16x32_bf16 v[80:83], v[16:19], v[152:155], v[80:83]
    s_lshr_b32 s73, s85, 3
    v_readlane_b32 s30, v240, 63
    v_readlane_b32 s31, v242, 63
    s_lshl_b32 s73, s73, 13
    s_add_u32 s73, s73, 42991616
    ds_read_b64_tr_b16 v[28:29], v0 offset:0
    v_mfma_f32_16x16x32_bf16 v[84:87], v[16:19], v[156:159], v[84:87]
    s_waitcnt lgkmcnt(3)
    v_mov_b32 v246, 0x3ae38e39
    v_mov_b32 v241, v245
    s_add_u32 m0, s32, 32768
    s_add_u32 s27, s87, 2949120
    ds_read_b64_tr_b16 v[30:31], v0 offset:1024
    v_mfma_f32_16x16x32_bf16 v[88:91], v[20:23], v[152:155], v[88:91]
    s_add_u32 s56, s73, s32
    ds_read_b64_tr_b16 v[16:17], v0 offset:4096
    ds_read_b64_tr_b16 v[18:19], v0 offset:5120
    buffer_load_dwordx4 v6, s[4:7], s27 offen  lds
    s_waitcnt vmcnt(13)
    v_mfma_f32_16x16x32_bf16 v[92:95], v[20:23], v[156:159], v[92:95]
    s_barrier
    s_waitcnt lgkmcnt(4)
    v_mfma_f32_16x16x32_bf16 v[100:103], v[96:99], v[24:27], v[100:103]
    ds_read_b64_tr_b16 v[20:21], v1 offset:0
    ds_read_b64_tr_b16 v[22:23], v1 offset:1024
    s_nop 0
    s_waitcnt lgkmcnt(4)
    v_mfma_f32_16x16x32_bf16 v[32:35], v[28:31], v[160:163], v[32:35]
    s_and_b32 s73, s2, 3
    v_mul_f32 v240, s30, v246
    v_mul_f32 v242, s31, v246
    s_add_u32 m0, s61, 2048
    s_add_u32 s28, s59, 19072
    ds_read_b64_tr_b16 v[24:25], v1 offset:4096
    v_mfma_f32_16x16x32_bf16 v[36:39], v[28:31], v[164:167], v[36:39]
    s_waitcnt lgkmcnt(3)
    v_fma_f32 v242, -v240, v240, v242
    v_max_f32 v242, 0, v242
    s_lshl_b32 s73, s73, 6
    s_lshr_b32 s74, s2, 2
    ds_read_b64_tr_b16 v[26:27], v1 offset:5120
    v_mfma_f32_16x16x32_bf16 v[40:43], v[16:19], v[160:163], v[40:43]
    s_add_u32 s74, s74, s73
    ds_read_b64_tr_b16 v[28:29], v2 offset:0
    ds_read_b64_tr_b16 v[30:31], v2 offset:1024
    buffer_load_dwordx4 v12, s[16:19], s28 offen lds
    v_mfma_f32_16x16x32_bf16 v[44:47], v[16:19], v[164:167], v[44:47]
    s_waitcnt lgkmcnt(4)
    v_cvt_pk_bf16_f32 v246, -v240, v242
    v_lshlrev_b32 v240, 16, v246
    s_lshl_b32 s74, s74, 7
    s_add_u32 s74, s74, 42991616
    s_waitcnt vmcnt(12)
    ds_read_b128 v[176:179], v14 offset:6144
    v_mfma_f32_16x16x32_bf16 v[48:51], v[20:23], v[160:163], v[48:51]
    s_lshl_b32 s75, s2, 7
    ds_read_b64_tr_b16 v[16:17], v2 offset:4096
    ds_read_b128 v[184:187], v15 offset:6144
    s_nop 1
    v_mfma_f32_16x16x32_bf16 v[52:55], v[20:23], v[164:167], v[52:55]
    s_waitcnt lgkmcnt(5)
    v_and_b32 v242, 0xffff0000, v246
    v_add_f32 v242, 0x3727c5ac, v242
    s_add_u32 m0, s61, 3072
    s_add_u32 s29, s59, 19072
    ds_read_b64_tr_b16 v[18:19], v2 offset:5120
    v_mfma_f32_16x16x32_bf16 v[56:59], v[24:27], v[160:163], v[56:59]
    s_add_u32 s75, s75, 43057152
    ds_read_b64_tr_b16 v[20:21], v3 offset:0
    ds_read_b64_tr_b16 v[22:23], v3 offset:1024
    buffer_load_dwordx4 v13, s[16:19], s29 offen lds
    v_mfma_f32_16x16x32_bf16 v[60:63], v[24:27], v[164:167], v[60:63]
    s_waitcnt lgkmcnt(6)
    v_cvt_pk_bf16_f32 v242, v242, v242
    v_and_b32 v242, 0xffff0000, v242
    s_cmp_eq_u32 s44, 3
    s_cselect_b32 s24, 1152, 0
    s_sub_u32 s59, s59, s24
    v_mfma_f32_16x16x32_bf16 v[64:67], v[28:31], v[160:163], v[64:67]
    s_add_u32 m0, s32, 40960
    v_sqrt_f32 v242, v242
    s_add_u32 s25, s87, 3244032
    ds_read_b64_tr_b16 v[24:25], v3 offset:4096
    v_mfma_f32_16x16x32_bf16 v[68:71], v[28:31], v[164:167], v[68:71]
    s_waitcnt lgkmcnt(3)
    v_cvt_pk_bf16_f32 v242, v242, v242
    v_and_b32 v242, 0xffff0000, v242
    s_cmp_eq_u32 s39, 0
    s_cselect_b32 s55, s74, s38
    s_cselect_b32 s57, s75, s38
    ds_read_b64_tr_b16 v[26:27], v3 offset:5120
    v_mfma_f32_16x16x32_bf16 v[72:75], v[16:19], v[160:163], v[72:75]
    s_lshl_b32 s73, s84, 4
    ds_read_b64_tr_b16 v[28:29], v5 offset:8192
    ds_read_b64_tr_b16 v[30:31], v5 offset:9216
    buffer_load_dwordx4 v6, s[4:7], s25 offen  lds
    v_mfma_f32_16x16x32_bf16 v[76:79], v[16:19], v[164:167], v[76:79]
    s_waitcnt lgkmcnt(4)
    v_rcp_f32 v242, v242
    s_cmp_eq_u32 s44, 3
    s_cselect_b32 s26, 5308416, 0
    s_sub_u32 s87, s87, s26
    v_mfma_f32_16x16x32_bf16 v[80:83], v[20:23], v[160:163], v[80:83]
    s_lshl_b32 s74, s39, 1
    v_mov_b32 v243, v245
    s_add_u32 m0, s61, 4096
    s_add_u32 s27, s59, 768
    ds_read_b64_tr_b16 v[16:17], v0 offset:8192
    v_mfma_f32_16x16x32_bf16 v[84:87], v[20:23], v[164:167], v[84:87]
    s_add_u32 s73, s73, s74
    s_mul_i32 s33, s73, 163840
    ds_read_b64_tr_b16 v[18:19], v0 offset:9216
    s_nop 0
    s_waitcnt lgkmcnt(4)
    v_mfma_f32_16x16x32_bf16 v[88:91], v[24:27], v[160:163], v[88:91]
    s_mul_i32 s74, s85, 5120
    ds_read_b64_tr_b16 v[20:21], v0 offset:12288
    ds_read_b64_tr_b16 v[22:23], v0 offset:13312
    buffer_load_dwordx4 v12, s[16:19], s27 offen lds
    s_waitcnt vmcnt(14)
    v_mfma_f32_16x16x32_bf16 v[92:95], v[24:27], v[164:167], v[92:95]
    s_barrier
    s_waitcnt lgkmcnt(4)
    v_mfma_f32_16x16x32_bf16 v[100:103], v[96:99], v[28:31], v[100:103]
    s_waitcnt lgkmcnt(2)
    ds_read_b64_tr_b16 v[24:25], v1 offset:8192
    ds_read_b64_tr_b16 v[26:27], v1 offset:9216
    buffer_store_dwordx4 v[240:243], v244, s[8:11], s58 offen sc1
    v_mfma_f32_16x16x32_bf16 v[32:35], v[16:19], v[168:171], v[32:35]
    s_add_u32 s33, s33, s74
    ds_read_b64_tr_b16 v[28:29], v1 offset:12288
    s_waitcnt vmcnt(11)
    ds_read_b128 v[180:183], v14 offset:8192
    s_nop 1
    v_mfma_f32_16x16x32_bf16 v[36:39], v[16:19], v[172:175], v[36:39]
    ds_read_b64_tr_b16 v[30:31], v1 offset:13312
    ds_read_b128 v[188:191], v15 offset:8192
    s_waitcnt lgkmcnt(6)
    v_mfma_f32_16x16x32_bf16 v[40:43], v[20:23], v[168:171], v[40:43]
    s_add_u32 s33, s33, 6291456
    v_bfe_u32 v106, v4, 4, 2
    v_lshlrev_b32 v106, s65, v106
    s_add_u32 m0, s61, 5120
    s_add_u32 s28, s59, 768
    ds_read_b64_tr_b16 v[16:17], v2 offset:8192
    v_mfma_f32_16x16x32_bf16 v[44:47], v[20:23], v[172:175], v[44:47]
    s_waitcnt lgkmcnt(5)
    v_and_b32 v107, 0x3c0, v4
    v_add3_u32 v106, v106, v107, s32
    s_lshr_b32 s73, s2, 2
    s_lshl_b32 s73, s73, 1
    ds_read_b64_tr_b16 v[18:19], v2 offset:9216
    v_mfma_f32_16x16x32_bf16 v[48:51], v[24:27], v[168:171], v[48:51]
    s_lshr_b32 s74, s39, 2
    ds_read_b64_tr_b16 v[20:21], v2 offset:12288
    ds_read_b64_tr_b16 v[22:23], v2 offset:13312
    buffer_load_dwordx4 v13, s[16:19], s28 offen lds
    v_mfma_f32_16x16x32_bf16 v[52:55], v[24:27], v[172:175], v[52:55]
    s_waitcnt lgkmcnt(5)
    v_add_u32 v107, 57344, v106
    v_add_u32 v106, 49152, v106
    s_add_u32 s73, s73, s74
    s_mul_i32 s74, s73, 21846
    ds_read_b64_tr_b16 v[108:109], v106
    ds_read_b64_tr_b16 v[110:111], v107
    v_mfma_f32_16x16x32_bf16 v[56:59], v[28:31], v[168:171], v[56:59]
    s_lshr_b32 s74, s74, 16
    s_add_u32 m0, s32, 0
    s_add_u32 s29, s87, 3538944
    ds_read_b64_tr_b16 v[24:25], v3 offset:8192
    s_nop 0
    v_mfma_f32_16x16x32_bf16 v[60:63], v[28:31], v[172:175], v[60:63]
    s_mul_i32 s75, s74, 3
    s_sub_u32 s75, s73, s75
    ds_read_b64_tr_b16 v[26:27], v3 offset:9216
    s_nop 0
    s_waitcnt lgkmcnt(6)
    v_mfma_f32_16x16x32_bf16 v[64:67], v[16:19], v[168:171], v[64:67]
    s_mul_i32 s76, s74, 13108
    ds_read_b64_tr_b16 v[28:29], v3 offset:12288
    ds_read_b64_tr_b16 v[30:31], v3 offset:13312
    buffer_load_dwordx4 v6, s[4:7], s29 offen  lds
    v_mfma_f32_16x16x32_bf16 v[68:71], v[16:19], v[172:175], v[68:71]
    s_waitcnt lgkmcnt(6)
    v_lshlrev_b32 v106, 21, v4
    v_and_b32 v106, s38, v106
    s_lshr_b32 s76, s76, 16
    s_mul_i32 s77, s76, 5
    v_mfma_f32_16x16x32_bf16 v[72:75], v[20:23], v[168:171], v[72:75]
    s_sub_u32 s77, s74, s77
    v_lshrrev_b32 v107, 2, v4
    v_or_b32 v106, v106, v107
    s_add_u32 m0, s61, 6144
    s_add_u32 s24, s59, 19200
    ds_read_b64_tr_b16 v[16:17], v5 offset:16384
    s_waitcnt lgkmcnt(5)
    v_mfma_f32_16x16x32_bf16 v[8:11], v[96:99], v[108:111], 0
    s_and_b32 s78, s2, 3
    buffer_load_dwordx4 v12, s[16:19], s24 offen lds
    s_nop 0
    v_mfma_f32_16x16x32_bf16 v[76:79], v[20:23], v[172:175], v[76:79]
    s_waitcnt lgkmcnt(3)
    ds_read_b64_tr_b16 v[18:19], v5 offset:17408
    buffer_store_dwordx4 v[108:111], v4, s[8:11], s68 offen sc1
    v_mfma_f32_16x16x32_bf16 v[80:83], v[24:27], v[168:171], v[80:83]
    s_lshr_b32 s53, s68, 3
    s_lshl_b32 s78, s78, 3
    s_add_u32 s78, s78, s76
    ds_read_b64_tr_b16 v[20:21], v0 offset:16384
    s_nop 0
    v_mfma_f32_16x16x32_bf16 v[84:87], v[24:27], v[172:175], v[84:87]
    s_waitcnt lgkmcnt(3)
    s_add_u32 s53, s53, 229376
    ds_read_b64_tr_b16 v[22:23], v0 offset:17408
    buffer_store_dword v8, v106, s[8:11], s53 offen sc1
    v_mfma_f32_16x16x32_bf16 v[88:91], v[28:31], v[168:171], v[88:91]
    s_and_b32 s79, s39, 3
    ds_read_b64_tr_b16 v[24:25], v0 offset:20480
    ds_read_b64_tr_b16 v[26:27], v0 offset:21504
    s_nop 1
    s_waitcnt vmcnt(15)
    v_mfma_f32_16x16x32_bf16 v[92:95], v[28:31], v[172:175], v[92:95]
    s_barrier
    s_waitcnt lgkmcnt(4)
    v_mfma_f32_16x16x32_bf16 v[100:103], v[96:99], v[16:19], v[100:103]
    ds_read_b64_tr_b16 v[28:29], v1 offset:16384
    ds_read_b64_tr_b16 v[30:31], v1 offset:17408
    s_waitcnt lgkmcnt(4)
    v_mfma_f32_16x16x32_bf16 v[32:35], v[20:23], v[176:179], v[32:35]
    s_cmp_eq_u32 s76, 3
    s_cselect_b32 s73, 31, 0
    ds_read_b64_tr_b16 v[16:17], v1 offset:20480
    s_nop 0
    v_mfma_f32_16x16x32_bf16 v[36:39], v[20:23], v[180:183], v[36:39]
    s_waitcnt lgkmcnt(3)
    s_add_u32 m0, s61, 7168
    s_add_u32 s25, s59, 19200
    ds_read_b64_tr_b16 v[18:19], v1 offset:21504
    v_mfma_f32_16x16x32_bf16 v[40:43], v[24:27], v[176:179], v[40:43]
    ds_read_b64_tr_b16 v[20:21], v2 offset:16384
    ds_read_b64_tr_b16 v[22:23], v2 offset:17408
    buffer_load_dwordx4 v13, s[16:19], s25 offen lds
    v_mfma_f32_16x16x32_bf16 v[44:47], v[24:27], v[180:183], v[44:47]
    s_waitcnt lgkmcnt(4)
    v_bfe_u32 v106, v4, 4, 2
    v_lshlrev_b32 v106, s66, v106
    s_cmp_eq_u32 s76, 2
    s_cselect_b32 s42, 1, 32
    s_waitcnt vmcnt(12)
    ds_read_b128 v[192:195], v14 offset:0
    v_mfma_f32_16x16x32_bf16 v[48:51], v[28:31], v[176:179], v[48:51]
    ds_read_b64_tr_b16 v[24:25], v2 offset:20480
    ds_read_b128 v[200:203], v15 offset:0
    s_nop 1
    v_mfma_f32_16x16x32_bf16 v[52:55], v[28:31], v[180:183], v[52:55]
    s_waitcnt lgkmcnt(5)
    v_and_b32 v107, 0x3c0, v4
    v_add3_u32 v106, v106, v107, s32
    s_add_u32 m0, s32, 8192
    s_add_u32 s26, s87, 3833856
    ds_read_b64_tr_b16 v[26:27], v2 offset:21504
    v_mfma_f32_16x16x32_bf16 v[56:59], v[16:19], v[176:179], v[56:59]
    ds_read_b64_tr_b16 v[28:29], v3 offset:16384
    ds_read_b64_tr_b16 v[30:31], v3 offset:17408
    buffer_load_dwordx4 v6, s[4:7], s26 offen  lds
    v_mfma_f32_16x16x32_bf16 v[60:63], v[16:19], v[180:183], v[60:63]
    s_waitcnt lgkmcnt(6)
    v_add_u32 v107, 155648, v106
    v_add_u32 v106, 65536, v106
    s_cmp_lt_u32 s77, 2
    s_cselect_b32 s73, s73, s42
    ds_read_b64_tr_b16 v[108:109], v106
    ds_read_b64_tr_b16 v[110:111], v107
    v_mfma_f32_16x16x32_bf16 v[64:67], v[20:23], v[176:179], v[64:67]
    s_add_u32 s73, s73, s78
    s_lshl_b32 s73, s73, 6
    s_and_b32 s42, s77, 1
    ds_read_b64_tr_b16 v[16:17], v3 offset:20480
    s_nop 0
    v_mfma_f32_16x16x32_bf16 v[68:71], v[20:23], v[180:183], v[68:71]
    s_add_u32 m0, s61, 8192
    s_add_u32 s27, s59, 896
    ds_read_b64_tr_b16 v[18:19], v3 offset:21504
    s_nop 0
    s_waitcnt lgkmcnt(6)
    v_mfma_f32_16x16x32_bf16 v[72:75], v[24:27], v[176:179], v[72:75]
    s_lshl_b32 s42, s42, 5
    ds_read_b64_tr_b16 v[20:21], v5 offset:24576
    ds_read_b64_tr_b16 v[22:23], v5 offset:25600
    buffer_load_dwordx4 v12, s[16:19], s27 offen lds
    v_mfma_f32_16x16x32_bf16 v[76:79], v[24:27], v[180:183], v[76:79]
    s_waitcnt lgkmcnt(6)
    v_lshlrev_b32 v106, 21, v4
    v_and_b32 v106, s38, v106
    s_add_u32 s73, s73, s42
    s_lshl_b32 s42, s79, 3
    v_mfma_f32_16x16x32_bf16 v[80:83], v[28:31], v[176:179], v[80:83]
    s_add_u32 s73, s73, s42
    v_lshrrev_b32 v107, 2, v4
    v_or_b32 v106, v106, v107
    s_lshl_b32 s43, s78, 4
    s_add_u32 s43, s43, 4096
    ds_read_b64_tr_b16 v[24:25], v0 offset:24576
    s_waitcnt lgkmcnt(5)
    v_mfma_f32_16x16x32_bf16 v[8:11], v[96:99], v[108:111], 0
    s_add_u32 s43, s43, s42
    buffer_store_dwordx4 v[108:111], v4, s[8:11], s69 offen sc1
    s_nop 0
    v_mfma_f32_16x16x32_bf16 v[84:87], v[28:31], v[180:183], v[84:87]
    s_lshr_b32 s53, s69, 3
    s_mul_i32 s72, s78, 18
    ds_read_b64_tr_b16 v[26:27], v0 offset:25600
    s_nop 0
    s_waitcnt lgkmcnt(4)
    v_mfma_f32_16x16x32_bf16 v[88:91], v[16:19], v[176:179], v[88:91]
    s_add_u32 s53, s53, 229376
    ds_read_b64_tr_b16 v[28:29], v0 offset:28672
    ds_read_b64_tr_b16 v[30:31], v0 offset:29696
    buffer_store_dword v8, v106, s[8:11], s53 offen sc1
    s_waitcnt vmcnt(15)
    v_mfma_f32_16x16x32_bf16 v[92:95], v[16:19], v[180:183], v[92:95]
    s_barrier
    s_waitcnt lgkmcnt(4)
    v_mfma_f32_16x16x32_bf16 v[100:103], v[96:99], v[20:23], v[100:103]
    ds_read_b64_tr_b16 v[16:17], v1 offset:24576
    ds_read_b64_tr_b16 v[18:19], v1 offset:25600
    s_nop 0
    s_waitcnt lgkmcnt(4)
    v_mfma_f32_16x16x32_bf16 v[32:35], v[24:27], v[184:187], v[32:35]
    s_add_u32 s72, s72, s42
    ds_read_b64_tr_b16 v[20:21], v1 offset:28672
    s_waitcnt vmcnt(13)
    ds_read_b128 v[196:199], v14 offset:2048
    s_nop 0
    v_mfma_f32_16x16x32_bf16 v[36:39], v[24:27], v[188:191], v[36:39]
    ds_read_b64_tr_b16 v[22:23], v1 offset:29696
    ds_read_b128 v[204:207], v15 offset:2048
    s_waitcnt lgkmcnt(6)
    v_mfma_f32_16x16x32_bf16 v[40:43], v[28:31], v[184:187], v[40:43]
    s_sub_u32 s72, s72, 16
    s_add_u32 m0, s61, 9216
    s_add_u32 s28, s59, 896
    ds_read_b64_tr_b16 v[24:25], v2 offset:24576
    v_mfma_f32_16x16x32_bf16 v[44:47], v[28:31], v[188:191], v[44:47]
    s_waitcnt lgkmcnt(5)
    s_cmp_lt_u32 s79, 2
    s_cselect_b32 s43, s43, s72
    s_cselect_b32 s72, 0, 1
    ds_read_b64_tr_b16 v[26:27], v2 offset:25600
    v_mfma_f32_16x16x32_bf16 v[48:51], v[16:19], v[184:187], v[48:51]
    ds_read_b64_tr_b16 v[28:29], v2 offset:28672
    ds_read_b64_tr_b16 v[30:31], v2 offset:29696
    buffer_load_dwordx4 v13, s[16:19], s28 offen lds
    v_mfma_f32_16x16x32_bf16 v[52:55], v[16:19], v[188:191], v[52:55]
    s_add_u32 m0, s32, 16384
    s_add_u32 s29, s87, 4128768
    s_nop 0
    s_waitcnt lgkmcnt(5)
    v_mfma_f32_16x16x32_bf16 v[56:59], v[20:23], v[184:187], v[56:59]
    ds_read_b64_tr_b16 v[16:17], v3 offset:24576
    ds_read_b64_tr_b16 v[18:19], v3 offset:25600
    buffer_load_dwordx4 v6, s[4:7], s29 offen  lds
    v_mfma_f32_16x16x32_bf16 v[60:63], v[20:23], v[188:191], v[60:63]
    s_waitcnt lgkmcnt(4)
    s_cmp_eq_u32 s77, 4
    s_cselect_b32 s73, s43, s73
    s_cselect_b32 s72, s72, 0
    v_mfma_f32_16x16x32_bf16 v[64:67], v[24:27], v[184:187], v[64:67]
    s_and_b32 s43, s2, 3
    s_add_u32 m0, s61, 0
    s_add_u32 s24, s59, 19328
    ds_read_b64_tr_b16 v[20:21], v3 offset:28672
    v_mfma_f32_16x16x32_bf16 v[68:71], v[24:27], v[188:191], v[68:71]
    s_waitcnt lgkmcnt(3)
    s_lshl_b32 s43, s43, 1
    s_add_u32 s43, s43, s79
    ds_read_b64_tr_b16 v[22:23], v3 offset:29696
    v_mfma_f32_16x16x32_bf16 v[72:75], v[28:31], v[184:187], v[72:75]
    s_mul_i32 s43, s43, 72
    ds_read_b64_tr_b16 v[24:25], v5 offset:32768
    ds_read_b64_tr_b16 v[26:27], v5 offset:33792
    buffer_load_dwordx4 v12, s[16:19], s24 offen lds
    v_mfma_f32_16x16x32_bf16 v[76:79], v[28:31], v[188:191], v[76:79]
    s_add_u32 s43, s43, 16
    s_waitcnt vmcnt(12)
    ds_read_b128 v[208:211], v14 offset:4096
    s_nop 0
    s_waitcnt lgkmcnt(5)
    v_mfma_f32_16x16x32_bf16 v[80:83], v[16:19], v[184:187], v[80:83]
    ds_read_b64_tr_b16 v[28:29], v0 offset:32768
    ds_read_b128 v[216:219], v15 offset:4096
    s_nop 0
    v_mfma_f32_16x16x32_bf16 v[84:87], v[16:19], v[188:191], v[84:87]
    s_waitcnt lgkmcnt(5)
    s_add_u32 m0, s61, 1024
    s_add_u32 s25, s59, 19328
    ds_read_b64_tr_b16 v[30:31], v0 offset:33792
    v_mfma_f32_16x16x32_bf16 v[88:91], v[20:23], v[184:187], v[88:91]
    ds_read_b64_tr_b16 v[16:17], v0 offset:36864
    ds_read_b64_tr_b16 v[18:19], v0 offset:37888
    buffer_load_dwordx4 v13, s[16:19], s25 offen lds
    v_mfma_f32_16x16x32_bf16 v[92:95], v[20:23], v[188:191], v[92:95]
    s_barrier
    s_waitcnt lgkmcnt(6)
    v_mfma_f32_16x16x32_bf16 v[100:103], v[96:99], v[24:27], v[100:103]
    s_waitcnt lgkmcnt(2)
    s_add_u32 m0, s32, 24576
    s_add_u32 s26, s87, 4423680
    ds_read_b64_tr_b16 v[20:21], v1 offset:32768
    ds_read_b64_tr_b16 v[22:23], v1 offset:33792
    v_mfma_f32_16x16x32_bf16 v[32:35], v[28:31], v[192:195], v[32:35]
    ds_read_b64_tr_b16 v[24:25], v1 offset:36864
    ds_read_b64_tr_b16 v[26:27], v1 offset:37888
    buffer_load_dwordx4 v6, s[4:7], s26 offen  lds
    v_mfma_f32_16x16x32_bf16 v[36:39], v[28:31], v[196:199], v[36:39]
    s_waitcnt lgkmcnt(4)
    s_cmp_ge_u32 s74, 40
    s_cselect_b32 s73, s43, s73
    s_cselect_b32 s72, 1, s72
    s_cselect_b32 s83, 18432, 0
    s_cselect_b32 s43, s79, 0
    v_mfma_f32_16x16x32_bf16 v[40:43], v[16:19], v[192:195], v[40:43]
    s_mul_i32 s73, s73, 1152
    s_add_u32 m0, s61, 2048
    s_add_u32 s27, s59, 1024
    ds_read_b64_tr_b16 v[28:29], v2 offset:32768
    v_mfma_f32_16x16x32_bf16 v[44:47], v[16:19], v[196:199], v[44:47]
    s_waitcnt lgkmcnt(3)
    s_mul_i32 s78, s75, 384
    s_add_u32 s67, s73, s78
    ds_read_b64_tr_b16 v[30:31], v2 offset:33792
    v_mfma_f32_16x16x32_bf16 v[48:51], v[20:23], v[192:195], v[48:51]
    s_mov_b32 s73, 663552
    ds_read_b64_tr_b16 v[16:17], v2 offset:36864
    ds_read_b64_tr_b16 v[18:19], v2 offset:37888
    buffer_load_dwordx4 v12, s[16:19], s27 offen lds
    v_mfma_f32_16x16x32_bf16 v[52:55], v[20:23], v[196:199], v[52:55]
    s_waitcnt lgkmcnt(4)
    s_cmp_eq_u32 s72, 1
    s_cselect_b32 s12, s48, s46
    s_cselect_b32 s13, s49, s47
    s_cselect_b32 s14, s73, 5308416
    v_mfma_f32_16x16x32_bf16 v[56:59], v[24:27], v[192:195], v[56:59]
    s_add_u32 m0, s61, 3072
    s_add_u32 s28, s59, 1024
    ds_read_b64_tr_b16 v[20:21], v3 offset:32768
    s_nop 0
    v_mfma_f32_16x16x32_bf16 v[60:63], v[24:27], v[196:199], v[60:63]
    s_waitcnt lgkmcnt(3)
    s_cmp_ge_u32 s43, 2
    s_cselect_b32 s14, 0, s14
    ds_read_b64_tr_b16 v[22:23], v3 offset:33792
    v_mfma_f32_16x16x32_bf16 v[64:67], v[28:31], v[192:195], v[64:67]
    s_mov_b32 s15, 0x20000
    ds_read_b64_tr_b16 v[24:25], v3 offset:36864
    ds_read_b64_tr_b16 v[26:27], v3 offset:37888
    buffer_load_dwordx4 v13, s[16:19], s28 offen lds
    v_mfma_f32_16x16x32_bf16 v[68:71], v[28:31], v[196:199], v[68:71]
    s_sub_u32 s73, 7, s77
    s_nop 1
    s_waitcnt lgkmcnt(4)
    v_mfma_f32_16x16x32_bf16 v[72:75], v[16:19], v[192:195], v[72:75]
    s_add_u32 m0, s61, 4096
    s_add_u32 s29, s59, 19456
    ds_read_b64_tr_b16 v[28:29], v5 offset:40960
    s_nop 0
    v_mfma_f32_16x16x32_bf16 v[76:79], v[16:19], v[196:199], v[76:79]
    s_waitcnt lgkmcnt(3)
    s_cmp_lt_u32 s77, 3
    s_cselect_b32 s73, s77, s73
    ds_read_b64_tr_b16 v[30:31], v5 offset:41984
    v_mfma_f32_16x16x32_bf16 v[80:83], v[20:23], v[192:195], v[80:83]
    s_lshl_b32 s73, s73, 2
    ds_read_b64_tr_b16 v[16:17], v0 offset:40960
    ds_read_b64_tr_b16 v[18:19], v0 offset:41984
    buffer_load_dwordx4 v12, s[16:19], s29 offen lds
    v_mfma_f32_16x16x32_bf16 v[84:87], v[20:23], v[196:199], v[84:87]
    s_waitcnt lgkmcnt(4)
    s_and_b32 s77, s76, 3
    s_add_u32 s73, s73, s77
    s_waitcnt vmcnt(12)
    ds_read_b128 v[212:215], v14 offset:6144
    v_mfma_f32_16x16x32_bf16 v[88:91], v[24:27], v[192:195], v[88:91]
    s_add_u32 m0, s61, 5120
    s_add_u32 s24, s59, 19456
    ds_read_b64_tr_b16 v[20:21], v0 offset:45056
    ds_read_b64_tr_b16 v[22:23], v0 offset:46080
    s_waitcnt vmcnt(8)
    v_mfma_f32_16x16x32_bf16 v[92:95], v[24:27], v[196:199], v[92:95]
    s_barrier
    s_waitcnt lgkmcnt(5)
    v_mfma_f32_16x16x32_bf16 v[100:103], v[96:99], v[28:31], v[100:103]
    ds_read_b64_tr_b16 v[24:25], v1 offset:40960
    ds_read_b64_tr_b16 v[26:27], v1 offset:41984
    s_waitcnt lgkmcnt(5)
    v_mfma_f32_16x16x32_bf16 v[32:35], v[16:19], v[200:203], v[32:35]
    s_lshr_b32 s76, s76, 2
    ds_read_b64_tr_b16 v[28:29], v1 offset:45056
    ds_read_b64_tr_b16 v[30:31], v1 offset:46080
    buffer_load_dwordx4 v13, s[16:19], s24 offen lds
    v_mfma_f32_16x16x32_bf16 v[36:39], v[16:19], v[204:207], v[36:39]
    s_waitcnt lgkmcnt(4)
    v_lshlrev_b32 v9, 21, v4
    v_and_b32 v9, s38, v9
    s_cmp_ge_u32 s74, 40
    s_cselect_b32 s73, 20, s73
    s_cselect_b32 s76, 0, s76
    ds_read_b128 v[220:223], v15 offset:6144
    v_mfma_f32_16x16x32_bf16 v[40:43], v[20:23], v[200:203], v[40:43]
    s_mul_i32 s75, s75, 12
    v_lshrrev_b32 v10, 2, v4
    v_or_b32 v9, v9, v10
    s_add_u32 m0, s32, 49152
    s_mov_b32 s25, 0
    ds_read_b64_tr_b16 v[16:17], v2 offset:40960
    v_mfma_f32_16x16x32_bf16 v[44:47], v[20:23], v[204:207], v[44:47]
    s_waitcnt lgkmcnt(4)
    v_mov_b32 v10, s54
    s_add_u32 s75, s75, s79
    ds_read_b64_tr_b16 v[18:19], v2 offset:41984
    v_mfma_f32_16x16x32_bf16 v[48:51], v[24:27], v[200:203], v[48:51]
    ds_read_b64_tr_b16 v[20:21], v2 offset:45056
    ds_read_b64_tr_b16 v[22:23], v2 offset:46080
    buffer_load_dword v7, s[4:7], s25 offen lds
    v_mfma_f32_16x16x32_bf16 v[52:55], v[24:27], v[204:207], v[52:55]
    s_waitcnt lgkmcnt(5)
    s_add_u32 s31, s55, 0
    buffer_store_dword v10, v9, s[8:11], s31 offen sc1
    v_mfma_f32_16x16x32_bf16 v[56:59], v[28:31], v[200:203], v[56:59]
    s_add_u32 m0, s32, 32768
    s_add_u32 s26, s87, 4718592
    ds_read_b64_tr_b16 v[24:25], v3 offset:40960
    s_nop 1
    v_mfma_f32_16x16x32_bf16 v[60:63], v[28:31], v[204:207], v[60:63]
    ds_read_b64_tr_b16 v[26:27], v3 offset:41984
    s_nop 1
    s_waitcnt lgkmcnt(4)
    v_mfma_f32_16x16x32_bf16 v[64:67], v[16:19], v[200:203], v[64:67]
    ds_read_b64_tr_b16 v[28:29], v3 offset:45056
    ds_read_b64_tr_b16 v[30:31], v3 offset:46080
    buffer_load_dwordx4 v6, s[4:7], s26 offen  lds
    v_mfma_f32_16x16x32_bf16 v[68:71], v[16:19], v[204:207], v[68:71]
    s_nop 2
    s_waitcnt lgkmcnt(4)
    v_mfma_f32_16x16x32_bf16 v[72:75], v[20:23], v[200:203], v[72:75]
    s_add_u32 m0, s32, 49152
    s_mov_b32 s27, 589824
    ds_read_b64_tr_b16 v[16:17], v5 offset:0
    s_nop 0
    v_mfma_f32_16x16x32_bf16 v[76:79], v[20:23], v[204:207], v[76:79]
    ds_read_b64_tr_b16 v[18:19], v5 offset:1024
    s_nop 0
    s_waitcnt lgkmcnt(4)
    v_mfma_f32_16x16x32_bf16 v[80:83], v[24:27], v[200:203], v[80:83]
    ds_read_b64_tr_b16 v[20:21], v0 offset:0
    ds_read_b64_tr_b16 v[22:23], v0 offset:1024
    buffer_load_dword v7, s[4:7], s27 offen lds
    v_mfma_f32_16x16x32_bf16 v[84:87], v[24:27], v[204:207], v[84:87]
    s_waitcnt vmcnt(12)
    ds_read_b128 v[224:227], v14 offset:8192
    s_nop 0
    s_waitcnt lgkmcnt(5)
    v_mfma_f32_16x16x32_bf16 v[88:91], v[28:31], v[200:203], v[88:91]
    ds_read_b64_tr_b16 v[24:25], v0 offset:4096
    ds_read_b64_tr_b16 v[26:27], v0 offset:5120
    s_nop 0
    v_mfma_f32_16x16x32_bf16 v[92:95], v[28:31], v[204:207], v[92:95]
    s_barrier
    s_waitcnt lgkmcnt(5)
    v_mfma_f32_16x16x32_bf16 v[100:103], v[96:99], v[16:19], v[100:103]
    s_waitcnt lgkmcnt(3)
    s_add_u32 m0, s32, 40960
    s_add_u32 s28, s87, 5013504
    ds_read_b64_tr_b16 v[28:29], v1 offset:0
    ds_read_b64_tr_b16 v[30:31], v1 offset:1024
    v_mfma_f32_16x16x32_bf16 v[32:35], v[20:23], v[208:211], v[32:35]
    ds_read_b64_tr_b16 v[16:17], v1 offset:4096
    ds_read_b64_tr_b16 v[18:19], v1 offset:5120
    buffer_load_dwordx4 v6, s[4:7], s28 offen  lds
    v_mfma_f32_16x16x32_bf16 v[36:39], v[20:23], v[212:215], v[36:39]
    s_waitcnt lgkmcnt(4)
    v_lshrrev_b32 v8, 5, v4
    v_lshlrev_b32 v8, 7, v8
    s_mul_i32 s87, s44, 589824
    ds_read_b128 v[232:235], v15 offset:8192
    v_mfma_f32_16x16x32_bf16 v[40:43], v[24:27], v[208:211], v[40:43]
    s_lshl_b32 s58, s84, 3
    s_add_u32 s58, s58, s39
    s_add_u32 m0, s32, 49152
    s_mov_b32 s29, 1179648
    ds_read_b64_tr_b16 v[20:21], v2 offset:0
    v_mfma_f32_16x16x32_bf16 v[44:47], v[24:27], v[212:215], v[44:47]
    ds_read_b64_tr_b16 v[22:23], v2 offset:1024
    s_nop 1
    s_waitcnt lgkmcnt(5)
    v_mfma_f32_16x16x32_bf16 v[48:51], v[28:31], v[208:211], v[48:51]
    ds_read_b64_tr_b16 v[24:25], v2 offset:4096
    ds_read_b64_tr_b16 v[26:27], v2 offset:5120
    buffer_load_dword v7, s[4:7], s29 offen lds
    v_mfma_f32_16x16x32_bf16 v[52:55], v[28:31], v[212:215], v[52:55]
    s_waitcnt lgkmcnt(5)
    s_lshl_b32 s58, s58, 12
    buffer_load_dwordx4 v[104:107], v8, s[8:11], s58 offen sc1
    v_mfma_f32_16x16x32_bf16 v[56:59], v[16:19], v[208:211], v[56:59]
    ds_read_b64_tr_b16 v[28:29], v3 offset:0
    s_nop 2
    v_mfma_f32_16x16x32_bf16 v[60:63], v[16:19], v[212:215], v[60:63]
    ds_read_b64_tr_b16 v[30:31], v3 offset:1024
    s_waitcnt vmcnt(12)
    ds_read_b128 v[228:231], v14 offset:0
    s_waitcnt lgkmcnt(5)
    v_mfma_f32_16x16x32_bf16 v[64:67], v[20:23], v[208:211], v[64:67]
    ds_read_b64_tr_b16 v[16:17], v3 offset:4096
    ds_read_b128 v[236:239], v15 offset:0
    s_nop 0
    v_mfma_f32_16x16x32_bf16 v[68:71], v[20:23], v[212:215], v[68:71]
    ds_read_b64_tr_b16 v[18:19], v3 offset:5120
    s_nop 0
    s_waitcnt lgkmcnt(6)
    v_mfma_f32_16x16x32_bf16 v[72:75], v[24:27], v[208:211], v[72:75]
    s_add_u32 m0, s32, 49152
    s_mov_b32 s24, 1769472
    ds_read_b64_tr_b16 v[20:21], v5 offset:8192
    s_nop 0
    v_mfma_f32_16x16x32_bf16 v[76:79], v[24:27], v[212:215], v[76:79]
    ds_read_b64_tr_b16 v[22:23], v5 offset:9216
    s_nop 0
    s_waitcnt lgkmcnt(6)
    v_mfma_f32_16x16x32_bf16 v[80:83], v[28:31], v[208:211], v[80:83]
    ds_read_b64_tr_b16 v[24:25], v0 offset:8192
    ds_read_b64_tr_b16 v[26:27], v0 offset:9216
    buffer_load_dword v7, s[4:7], s24 offen lds
    v_mfma_f32_16x16x32_bf16 v[84:87], v[28:31], v[212:215], v[84:87]
    s_nop 2
    s_waitcnt lgkmcnt(4)
    v_mfma_f32_16x16x32_bf16 v[88:91], v[16:19], v[208:211], v[88:91]
    ds_read_b64_tr_b16 v[28:29], v0 offset:12288
    ds_read_b64_tr_b16 v[30:31], v0 offset:13312
    s_nop 0
    v_mfma_f32_16x16x32_bf16 v[92:95], v[16:19], v[212:215], v[92:95]
    s_barrier
    s_waitcnt lgkmcnt(4)
    v_mfma_f32_16x16x32_bf16 v[100:103], v[96:99], v[20:23], v[100:103]
    ds_read_b64_tr_b16 v[16:17], v1 offset:8192
    ds_read_b64_tr_b16 v[18:19], v1 offset:9216
    s_waitcnt lgkmcnt(4)
    v_mfma_f32_16x16x32_bf16 v[32:35], v[24:27], v[216:219], v[32:35]
    ds_read_b64_tr_b16 v[20:21], v1 offset:12288
    s_waitcnt vmcnt(10)
    ds_read_b128 v[240:243], v14 offset:2048
    s_nop 0
    v_mfma_f32_16x16x32_bf16 v[36:39], v[24:27], v[220:223], v[36:39]
    ds_read_b64_tr_b16 v[22:23], v1 offset:13312
    ds_read_b128 v[248:251], v15 offset:2048
    s_waitcnt lgkmcnt(6)
    v_mfma_f32_16x16x32_bf16 v[40:43], v[28:31], v[216:219], v[40:43]
    s_add_u32 m0, s32, 49152
    s_mov_b32 s25, 2359296
    ds_read_b64_tr_b16 v[24:25], v2 offset:8192
    s_nop 0
    v_mfma_f32_16x16x32_bf16 v[44:47], v[28:31], v[220:223], v[44:47]
    ds_read_b64_tr_b16 v[26:27], v2 offset:9216
    s_nop 0
    s_waitcnt lgkmcnt(6)
    v_mfma_f32_16x16x32_bf16 v[48:51], v[16:19], v[216:219], v[48:51]
    ds_read_b64_tr_b16 v[28:29], v2 offset:12288
    ds_read_b64_tr_b16 v[30:31], v2 offset:13312
    buffer_load_dword v7, s[4:7], s25 offen lds
    v_mfma_f32_16x16x32_bf16 v[52:55], v[16:19], v[220:223], v[52:55]
    s_nop 2
    s_waitcnt lgkmcnt(5)
    v_mfma_f32_16x16x32_bf16 v[56:59], v[20:23], v[216:219], v[56:59]
    ds_read_b64_tr_b16 v[16:17], v3 offset:8192
    s_nop 1
    v_mfma_f32_16x16x32_bf16 v[60:63], v[20:23], v[220:223], v[60:63]
    ds_read_b64_tr_b16 v[18:19], v3 offset:9216
    s_nop 0
    s_waitcnt lgkmcnt(4)
    v_mfma_f32_16x16x32_bf16 v[64:67], v[24:27], v[216:219], v[64:67]
    ds_read_b64_tr_b16 v[20:21], v3 offset:12288
    s_waitcnt vmcnt(9)
    ds_read_b128 v[244:247], v14 offset:4096
    s_nop 0
    v_mfma_f32_16x16x32_bf16 v[68:71], v[24:27], v[220:223], v[68:71]
    ds_read_b64_tr_b16 v[22:23], v3 offset:13312
    ds_read_b128 v[252:255], v15 offset:4096
    s_waitcnt lgkmcnt(6)
    v_mfma_f32_16x16x32_bf16 v[72:75], v[28:31], v[216:219], v[72:75]
    s_add_u32 m0, s32, 49152
    v_lshrrev_b32 v9, 7, v4
    v_lshlrev_b32 v9, 7, v9
    s_mov_b32 s26, 2949120
    ds_read_b64_tr_b16 v[24:25], v5 offset:16384
    v_mfma_f32_16x16x32_bf16 v[76:79], v[28:31], v[220:223], v[76:79]
    ds_read_b64_tr_b16 v[26:27], v5 offset:17408
    s_nop 1
    s_waitcnt lgkmcnt(6)
    v_mfma_f32_16x16x32_bf16 v[80:83], v[16:19], v[216:219], v[80:83]
    ds_read_b64_tr_b16 v[28:29], v0 offset:16384
    ds_read_b64_tr_b16 v[30:31], v0 offset:17408
    buffer_load_dword v7, s[4:7], s26 offen lds
    v_mfma_f32_16x16x32_bf16 v[84:87], v[16:19], v[220:223], v[84:87]
    buffer_load_dword v10, v9, s[8:11], s56 offen sc1
    s_waitcnt lgkmcnt(5)
    v_mfma_f32_16x16x32_bf16 v[88:91], v[20:23], v[216:219], v[88:91]
    ds_read_b64_tr_b16 v[16:17], v0 offset:20480
    ds_read_b64_tr_b16 v[18:19], v0 offset:21504
    s_nop 1
    s_waitcnt lgkmcnt(6)
    s_waitcnt vmcnt(8)
    v_mfma_f32_16x16x32_bf16 v[92:95], v[20:23], v[220:223], v[92:95]
    s_barrier
    s_waitcnt lgkmcnt(4)
    v_mfma_f32_16x16x32_bf16 v[100:103], v[96:99], v[24:27], v[100:103]
    ds_read_b64_tr_b16 v[20:21], v1 offset:16384
    ds_read_b64_tr_b16 v[22:23], v1 offset:17408
    s_waitcnt lgkmcnt(4)
    v_mfma_f32_16x16x32_bf16 v[32:35], v[28:31], v[224:227], v[32:35]
    ds_read_b64_tr_b16 v[24:25], v1 offset:20480
    s_nop 1
    v_mfma_f32_16x16x32_bf16 v[36:39], v[28:31], v[228:231], v[36:39]
    s_waitcnt lgkmcnt(3)
    s_add_u32 m0, s32, 49152
    s_mov_b32 s27, 3538944
    ds_read_b64_tr_b16 v[26:27], v1 offset:21504
    v_mfma_f32_16x16x32_bf16 v[40:43], v[16:19], v[224:227], v[40:43]
    ds_read_b64_tr_b16 v[28:29], v2 offset:16384
    ds_read_b64_tr_b16 v[30:31], v2 offset:17408
    buffer_load_dword v7, s[4:7], s27 offen lds
    v_mfma_f32_16x16x32_bf16 v[44:47], v[16:19], v[228:231], v[44:47]
    s_nop 2
    s_waitcnt lgkmcnt(4)
    v_mfma_f32_16x16x32_bf16 v[48:51], v[20:23], v[224:227], v[48:51]
    s_waitcnt vmcnt(5)
    v_xor_b32 v105, s54, v105
    v_xor_b32 v107, s54, v107
    ds_read_b64_tr_b16 v[16:17], v2 offset:20480
    v_mfma_f32_16x16x32_bf16 v[52:55], v[20:23], v[228:231], v[52:55]
    s_waitcnt lgkmcnt(3)
    v_or_b32 v105, v105, v107
    v_cmp_ne_u32 vcc, 0, v105
    ds_read_b64_tr_b16 v[18:19], v2 offset:21504
    v_mfma_f32_16x16x32_bf16 v[56:59], v[24:27], v[224:227], v[56:59]
    ds_read_b64_tr_b16 v[20:21], v3 offset:16384
    s_nop 1
    s_cbranch_vccnz L_sl7
L_bk7:
    s_nop 1
    v_mfma_f32_16x16x32_bf16 v[60:63], v[24:27], v[228:231], v[60:63]
    s_waitcnt lgkmcnt(3)
    v_lshrrev_b32 v8, 5, v8
    s_add_u32 s53, s32, 155648
    ds_read_b64_tr_b16 v[22:23], v3 offset:17408
    v_mfma_f32_16x16x32_bf16 v[64:67], v[28:31], v[224:227], v[64:67]
    v_add_u32 v8, s53, v8
    v_bfe_u32 v105, v4, 4, 4
    ds_read_b64_tr_b16 v[24:25], v3 offset:20480
    v_mfma_f32_16x16x32_bf16 v[68:71], v[28:31], v[228:231], v[68:71]
    s_waitcnt lgkmcnt(3)
    v_lshl_add_u32 v105, v105, 2, s53
    s_add_u32 m0, s32, 49152
    s_mov_b32 s28, 4128768
    ds_read_b64_tr_b16 v[26:27], v3 offset:21504
    ds_write_b32 v8, v106 offset:512
    v_mfma_f32_16x16x32_bf16 v[72:75], v[16:19], v[224:227], v[72:75]
    ds_read_b64_tr_b16 v[28:29], v5 offset:24576
    ds_read_b64_tr_b16 v[30:31], v5 offset:25600
    buffer_load_dword v7, s[4:7], s28 offen lds
    v_mfma_f32_16x16x32_bf16 v[76:79], v[16:19], v[228:231], v[76:79]
    ds_write_b32 v8, v104 offset:640
    ds_read_b32 v108, v105 offset:640
    s_nop 0
    s_waitcnt lgkmcnt(7)
    v_mfma_f32_16x16x32_bf16 v[80:83], v[20:23], v[224:227], v[80:83]
    ds_read_b64_tr_b16 v[16:17], v0 offset:24576
    ds_read_b32 v109, v105 offset:512
    s_nop 1
    v_mfma_f32_16x16x32_bf16 v[84:87], v[20:23], v[228:231], v[84:87]
    ds_read_b64_tr_b16 v[18:19], v0 offset:25600
    ds_read_b32 v110, v105 offset:704
    s_nop 0
    s_waitcnt lgkmcnt(9)
    v_mfma_f32_16x16x32_bf16 v[88:91], v[24:27], v[224:227], v[88:91]
    ds_read_b64_tr_b16 v[20:21], v5 offset:32768
    ds_read_b64_tr_b16 v[22:23], v5 offset:33792
    s_nop 1
    v_mfma_f32_16x16x32_bf16 v[92:95], v[24:27], v[228:231], v[92:95]
    s_barrier
    s_waitcnt lgkmcnt(8)
    v_mfma_f32_16x16x32_bf16 v[100:103], v[96:99], v[28:31], v[100:103]
    ds_read_b64_tr_b16 v[24:25], v0 offset:28672
    ds_read_b64_tr_b16 v[26:27], v0 offset:29696
    s_waitcnt lgkmcnt(5)
    v_mfma_f32_16x16x32_bf16 v[32:35], v[16:19], v[232:235], v[32:35]
    s_add_u32 m0, s32, 49152
    s_mov_b32 s29, 4718592
    ds_read_b64_tr_b16 v[28:29], v5 offset:40960
    ds_read_b32 v111, v105 offset:576
    v_mfma_f32_16x16x32_bf16 v[36:39], v[16:19], v[236:239], v[36:39]
    ds_read_b64_tr_b16 v[30:31], v5 offset:41984
    s_nop 0
    s_waitcnt lgkmcnt(5)
    v_mfma_f32_16x16x32_bf16 v[100:103], v[96:99], v[20:23], v[100:103]
    ds_read_b64_tr_b16 v[16:17], v0 offset:32768
    ds_read_b64_tr_b16 v[18:19], v0 offset:33792
    s_waitcnt lgkmcnt(5)
    v_mfma_f32_16x16x32_bf16 v[40:43], v[24:27], v[232:235], v[40:43]
    ds_read_b64_tr_b16 v[20:21], v0 offset:36864
    ds_read_b64_tr_b16 v[22:23], v0 offset:37888
    buffer_load_dword v7, s[4:7], s29 offen lds
    v_mfma_f32_16x16x32_bf16 v[44:47], v[24:27], v[236:239], v[44:47]
    s_waitcnt vmcnt(3)
    v_cmp_ne_u32 vcc, s54, v10
    s_nop 1
    s_waitcnt lgkmcnt(4)
    v_mfma_f32_16x16x32_bf16 v[100:103], v[96:99], v[28:31], v[100:103]
    ds_read_b64_tr_b16 v[24:25], v0 offset:40960
    ds_read_b64_tr_b16 v[26:27], v0 offset:41984
    s_cbranch_vccnz L_sl1
L_bk1:
    s_waitcnt lgkmcnt(4)
    v_mfma_f32_16x16x32_bf16 v[32:35], v[16:19], v[240:243], v[32:35]
    ds_read_b64_tr_b16 v[28:29], v0 offset:45056
    s_nop 2
    v_mfma_f32_16x16x32_bf16 v[36:39], v[16:19], v[244:247], v[36:39]
    ds_read_b64_tr_b16 v[30:31], v0 offset:46080
    s_nop 1
    s_waitcnt lgkmcnt(4)
    v_mfma_f32_16x16x32_bf16 v[40:43], v[20:23], v[240:243], v[40:43]
    v_cvt_pk_bf16_f32 v96, v100, v100
    v_and_b32 v96, 0xffff0000, v96
    ds_read_b64_tr_b16 v[16:17], v1 offset:24576
    v_mfma_f32_16x16x32_bf16 v[44:47], v[20:23], v[244:247], v[44:47]
    s_waitcnt lgkmcnt(3)
    v_sub_f32 v96, v100, v96
    v_cvt_pk_bf16_f32 v96, v100, v96
    ds_read_b64_tr_b16 v[18:19], v1 offset:25600
    v_mfma_f32_16x16x32_bf16 v[32:35], v[24:27], v[248:251], v[32:35]
    v_mov_b32 v97, 0
    v_bfe_u32 v98, v4, 1, 8
    s_add_u32 s72, s32, 156416
    ds_read_b64_tr_b16 v[20:21], v1 offset:28672
    v_mfma_f32_16x16x32_bf16 v[36:39], v[24:27], v[252:255], v[36:39]
    s_waitcnt lgkmcnt(3)
    v_bfe_i32 v99, v4, 8, 1
    v_bfi_b32 v96, v99, 0, v96
    ds_read_b64_tr_b16 v[22:23], v1 offset:29696
    v_mfma_f32_16x16x32_bf16 v[40:43], v[28:31], v[248:251], v[40:43]
    v_add_u32 v98, s72, v98
    ds_read_b64_tr_b16 v[24:25], v1 offset:32768
    ds_read_b64_tr_b16 v[26:27], v1 offset:33792
    ds_write_b64 v98, v[96:97]
    v_cmp_gt_u32 vcc, 0x200, v4
    v_cvt_pk_bf16_f32 v108, v108, v108
    v_mul_f32 v109, 0xc0135761, v109
    v_cvt_pk_bf16_f32 v110, v110, v110
    v_mul_f32 v111, 0xc0135761, v111
    v_cndmask_b32 v12, 0, v108, vcc
    v_and_b32 v13, 0xffffff7f, v109
    v_cndmask_b32 v14, 0, v110, vcc
    v_and_b32 v15, 0xffffff7f, v111
    s_waitcnt lgkmcnt(0)
    v_mfma_f32_16x16x32_bf16 v[44:47], v[28:31], v[252:255], v[44:47]
    s_barrier
    v_mfma_f32_16x16x32_bf16 v[48:51], v[16:19], v[232:235], v[48:51]
    s_add_u32 s30, s39, 38
    s_add_u32 m0, s32, 73728
    s_add_u32 s24, s60, s86
    ds_read_b64_tr_b16 v[28:29], v1 offset:36864
    s_cmp_lt_u32 s39, 2
    s_cselect_b32 s30, s39, s30
    s_cselect_b32 s31, 8, 9
    v_mfma_f32_16x16x32_bf16 v[52:55], v[16:19], v[236:239], v[52:55]
    s_mul_i32 s53, s85, 112
    s_add_u32 s30, s30, s53
    ds_read_b64_tr_b16 v[30:31], v1 offset:37888
    s_nop 0
    v_mfma_f32_16x16x32_bf16 v[56:59], v[20:23], v[232:235], v[56:59]
    s_lshl_b32 s30, s30, 7
    v_bfe_u32 v5, v4, 1, 8
    v_add_u32 v5, 0x18000, v5
    s_add_u32 s53, s30, 524288
    ds_read_b64 v[16:17], v5 offset:58112
    v_mfma_f32_16x16x32_bf16 v[60:63], v[20:23], v[236:239], v[60:63]
    buffer_load_dwordx4 v4, s[8:11], s24 offen sc1 lds
    v_mfma_f32_16x16x32_bf16 v[48:51], v[24:27], v[240:243], v[48:51]
    v_lshrrev_b32 v96, 8, v4
    v_cmp_gt_u32 vcc, 2, v96
    s_add_u32 s86, s86, 8192
    s_sub_u32 s24, s86, 36864
    s_cselect_b32 s86, s86, s24
    ds_read_b64 v[20:21], v5 offset:62208
    v_mfma_f32_16x16x32_bf16 v[52:55], v[24:27], v[244:247], v[52:55]
    s_waitcnt lgkmcnt(2)
    v_lshlrev_b32 v96, s31, v96
    v_bfe_u32 v97, v4, 4, 4
    s_add_u32 m0, s32, 81920
    s_add_u32 s25, s60, s86
    v_mfma_f32_16x16x32_bf16 v[56:59], v[28:31], v[240:243], v[56:59]
    ds_read_b64_tr_b16 v[24:25], v1 offset:40960
    ds_read_b64_tr_b16 v[26:27], v1 offset:41984
    buffer_load_dwordx4 v4, s[8:11], s25 offen sc1 lds
    v_mfma_f32_16x16x32_bf16 v[60:63], v[28:31], v[244:247], v[60:63]
    s_waitcnt lgkmcnt(3)
    v_lshl_add_u32 v96, v97, 2, v96
    v_mov_b32 v97, s38
    s_add_u32 s86, s86, 8192
    s_sub_u32 s25, s86, 36864
    s_cselect_b32 s86, s86, s25
    v_mfma_f32_16x16x16_bf16 v[32:35], v[16:17], v[12:13], v[32:35]
    v_cndmask_b32 v97, v97, v96, vcc
    ds_read_b64_tr_b16 v[28:29], v1 offset:45056
    v_mfma_f32_16x16x16_bf16 v[36:39], v[16:17], v[14:15], v[36:39]
    s_waitcnt lgkmcnt(3)
    s_lshl_b32 s31, 4, s31
    ds_read_b64_tr_b16 v[30:31], v1 offset:46080
    buffer_load_dword v100, v96, s[8:11], s53 offen sc1
    v_mfma_f32_16x16x16_bf16 v[40:43], v[20:21], v[12:13], v[40:43]
    s_add_u32 s53, s53, s31
    ds_read_b64 v[16:17], v5 offset:59136
    buffer_load_dword v101, v96, s[8:11], s53 offen sc1
    v_mfma_f32_16x16x16_bf16 v[44:47], v[20:21], v[14:15], v[44:47]
    s_waitcnt lgkmcnt(3)
    s_add_u32 s53, s53, s31
    buffer_load_dword v102, v96, s[8:11], s53 offen sc1
    v_mfma_f32_16x16x32_bf16 v[48:51], v[24:27], v[248:251], v[48:51]
    s_add_u32 s53, s53, s31
    ds_read_b64 v[20:21], v5 offset:63232
    buffer_load_dword v103, v96, s[8:11], s53 offen sc1
    v_mfma_f32_16x16x32_bf16 v[52:55], v[24:27], v[252:255], v[52:55]
    s_waitcnt lgkmcnt(2)
    s_add_u32 s53, s53, s31
    buffer_load_dword v98, v97, s[8:11], s53 offen sc1
    v_mfma_f32_16x16x32_bf16 v[56:59], v[28:31], v[248:251], v[56:59]
    v_lshrrev_b32 v105, 3, v4
    v_xor_b32 v105, v105, v4
    ds_read_b64_tr_b16 v[24:25], v2 offset:24576
    v_mfma_f32_16x16x32_bf16 v[60:63], v[28:31], v[252:255], v[60:63]
    s_waitcnt lgkmcnt(2)
    v_and_b32 v105, 0x60, v105
    v_and_or_b32 v105, v4, 16, v105
    ds_read_b64_tr_b16 v[26:27], v2 offset:25600
    v_mfma_f32_16x16x16_bf16 v[48:51], v[16:17], v[12:13], v[48:51]
    s_add_u32 m0, s32, 90112
    v_lshrrev_b32 v106, 8, v4
    v_mad_u32_u24 v105, v106, s83, v105
    s_add_u32 s26, s60, s86
    ds_read_b64_tr_b16 v[28:29], v2 offset:28672
    v_mfma_f32_16x16x16_bf16 v[52:55], v[16:17], v[14:15], v[52:55]
    s_waitcnt lgkmcnt(3)
    v_lshrrev_b32 v106, 7, v4
    v_mul_u32_u24 v106, 1152, v106
    ds_read_b64_tr_b16 v[30:31], v2 offset:29696
    v_mfma_f32_16x16x16_bf16 v[56:59], v[20:21], v[12:13], v[56:59]
    ds_read_b64_tr_b16 v[16:17], v2 offset:32768
    ds_read_b64_tr_b16 v[18:19], v2 offset:33792
    buffer_load_dwordx4 v4, s[8:11], s26 offen sc1 lds
    v_mfma_f32_16x16x16_bf16 v[60:63], v[20:21], v[14:15], v[60:63]
    s_waitcnt lgkmcnt(4)
    v_add_u32 v105, v105, v106
    v_mul_f32 v0, v13, v13
    s_add_u32 s86, s86, 8192
    s_sub_u32 s26, s86, 36864
    s_cselect_b32 s86, s86, s26
    v_mfma_f32_16x16x32_bf16 v[64:67], v[24:27], v[232:235], v[64:67]
    s_add_u32 m0, s32, 98304
    v_mul_f32 v7, v15, v15
    v_mul_f32 v0, 0x3c0a3963, v0
    s_add_u32 s27, s60, s86
    ds_read_b64_tr_b16 v[20:21], v2 offset:36864
    v_mfma_f32_16x16x32_bf16 v[68:71], v[24:27], v[236:239], v[68:71]
    s_waitcnt lgkmcnt(3)
    v_mul_f32 v7, 0x3c0a3963, v7
    v_mul_f32 v0, v0, v13
    ds_read_b64_tr_b16 v[22:23], v2 offset:37888
    v_mfma_f32_16x16x32_bf16 v[72:75], v[28:31], v[232:235], v[72:75]
    ds_read_b64_tr_b16 v[24:25], v2 offset:40960
    ds_read_b64_tr_b16 v[26:27], v2 offset:41984
    buffer_load_dwordx4 v4, s[8:11], s27 offen sc1 lds
    v_mfma_f32_16x16x32_bf16 v[76:79], v[28:31], v[236:239], v[76:79]
    s_waitcnt lgkmcnt(4)
    v_mul_f32 v7, v7, v15
    v_mul_f32 v8, v32, v32
    s_add_u32 s86, s86, 8192
    s_sub_u32 s27, s86, 36864
    s_cselect_b32 s86, s86, s27
    v_mfma_f32_16x16x32_bf16 v[64:67], v[16:19], v[240:243], v[64:67]
    s_add_u32 m0, s32, 106496
    v_mul_f32 v9, v33, v33
    v_mul_f32 v10, v34, v34
    s_add_u32 s28, s60, s86
    ds_read_b64_tr_b16 v[28:29], v2 offset:45056
    v_mfma_f32_16x16x32_bf16 v[68:71], v[16:19], v[244:247], v[68:71]
    s_waitcnt lgkmcnt(3)
    v_mul_f32 v11, v35, v35
    v_fma_f32 v8, v8, v0, v13
    ds_read_b64_tr_b16 v[30:31], v2 offset:46080
    v_mfma_f32_16x16x32_bf16 v[72:75], v[20:23], v[240:243], v[72:75]
    v_fma_f32 v9, v9, v0, v13
    v_fma_f32 v10, v10, v0, v13
    ds_read_b64 v[16:17], v5 offset:60160
    v_mfma_f32_16x16x32_bf16 v[76:79], v[20:23], v[244:247], v[76:79]
    buffer_load_dwordx4 v4, s[8:11], s28 offen sc1 lds
    s_waitcnt lgkmcnt(3)
    v_mfma_f32_16x16x32_bf16 v[64:67], v[24:27], v[248:251], v[64:67]
    v_fma_f32 v11, v11, v0, v13
    v_mul_f32 v8, v32, v8
    s_add_u32 s60, s60, 40960
    s_lshl_b32 s86, s44, 13
    s_add_u32 s86, s86, s32
    ds_read_b64 v[20:21], v5 offset:64256
    v_mfma_f32_16x16x32_bf16 v[68:71], v[24:27], v[252:255], v[68:71]
    s_waitcnt lgkmcnt(2)
    v_mul_f32 v9, v33, v9
    v_mul_f32 v10, v34, v10
    s_add_u32 m0, s32, 114688
    s_add_u32 s29, s60, s86
    v_mfma_f32_16x16x32_bf16 v[72:75], v[28:31], v[248:251], v[72:75]
    ds_read_b64_tr_b16 v[24:25], v3 offset:24576
    ds_read_b64_tr_b16 v[26:27], v3 offset:25600
    buffer_load_dwordx4 v4, s[8:11], s29 offen sc1 lds
    v_mfma_f32_16x16x32_bf16 v[76:79], v[28:31], v[252:255], v[76:79]
    s_waitcnt lgkmcnt(3)
    v_mul_f32 v11, v35, v11
    v_mul_f32 v40, v32, v40
    s_add_u32 s86, s86, 8192
    s_sub_u32 s29, s86, 73728
    s_cselect_b32 s86, s86, s29
    v_mfma_f32_16x16x16_bf16 v[64:67], v[16:17], v[12:13], v[64:67]
    s_add_u32 m0, s32, 122880
    v_exp_f32 v8, v8
    s_add_u32 s24, s60, s86
    ds_read_b64_tr_b16 v[28:29], v3 offset:28672
    v_mfma_f32_16x16x16_bf16 v[68:71], v[16:17], v[14:15], v[68:71]
    s_waitcnt lgkmcnt(3)
    v_exp_f32 v9, v9
    ds_read_b64_tr_b16 v[30:31], v3 offset:29696
    v_mfma_f32_16x16x16_bf16 v[72:75], v[20:21], v[12:13], v[72:75]
    ds_read_b64_tr_b16 v[16:17], v3 offset:32768
    ds_read_b64_tr_b16 v[18:19], v3 offset:33792
    buffer_load_dwordx4 v4, s[8:11], s24 offen sc1 lds
    v_mfma_f32_16x16x16_bf16 v[76:79], v[20:21], v[14:15], v[76:79]
    s_waitcnt lgkmcnt(4)
    v_exp_f32 v10, v10
    s_add_u32 s86, s86, 8192
    s_sub_u32 s24, s86, 73728
    s_cselect_b32 s86, s86, s24
    v_mfma_f32_16x16x32_bf16 v[80:83], v[24:27], v[232:235], v[80:83]
    s_add_u32 m0, s32, 131072
    s_waitcnt vmcnt(8)
    v_add_f32 v100, v100, v101
    s_waitcnt vmcnt(6)
    v_add_f32 v102, v102, v103
    s_add_u32 s25, s60, s86
    ds_read_b64_tr_b16 v[20:21], v3 offset:36864
    v_mfma_f32_16x16x32_bf16 v[84:87], v[24:27], v[236:239], v[84:87]
    s_waitcnt lgkmcnt(3)
    s_waitcnt vmcnt(5)
    v_add_f32 v100, v100, v98
    v_add_f32 v100, v100, v102
    ds_read_b64_tr_b16 v[22:23], v3 offset:37888
    v_mfma_f32_16x16x32_bf16 v[88:91], v[28:31], v[232:235], v[88:91]
    ds_read_b64_tr_b16 v[24:25], v3 offset:40960
    ds_read_b64_tr_b16 v[26:27], v3 offset:41984
    buffer_load_dwordx4 v4, s[8:11], s25 offen sc1 lds
    v_mfma_f32_16x16x32_bf16 v[92:95], v[28:31], v[236:239], v[92:95]
    s_waitcnt lgkmcnt(4)
    v_mov_b32 v101, v100
    s_add_u32 s86, s86, 8192
    s_sub_u32 s25, s86, 73728
    s_cselect_b32 s86, s86, s25
    v_mfma_f32_16x16x32_bf16 v[80:83], v[16:19], v[240:243], v[80:83]
    s_add_u32 m0, s32, 49152
    v_permlane32_swap_b32 v100, v101
    v_add_f32 v100, v100, v101
    s_add_u32 s26, s67, 0
    ds_read_b64_tr_b16 v[28:29], v3 offset:45056
    v_mfma_f32_16x16x32_bf16 v[84:87], v[16:19], v[244:247], v[84:87]
    s_waitcnt lgkmcnt(3)
    v_cvt_pk_bf16_f32 v96, v100, v100
    v_and_b32 v96, 0xffff0000, v96
    ds_read_b64_tr_b16 v[30:31], v3 offset:46080
    v_mfma_f32_16x16x32_bf16 v[88:91], v[20:23], v[240:243], v[88:91]
    ds_read_b64 v[16:17], v5 offset:61184
    buffer_load_dwordx4 v105, s[12:15], s26 offen nt lds
    v_mfma_f32_16x16x32_bf16 v[92:95], v[20:23], v[244:247], v[92:95]
    s_barrier
    s_waitcnt lgkmcnt(3)
    v_mfma_f32_16x16x32_bf16 v[80:83], v[24:27], v[248:251], v[80:83]
    s_add_u32 m0, s32, 57344
    v_add_u32 v5, 0x0, v5
    v_sub_f32 v96, v100, v96
    s_add_u32 s27, s67, 128
    ds_read_b64 v[20:21], v5 offset:65280
    v_mfma_f32_16x16x32_bf16 v[84:87], v[24:27], v[252:255], v[84:87]
    buffer_load_dwordx4 v105, s[12:15], s27 offen nt lds
    s_waitcnt lgkmcnt(2)
    v_mfma_f32_16x16x32_bf16 v[88:91], v[28:31], v[248:251], v[88:91]
    s_add_u32 m0, s32, 65536
    v_mov_b32 v5, v4
    v_add_u32 v5, 0x12000, v5
    s_add_u32 s28, s67, 256
    ds_read_b128 v[24:27], v5 offset:0
    v_mfma_f32_16x16x32_bf16 v[92:95], v[28:31], v[252:255], v[92:95]
    buffer_load_dwordx4 v105, s[12:15], s28 offen nt lds
    s_waitcnt lgkmcnt(2)
    v_mfma_f32_16x16x16_bf16 v[80:83], v[16:17], v[12:13], v[80:83]
    v_cvt_pk_bf16_f32 v96, v100, v96
    v_mov_b32 v97, 0
    ds_read_b128 v[28:31], v5 offset:1024
    v_mfma_f32_16x16x16_bf16 v[84:87], v[16:17], v[14:15], v[84:87]
    v_bfe_u32 v98, v4, 1, 8
    s_add_u32 s72, s32, 155648
    s_nop 0
    s_waitcnt lgkmcnt(2)
    v_mfma_f32_16x16x16_bf16 v[88:91], v[20:21], v[12:13], v[88:91]
    v_add_u32 v98, s72, v98
    ds_read_b128 v[16:19], v5 offset:2048
    ds_write_b64 v98, v[96:97]
    s_waitcnt vmcnt(8)
    v_mfma_f32_16x16x16_bf16 v[92:95], v[20:21], v[14:15], v[92:95]
    s_barrier
    s_waitcnt lgkmcnt(3)
    v_mfma_f32_16x16x32_bf16 v[96:99], v[24:27], v[112:115], 0
    s_add_u32 s77, s75, 0
    v_bfe_u32 v6, v4, 6, 2
    v_lshrrev_b32 v3, 8, v4
    s_mul_i32 s78, s77, 7282
    s_lshr_b32 s78, s78, 16
    ds_read_b128 v[20:23], v5 offset:3072
    v_mfma_f32_16x16x32_bf16 v[100:103], v[24:27], v[116:119], 0
    s_waitcnt lgkmcnt(3)
    v_lshl_add_u32 v6, v3, 3, v6
    s_mul_i32 s79, s78, 9
    s_sub_u32 s79, s77, s79
    s_and_b32 s72, s39, 1
    s_lshl_b32 s72, s72, 2
    s_and_b32 s71, s39, 2
    s_lshl_b32 s71, s71, 4
    s_add_u32 s72, s72, s71
    v_mfma_f32_16x16x32_bf16 v[104:107], v[28:31], v[112:115], 0
    s_lshr_b32 s77, s79, 1
    v_add_u32 v6, s72, v6
    v_mul_u32_u24 v6, 9216, v6
    s_sub_u32 s77, s77, s2
    s_and_b32 s77, s77, 3
    ds_read_b128 v[24:27], v5 offset:4096
    v_mfma_f32_16x16x32_bf16 v[108:111], v[28:31], v[116:119], 0
    s_waitcnt lgkmcnt(3)
    v_lshlrev_b32 v3, 5, v3
    v_xor_b32 v3, v3, v4
    s_lshl_b32 s77, s77, 1
    s_and_b32 s42, s79, 1
    v_mfma_f32_16x16x32_bf16 v[96:99], v[16:19], v[120:123], v[96:99]
    s_add_u32 s77, s77, s42
    v_and_b32 v3, 0x30, v3
    s_cmp_eq_u32 s79, 8
    s_cselect_b32 s77, 8, s77
    ds_read_b128 v[28:31], v5 offset:5120
    s_and_b32 s72, s85, 7
    s_cmp_eq_u32 s72, 2
    s_cselect_b32 s72, 1, 32
    s_add_u32 s72, s72, s85
    s_lshl_b32 s72, s72, 7
    v_mfma_f32_16x16x32_bf16 v[100:103], v[16:19], v[124:127], v[100:103]
    s_waitcnt lgkmcnt(2)
    v_add3_u32 v6, v6, v3, s72
    v_mul_f32 v41, v33, v41
    s_mul_i32 s79, s73, 7
    s_add_u32 s79, s79, s77
    v_mfma_f32_16x16x32_bf16 v[104:107], v[20:23], v[120:123], v[104:107]
    s_sub_u32 s79, s79, 2
    v_exp_f32 v11, v11
    ds_read_b128 v[16:19], v5 offset:6144
    v_mfma_f32_16x16x32_bf16 v[108:111], v[20:23], v[124:127], v[108:111]
    s_waitcnt lgkmcnt(2)
    v_mul_f32 v42, v34, v42
    v_mul_f32 v43, v35, v43
    s_cmp_eq_u32 s73, 20
    s_cselect_b32 s42, 1, 20
    s_cselect_b32 s43, 20, 0
    v_mfma_f32_16x16x32_bf16 v[96:99], v[24:27], v[128:131], v[96:99]
    s_mul_i32 s42, s42, s77
    v_add_f32 v8, 1.0, v8
    v_add_f32 v9, 1.0, v9
    s_add_u32 s42, s42, s73
    s_add_u32 s42, s42, s43
    ds_read_b128 v[20:23], v5 offset:7168
    v_mfma_f32_16x16x32_bf16 v[100:103], v[24:27], v[132:135], v[100:103]
    v_add_f32 v10, 1.0, v10
    v_add_f32 v11, 1.0, v11
    s_add_u32 s42, s42, 148
    s_waitcnt lgkmcnt(2)
    v_mfma_f32_16x16x32_bf16 v[104:107], v[28:31], v[128:131], v[104:107]
    v_rcp_f32 v8, v8
    s_cmp_ge_u32 s77, 2
    s_cselect_b32 s79, s79, s42
    s_and_b32 s42, s2, 3
    ds_read_b128 v[24:27], v5 offset:8192
    v_mfma_f32_16x16x32_bf16 v[108:111], v[28:31], v[132:135], v[108:111]
    s_waitcnt lgkmcnt(2)
    v_rcp_f32 v9, v9
    s_lshl_b32 s42, s42, 2
    s_add_u32 s42, s42, s78
    v_mfma_f32_16x16x32_bf16 v[96:99], v[16:19], v[136:139], v[96:99]
    s_lshl_b32 s42, s42, 1
    v_rcp_f32 v10, v10
    s_add_u32 s42, s42, s76
    s_mul_i32 s42, s42, 192
    ds_read_b128 v[28:31], v5 offset:9216
    v_mfma_f32_16x16x32_bf16 v[100:103], v[16:19], v[140:143], v[100:103]
    s_waitcnt lgkmcnt(2)
    v_rcp_f32 v11, v11
    s_add_u32 s42, s42, s79
    s_lshl_b32 s42, s42, 10
    v_mfma_f32_16x16x32_bf16 v[104:107], v[20:23], v[136:139], v[104:107]
    s_add_u32 s42, s42, 36700160
    v_mul_f32 v40, v40, v8
    v_mul_f32 v41, v41, v9
    s_cmp_lt_u32 s74, 41
    s_cselect_b32 s80, s42, s38
    ds_read_b128 v[16:19], v5 offset:10240
    v_mfma_f32_16x16x32_bf16 v[108:111], v[20:23], v[140:143], v[108:111]
    s_waitcnt lgkmcnt(2)
    v_mul_f32 v42, v42, v10
    v_mul_f32 v43, v43, v11
    s_add_u32 s77, s75, 4
    s_mul_i32 s78, s77, 7282
    v_mfma_f32_16x16x32_bf16 v[96:99], v[24:27], v[144:147], v[96:99]
    s_lshr_b32 s78, s78, 16
    v_cvt_pk_bf16_f32 v32, v40, v41
    v_cvt_pk_bf16_f32 v33, v42, v43
    s_mul_i32 s79, s78, 9
    s_sub_u32 s79, s77, s79
    ds_read_b128 v[20:23], v5 offset:11264
    v_mfma_f32_16x16x32_bf16 v[100:103], v[24:27], v[148:151], v[100:103]
    s_waitcnt lgkmcnt(2)
    v_mul_f32 v8, v36, v36
    v_mul_f32 v9, v37, v37
    s_lshr_b32 s77, s79, 1
    s_sub_u32 s77, s77, s2
    v_mfma_f32_16x16x32_bf16 v[104:107], v[28:31], v[144:147], v[104:107]
    s_and_b32 s77, s77, 3
    v_mul_f32 v10, v38, v38
    v_mul_f32 v11, v39, v39
    s_lshl_b32 s77, s77, 1
    s_and_b32 s42, s79, 1
    ds_read_b128 v[24:27], v5 offset:12288
    v_mfma_f32_16x16x32_bf16 v[108:111], v[28:31], v[148:151], v[108:111]
    v_fma_f32 v8, v8, v7, v15
    v_fma_f32 v9, v9, v7, v15
    s_add_u32 s77, s77, s42
    s_waitcnt lgkmcnt(2)
    v_mfma_f32_16x16x32_bf16 v[96:99], v[16:19], v[152:155], v[96:99]
    v_fma_f32 v10, v10, v7, v15
    v_fma_f32 v11, v11, v7, v15
    s_cmp_eq_u32 s79, 8
    s_cselect_b32 s77, 8, s77
    s_mul_i32 s79, s73, 7
    ds_read_b128 v[28:31], v5 offset:13312
    v_mfma_f32_16x16x32_bf16 v[100:103], v[16:19], v[156:159], v[100:103]
    s_waitcnt lgkmcnt(2)
    v_mul_f32 v8, v36, v8
    v_mul_f32 v9, v37, v9
    s_add_u32 s79, s79, s77
    s_sub_u32 s79, s79, 2
    v_mfma_f32_16x16x32_bf16 v[104:107], v[20:23], v[152:155], v[104:107]
    v_mul_f32 v10, v38, v10
    v_mul_f32 v11, v39, v11
    s_cmp_eq_u32 s73, 20
    s_cselect_b32 s42, 1, 20
    s_cselect_b32 s43, 20, 0
    ds_read_b128 v[16:19], v5 offset:14336
    v_mfma_f32_16x16x32_bf16 v[108:111], v[20:23], v[156:159], v[108:111]
    s_waitcnt lgkmcnt(2)
    v_exp_f32 v8, v8
    s_mul_i32 s42, s42, s77
    s_add_u32 s42, s42, s73
    v_mfma_f32_16x16x32_bf16 v[96:99], v[24:27], v[160:163], v[96:99]
    s_add_u32 s42, s42, s43
    v_exp_f32 v9, v9
    s_add_u32 s42, s42, 148
    ds_read_b128 v[20:23], v5 offset:15360
    v_mfma_f32_16x16x32_bf16 v[100:103], v[24:27], v[164:167], v[100:103]
    s_waitcnt lgkmcnt(2)
    v_exp_f32 v10, v10
    s_cmp_ge_u32 s77, 2
    s_cselect_b32 s79, s79, s42
    v_mfma_f32_16x16x32_bf16 v[104:107], v[28:31], v[160:163], v[104:107]
    s_and_b32 s42, s2, 3
    v_exp_f32 v11, v11
    s_lshl_b32 s42, s42, 2
    s_add_u32 s42, s42, s78
    ds_read_b128 v[24:27], v5 offset:16384
    v_mfma_f32_16x16x32_bf16 v[108:111], v[28:31], v[164:167], v[108:111]
    s_waitcnt lgkmcnt(2)
    v_mul_f32 v44, v36, v44
    v_mul_f32 v45, v37, v45
    s_lshl_b32 s42, s42, 1
    s_add_u32 s42, s42, s76
    v_mfma_f32_16x16x32_bf16 v[96:99], v[16:19], v[168:171], v[96:99]
    s_mul_i32 s42, s42, 192
    v_mul_f32 v46, v38, v46
    v_mul_f32 v47, v39, v47
    s_add_u32 s42, s42, s79
    s_lshl_b32 s42, s42, 10
    ds_read_b128 v[28:31], v5 offset:17408
    v_mfma_f32_16x16x32_bf16 v[100:103], v[16:19], v[172:175], v[100:103]
    v_add_f32 v8, 1.0, v8
    v_add_f32 v9, 1.0, v9
    s_add_u32 s42, s42, 36700160
    s_waitcnt lgkmcnt(2)
    v_mfma_f32_16x16x32_bf16 v[104:107], v[20:23], v[168:171], v[104:107]
    v_add_f32 v10, 1.0, v10
    v_add_f32 v11, 1.0, v11
    s_cmp_lt_u32 s74, 41
    s_cselect_b32 s81, s42, s38
    s_add_u32 s77, s75, 8
    ds_read_b128 v[16:19], v5 offset:18432
    v_mfma_f32_16x16x32_bf16 v[108:111], v[20:23], v[172:175], v[108:111]
    s_waitcnt lgkmcnt(2)
    v_rcp_f32 v8, v8
    s_mul_i32 s78, s77, 7282
    s_lshr_b32 s78, s78, 16
    v_mfma_f32_16x16x32_bf16 v[96:99], v[24:27], v[176:179], v[96:99]
    s_mul_i32 s79, s78, 9
    v_rcp_f32 v9, v9
    s_sub_u32 s79, s77, s79
    s_lshr_b32 s77, s79, 1
    ds_read_b128 v[20:23], v5 offset:19456
    v_mfma_f32_16x16x32_bf16 v[100:103], v[24:27], v[180:183], v[100:103]
    s_waitcnt lgkmcnt(2)
    v_rcp_f32 v10, v10
    s_sub_u32 s77, s77, s2
    s_and_b32 s77, s77, 3
    v_mfma_f32_16x16x32_bf16 v[104:107], v[28:31], v[176:179], v[104:107]
    s_lshl_b32 s77, s77, 1
    v_rcp_f32 v11, v11
    s_and_b32 s42, s79, 1
    s_add_u32 s77, s77, s42
    ds_read_b128 v[24:27], v5 offset:20480
    s_waitcnt vmcnt(5)
    v_mfma_f32_16x16x32_bf16 v[108:111], v[28:31], v[180:183], v[108:111]
    s_barrier
    s_waitcnt lgkmcnt(2)
    v_mfma_f32_16x16x32_bf16 v[96:99], v[16:19], v[184:187], v[96:99]
    s_add_u32 m0, s32, 139264
    v_mul_f32 v44, v44, v8
    v_mul_f32 v45, v45, v9
    s_add_u32 s29, s60, s86
    ds_read_b128 v[28:31], v5 offset:21504
    v_mfma_f32_16x16x32_bf16 v[100:103], v[16:19], v[188:191], v[100:103]
    buffer_load_dwordx4 v4, s[8:11], s29 offen sc1 lds
    s_waitcnt lgkmcnt(2)
    v_mfma_f32_16x16x32_bf16 v[104:107], v[20:23], v[184:187], v[104:107]
    v_mul_f32 v46, v46, v10
    v_mul_f32 v47, v47, v11
    s_add_u32 s86, s86, 8192
    s_sub_u32 s29, s86, 73728
    s_cselect_b32 s86, s86, s29
    ds_read_b128 v[16:19], v5 offset:22528
    v_mfma_f32_16x16x32_bf16 v[108:111], v[20:23], v[188:191], v[108:111]
    s_waitcnt lgkmcnt(2)
    v_cvt_pk_bf16_f32 v36, v44, v45
    v_cvt_pk_bf16_f32 v37, v46, v47
    s_add_u32 m0, s32, 147456
    s_add_u32 s24, s60, s86
    v_mfma_f32_16x16x32_bf16 v[96:99], v[24:27], v[192:195], v[96:99]
    v_mul_f32 v8, v48, v48
    v_mul_f32 v9, v49, v49
    s_cmp_eq_u32 s79, 8
    s_cselect_b32 s77, 8, s77
    s_mul_i32 s79, s73, 7
    ds_read_b128 v[20:23], v5 offset:23552
    v_mfma_f32_16x16x32_bf16 v[100:103], v[24:27], v[196:199], v[100:103]
    buffer_load_dwordx4 v4, s[8:11], s24 offen sc1 lds
    s_waitcnt lgkmcnt(2)
    v_mfma_f32_16x16x32_bf16 v[104:107], v[28:31], v[192:195], v[104:107]
    v_mul_f32 v10, v50, v50
    v_mul_f32 v11, v51, v51
    s_add_u32 s86, s86, 8192
    s_sub_u32 s24, s86, 73728
    s_cselect_b32 s86, s86, s24
    ds_read_b128 v[24:27], v5 offset:24576
    v_mfma_f32_16x16x32_bf16 v[108:111], v[28:31], v[196:199], v[108:111]
    s_waitcnt lgkmcnt(2)
    v_fma_f32 v8, v8, v0, v13
    v_fma_f32 v9, v9, v0, v13
    s_add_u32 m0, s32, 0
    s_add_u32 s25, s60, s86
    v_mfma_f32_16x16x32_bf16 v[96:99], v[16:19], v[200:203], v[96:99]
    s_add_u32 s79, s79, s77
    v_fma_f32 v10, v10, v0, v13
    v_fma_f32 v11, v11, v0, v13
    s_sub_u32 s79, s79, 2
    ds_read_b128 v[28:31], v5 offset:25600
    v_mfma_f32_16x16x32_bf16 v[100:103], v[16:19], v[204:207], v[100:103]
    buffer_load_dwordx4 v4, s[8:11], s25 offen sc1 lds
    s_waitcnt lgkmcnt(2)
    v_mfma_f32_16x16x32_bf16 v[104:107], v[20:23], v[200:203], v[104:107]
    v_mul_f32 v8, v48, v8
    v_mul_f32 v9, v49, v9
    s_add_u32 s86, s86, 8192
    s_sub_u32 s25, s86, 73728
    s_cselect_b32 s86, s86, s25
    ds_read_b128 v[16:19], v5 offset:26624
    v_mfma_f32_16x16x32_bf16 v[108:111], v[20:23], v[204:207], v[108:111]
    s_waitcnt lgkmcnt(2)
    v_mul_f32 v10, v50, v10
    v_mul_f32 v11, v51, v11
    s_add_u32 m0, s32, 8192
    s_add_u32 s26, s60, s86
    v_mfma_f32_16x16x32_bf16 v[96:99], v[24:27], v[208:211], v[96:99]
    v_exp_f32 v8, v8
    s_cmp_eq_u32 s73, 20
    s_cselect_b32 s42, 1, 20
    s_cselect_b32 s43, 20, 0
    ds_read_b128 v[20:23], v5 offset:27648
    v_mfma_f32_16x16x32_bf16 v[100:103], v[24:27], v[212:215], v[100:103]
    buffer_load_dwordx4 v4, s[8:11], s26 offen sc1 lds
    s_waitcnt lgkmcnt(2)
    v_mfma_f32_16x16x32_bf16 v[104:107], v[28:31], v[208:211], v[104:107]
    v_exp_f32 v9, v9
    s_add_u32 s86, s86, 8192
    s_sub_u32 s26, s86, 73728
    s_cselect_b32 s86, s86, s26
    ds_read_b128 v[24:27], v5 offset:28672
    v_mfma_f32_16x16x32_bf16 v[108:111], v[28:31], v[212:215], v[108:111]
    s_waitcnt lgkmcnt(2)
    v_exp_f32 v10, v10
    s_add_u32 m0, s32, 16384
    s_add_u32 s27, s60, s86
    v_mfma_f32_16x16x32_bf16 v[96:99], v[16:19], v[216:219], v[96:99]
    s_mul_i32 s42, s42, s77
    v_exp_f32 v11, v11
    s_add_u32 s42, s42, s73
    s_add_u32 s42, s42, s43
    ds_read_b128 v[28:31], v5 offset:29696
    v_mfma_f32_16x16x32_bf16 v[100:103], v[16:19], v[220:223], v[100:103]
    buffer_load_dwordx4 v4, s[8:11], s27 offen sc1 lds
    s_waitcnt lgkmcnt(2)
    v_mfma_f32_16x16x32_bf16 v[104:107], v[20:23], v[216:219], v[104:107]
    v_mul_f32 v56, v48, v56
    v_mul_f32 v57, v49, v57
    s_add_u32 s86, s86, 8192
    s_sub_u32 s27, s86, 73728
    s_cselect_b32 s86, s86, s27
    ds_read_b128 v[16:19], v5 offset:30720
    v_mfma_f32_16x16x32_bf16 v[108:111], v[20:23], v[220:223], v[108:111]
    s_waitcnt lgkmcnt(2)
    v_mul_f32 v58, v50, v58
    v_mul_f32 v59, v51, v59
    s_add_u32 m0, s32, 24576
    s_add_u32 s28, s60, s86
    v_mfma_f32_16x16x32_bf16 v[96:99], v[24:27], v[224:227], v[96:99]
    s_add_u32 s42, s42, 148
    v_add_f32 v8, 1.0, v8
    v_add_f32 v9, 1.0, v9
    s_cmp_ge_u32 s77, 2
    s_cselect_b32 s79, s79, s42
    ds_read_b128 v[20:23], v5 offset:31744
    v_mfma_f32_16x16x32_bf16 v[100:103], v[24:27], v[228:231], v[100:103]
    buffer_load_dwordx4 v4, s[8:11], s28 offen sc1 lds
    s_waitcnt lgkmcnt(2)
    v_mfma_f32_16x16x32_bf16 v[104:107], v[28:31], v[224:227], v[104:107]
    v_add_f32 v10, 1.0, v10
    v_add_f32 v11, 1.0, v11
    s_add_u32 s86, s86, 8192
    s_sub_u32 s28, s86, 73728
    s_cselect_b32 s86, s86, s28
    ds_read_b128 v[24:27], v5 offset:32768
    v_mfma_f32_16x16x32_bf16 v[108:111], v[28:31], v[228:231], v[108:111]
    s_waitcnt lgkmcnt(2)
    v_rcp_f32 v8, v8
    s_and_b32 s42, s2, 3
    s_lshl_b32 s42, s42, 2
    v_mfma_f32_16x16x32_bf16 v[96:99], v[16:19], v[232:235], v[96:99]
    s_add_u32 s42, s42, s78
    v_rcp_f32 v9, v9
    s_lshl_b32 s42, s42, 1
    s_add_u32 s42, s42, s76
    ds_read_b128 v[28:31], v5 offset:33792
    v_mfma_f32_16x16x32_bf16 v[100:103], v[16:19], v[236:239], v[100:103]
    s_waitcnt lgkmcnt(2)
    v_rcp_f32 v10, v10
    s_mul_i32 s42, s42, 192
    s_add_u32 s42, s42, s79
    v_mfma_f32_16x16x32_bf16 v[104:107], v[20:23], v[232:235], v[104:107]
    s_lshl_b32 s42, s42, 10
    v_rcp_f32 v11, v11
    s_add_u32 s42, s42, 36700160
    ds_read_b128 v[16:19], v5 offset:34816
    v_mfma_f32_16x16x32_bf16 v[108:111], v[20:23], v[236:239], v[108:111]
    s_waitcnt lgkmcnt(2)
    v_mul_f32 v56, v56, v8
    v_mul_f32 v57, v57, v9
    s_cmp_lt_u32 s74, 41
    s_cselect_b32 s82, s42, s38
    v_mfma_f32_16x16x32_bf16 v[96:99], v[24:27], v[240:243], v[96:99]
    s_mov_b32 s42, 0
    v_mul_f32 v58, v58, v10
    v_mul_f32 v59, v59, v11
    s_mov_b32 s43, 0x0000ffff
    s_lshl_b32 s73, s2, 3
    ds_read_b128 v[20:23], v5 offset:35840
    v_mfma_f32_16x16x32_bf16 v[100:103], v[24:27], v[244:247], v[100:103]
    s_waitcnt lgkmcnt(2)
    v_cvt_pk_bf16_f32 v34, v56, v57
    v_cvt_pk_bf16_f32 v35, v58, v59
    s_add_u32 s73, s73, s39
    s_mul_i32 s73, s73, 3072
    v_mfma_f32_16x16x32_bf16 v[104:107], v[28:31], v[240:243], v[104:107]
    s_add_u32 s30, s33, 0
    ds_read_b128 v[24:27], v5 offset:40960
    buffer_store_dwordx4 v[32:35], v4, s[8:11], s30 offen offset:0 sc1
    v_mfma_f32_16x16x32_bf16 v[108:111], v[28:31], v[244:247], v[108:111]
    s_waitcnt lgkmcnt(2)
    v_mul_f32 v8, v52, v52
    v_mul_f32 v9, v53, v53
    s_add_u32 s49, s73, 28311552
    s_lshr_b32 s73, s2, 2
    v_mfma_f32_16x16x32_bf16 v[96:99], v[16:19], v[248:251], v[96:99]
    s_lshl_b32 s73, s73, 3
    v_mul_f32 v10, v54, v54
    v_mul_f32 v11, v55, v55
    s_add_u32 s73, s73, s39
    s_lshl_b32 s73, s73, 11
    ds_read_b128 v[28:31], v5 offset:41984
    v_mfma_f32_16x16x32_bf16 v[100:103], v[16:19], v[252:255], v[100:103]
    s_waitcnt lgkmcnt(2)
    v_fma_f32 v8, v8, v7, v15
    v_fma_f32 v9, v9, v7, v15
    s_add_u32 s73, s73, 35651584
    s_xor_b32 s74, s2, s39
    v_mfma_f32_16x16x32_bf16 v[104:107], v[20:23], v[248:251], v[104:107]
    s_and_b32 s74, s74, 3
    v_fma_f32 v10, v10, v7, v15
    v_fma_f32 v11, v11, v7, v15
    s_cmp_eq_u32 s74, 0
    s_cselect_b32 s50, s73, s38
    ds_read_b128 v[16:19], v5 offset:43008
    v_mul_f32 v8, v52, v8
    v_mul_f32 v9, v53, v9
    v_mul_f32 v10, v54, v10
    v_mul_f32 v11, v55, v11
    v_exp_f32 v8, v8
    v_exp_f32 v9, v9
    v_exp_f32 v10, v10
    v_exp_f32 v11, v11
    v_mul_f32 v60, v52, v60
    v_mul_f32 v61, v53, v61
    v_mul_f32 v62, v54, v62
    v_mul_f32 v63, v55, v63
    v_add_f32 v8, 1.0, v8
    v_add_f32 v9, 1.0, v9
    v_add_f32 v10, 1.0, v10
    v_add_f32 v11, 1.0, v11
    v_rcp_f32 v8, v8
    v_rcp_f32 v9, v9
    v_rcp_f32 v10, v10
    v_rcp_f32 v11, v11
    v_mul_f32 v60, v60, v8
    v_mul_f32 v61, v61, v9
    v_mul_f32 v62, v62, v10
    v_mul_f32 v63, v63, v11
    v_cvt_pk_bf16_f32 v38, v60, v61
    v_cvt_pk_bf16_f32 v39, v62, v63
    s_add_u32 s31, s33, 163840
    buffer_store_dwordx4 v[36:39], v4, s[8:11], s31 offen offset:0 sc1
    v_mul_f32 v8, v64, v64
    s_waitcnt vmcnt(11)
    v_mfma_f32_16x16x32_bf16 v[108:111], v[20:23], v[252:255], v[108:111]
    s_barrier
    s_waitcnt lgkmcnt(2)
    v_mfma_f32_16x16x32_bf16 v[32:35], v[24:27], v[112:115], 0
    s_lshl_b32 s73, s84, 4
    v_mul_f32 v9, v65, v65
    v_mul_f32 v10, v66, v66
    s_add_u32 m0, s32, 73728
    s_add_u32 s29, s87, 0
    ds_read_b128 v[20:23], v5 offset:44032
    v_mfma_f32_16x16x32_bf16 v[36:39], v[24:27], v[116:119], 0
    buffer_load_dwordx4 v6, s[4:7], s29 offen  lds
    s_waitcnt lgkmcnt(2)
    v_mfma_f32_16x16x32_bf16 v[40:43], v[112:115], v[28:31], 0
    s_lshl_b32 s74, s39, 1
    v_bfe_u32 v5, v4, 1, 8
    v_add_u32 v5, 0x18000, v5
    s_add_u32 m0, s32, 81920
    s_add_u32 s24, s87, 64
    ds_read_b64 v[24:25], v5 offset:57344
    v_mfma_f32_16x16x32_bf16 v[44:47], v[116:119], v[28:31], 0
    buffer_load_dwordx4 v6, s[4:7], s24 offen  lds
    s_waitcnt lgkmcnt(2)
    v_mfma_f32_16x16x32_bf16 v[48:51], v[112:115], v[16:19], 0
    s_add_u32 s73, s73, s74
    v_mul_f32 v11, v67, v67
    v_fma_f32 v8, v8, v0, v13
    s_lshl_b32 s48, s73, 11
    s_lshl_b32 s74, s85, 7
    ds_read_b64 v[28:29], v5 offset:58368
    v_mfma_f32_16x16x32_bf16 v[52:55], v[116:119], v[16:19], 0
    s_waitcnt lgkmcnt(2)
    v_fma_f32 v9, v9, v0, v13
    v_fma_f32 v10, v10, v0, v13
    s_add_u32 s48, s48, s74
    s_add_u32 s48, s48, 27262976
    v_mfma_f32_16x16x32_bf16 v[56:59], v[112:115], v[20:23], 0
    s_lshl_b32 s37, s39, 8
    v_mov_b32 v5, v4
    v_add_u32 v5, 0x18000, v5
    s_lshl_b32 s73, s85, 3
    s_add_u32 s74, s73, s84
    ds_read_b128 v[16:19], v5 offset:20480
    v_mfma_f32_16x16x32_bf16 v[60:63], v[116:119], v[20:23], 0
    s_waitcnt lgkmcnt(2)
    v_fma_f32 v11, v11, v0, v13
    v_mul_f32 v8, v64, v8
    s_mul_i32 s74, s74, 1536
    s_lshl_b32 s75, s39, 8
    v_mfma_f32_16x16x16_bf16 v[96:99], v[24:25], v[12:13], v[96:99]
    s_add_u32 s75, s75, 27525120
    v_mul_f32 v9, v65, v9
    v_mul_f32 v10, v66, v10
    s_add_u32 s74, s74, s75
    s_mul_i32 s73, s73, 1536
    ds_read_b128 v[20:23], v5 offset:21504
    v_mfma_f32_16x16x16_bf16 v[100:103], v[24:25], v[14:15], v[100:103]
    v_mul_f32 v11, v67, v11
    v_mul_f32 v72, v64, v72
    s_add_u32 s73, s73, s75
    s_waitcnt lgkmcnt(2)
    v_mfma_f32_16x16x16_bf16 v[104:107], v[28:29], v[12:13], v[104:107]
    v_exp_f32 v8, v8
    s_cmp_lt_u32 s39, 6
    s_cselect_b32 s46, s74, s38
    s_cselect_b32 s47, s73, s38
    ds_read_b128 v[24:27], v5 offset:22528
    v_mfma_f32_16x16x16_bf16 v[108:111], v[28:29], v[14:15], v[108:111]
    s_waitcnt lgkmcnt(2)
    v_exp_f32 v9, v9
    s_add_u32 s73, s37, 32768
    s_add_u32 s74, s37, 154624
    v_mfma_f32_16x16x32_bf16 v[32:35], v[16:19], v[120:123], v[32:35]
    v_exp_f32 v10, v10
    s_cmp_lt_u32 s39, 4
    s_cselect_b32 s3, s73, s74
    s_lshl_b32 s73, s84, 2
    ds_read_b128 v[28:31], v5 offset:23552
    v_mfma_f32_16x16x32_bf16 v[36:39], v[16:19], v[124:127], v[36:39]
    s_waitcnt lgkmcnt(2)
    v_exp_f32 v11, v11
    s_lshr_b32 s74, s85, 3
    s_add_u32 s73, s73, s74
    v_mfma_f32_16x16x32_bf16 v[40:43], v[120:123], v[20:23], v[40:43]
    s_lshl_b32 s73, s73, 13
    v_mul_f32 v73, v65, v73
    v_mul_f32 v74, v66, v74
    s_add_u32 s73, s73, 45088768
    s_add_u32 s52, s73, s32
    ds_read_b128 v[16:19], v5 offset:24576
    v_mfma_f32_16x16x32_bf16 v[44:47], v[124:127], v[20:23], v[44:47]
    s_waitcnt lgkmcnt(2)
    v_mul_f32 v75, v67, v75
    v_add_f32 v8, 1.0, v8
    s_and_b32 s74, s85, 7
    s_lshl_b32 s74, s74, 7
    v_mfma_f32_16x16x32_bf16 v[48:51], v[120:123], v[24:27], v[48:51]
    s_add_u32 s52, s52, s74
    v_add_f32 v9, 1.0, v9
    v_add_f32 v10, 1.0, v10
    s_and_b32 s73, s2, 4
    s_lshr_b32 s74, s2, 6
    ds_read_b128 v[20:23], v5 offset:25600
    v_mfma_f32_16x16x32_bf16 v[52:55], v[124:127], v[24:27], v[52:55]
    v_add_f32 v11, 1.0, v11
    s_add_u32 s73, s73, s74
    s_lshl_b32 s73, s73, 2
    s_waitcnt lgkmcnt(2)
    v_mfma_f32_16x16x32_bf16 v[56:59], v[120:123], v[28:31], v[56:59]
    s_and_b32 s74, s2, 3
    v_rcp_f32 v8, v8
    s_add_u32 m0, s32, 90112
    s_add_u32 s25, s87, 589824
    ds_read_b128 v[24:27], v5 offset:26624
    v_mfma_f32_16x16x32_bf16 v[60:63], v[124:127], v[28:31], v[60:63]
    buffer_load_dwordx4 v6, s[4:7], s25 offen  lds
    s_waitcnt lgkmcnt(2)
    v_mfma_f32_16x16x32_bf16 v[32:35], v[16:19], v[128:131], v[32:35]
    s_add_u32 s73, s73, s74
    v_rcp_f32 v9, v9
    s_add_u32 m0, s32, 98304
    s_add_u32 s26, s87, 589888
    ds_read_b128 v[28:31], v5 offset:27648
    v_mfma_f32_16x16x32_bf16 v[36:39], v[16:19], v[132:135], v[36:39]
    buffer_load_dwordx4 v6, s[4:7], s26 offen  lds
    s_waitcnt lgkmcnt(2)
    v_mfma_f32_16x16x32_bf16 v[40:43], v[128:131], v[20:23], v[40:43]
    s_lshl_b32 s73, s73, 13
    v_rcp_f32 v10, v10
    s_add_u32 s73, s73, 45088768
    s_and_b32 s74, s2, 32
    ds_read_b128 v[16:19], v5 offset:28672
    v_mfma_f32_16x16x32_bf16 v[44:47], v[132:135], v[20:23], v[44:47]
    s_waitcnt lgkmcnt(2)
    v_rcp_f32 v11, v11
    s_lshl_b32 s74, s74, 7
    s_add_u32 s73, s73, s74
    v_mfma_f32_16x16x32_bf16 v[48:51], v[128:131], v[24:27], v[48:51]
    s_and_b32 s74, s39, 3
    v_mul_f32 v72, v72, v8
    v_mul_f32 v73, v73, v9
    s_lshl_b32 s74, s74, 10
    s_add_u32 s51, s73, s74
    ds_read_b128 v[20:23], v5 offset:29696
    v_mfma_f32_16x16x32_bf16 v[52:55], v[132:135], v[24:27], v[52:55]
    s_waitcnt lgkmcnt(2)
    v_mul_f32 v74, v74, v10
    v_mul_f32 v75, v75, v11
    s_and_b32 s73, s39, 1
    s_lshl_b32 s73, s73, 5
    v_mfma_f32_16x16x32_bf16 v[56:59], v[128:131], v[28:31], v[56:59]
    s_and_b32 s74, s39, 2
    v_cvt_pk_bf16_f32 v64, v72, v73
    v_cvt_pk_bf16_f32 v65, v74, v75
    s_lshl_b32 s74, s74, 11
    s_or_b32 s73, s73, s74
    ds_read_b128 v[24:27], v5 offset:30720
    v_mfma_f32_16x16x32_bf16 v[60:63], v[132:135], v[28:31], v[60:63]
    s_waitcnt lgkmcnt(2)
    v_mul_f32 v8, v68, v68
    v_mul_f32 v9, v69, v69
    s_and_b32 s74, s39, 4
    s_lshl_b32 s74, s74, 9
    v_mfma_f32_16x16x32_bf16 v[32:35], v[16:19], v[136:139], v[32:35]
    s_or_b32 s34, s73, s74
    v_mul_f32 v10, v70, v70
    v_mul_f32 v11, v71, v71
    s_mul_i32 s73, s39, 86
    s_lshr_b32 s73, s73, 8
    ds_read_b128 v[28:31], v5 offset:31744
    v_mfma_f32_16x16x32_bf16 v[36:39], v[16:19], v[140:143], v[36:39]
    s_waitcnt lgkmcnt(2)
    v_fma_f32 v8, v8, v7, v15
    v_fma_f32 v9, v9, v7, v15
    s_mul_i32 s74, s73, 3
    s_sub_u32 s74, s39, s74
    v_mfma_f32_16x16x32_bf16 v[40:43], v[136:139], v[20:23], v[40:43]
    s_lshl_b32 s74, s74, 9
    v_fma_f32 v10, v10, v7, v15
    v_fma_f32 v11, v11, v7, v15
    s_lshl_b32 s73, s73, 2
    s_and_b32 s75, s2, 3
    ds_read_b128 v[16:19], v5 offset:32768
    v_mfma_f32_16x16x32_bf16 v[44:47], v[140:143], v[20:23], v[44:47]
    s_waitcnt lgkmcnt(2)
    v_mul_f32 v8, v68, v8
    v_mul_f32 v9, v69, v9
    s_add_u32 s73, s73, s75
    s_lshr_b32 s75, s2, 2
    v_mfma_f32_16x16x32_bf16 v[48:51], v[136:139], v[24:27], v[48:51]
    s_lshl_b32 s75, s75, 3
    v_mul_f32 v10, v70, v10
    v_mul_f32 v11, v71, v11
    s_add_u32 s73, s73, s75
    s_lshl_b32 s73, s73, 11
    ds_read_b128 v[20:23], v5 offset:33792
    v_mfma_f32_16x16x32_bf16 v[52:55], v[140:143], v[24:27], v[52:55]
    s_waitcnt lgkmcnt(2)
    v_exp_f32 v8, v8
    s_add_u32 s73, s73, s74
    s_add_u32 s73, s73, 35651584
    v_mfma_f32_16x16x32_bf16 v[56:59], v[136:139], v[28:31], v[56:59]
    v_exp_f32 v9, v9
    s_cmp_lt_u32 s39, 6
    s_cselect_b32 s37, s73, s38
    s_mov_b32 s35, 0x3fb8aa3b
    ds_read_b128 v[24:27], v5 offset:34816
    v_mfma_f32_16x16x32_bf16 v[60:63], v[140:143], v[28:31], v[60:63]
    s_waitcnt lgkmcnt(2)
    v_exp_f32 v10, v10
    s_mov_b32 s36, 0x358637bd
    s_mov_b32 s40, 0x00040004
    v_mfma_f32_16x16x32_bf16 v[32:35], v[16:19], v[144:147], v[32:35]
    s_mov_b32 s41, 0x00040004
    v_exp_f32 v11, v11
    ds_read_b128 v[28:31], v5 offset:35840
    v_mfma_f32_16x16x32_bf16 v[36:39], v[16:19], v[148:151], v[36:39]
    v_mul_f32 v76, v68, v76
    v_mul_f32 v77, v69, v77
    s_nop 0
    s_waitcnt lgkmcnt(2)
    v_mfma_f32_16x16x32_bf16 v[40:43], v[144:147], v[20:23], v[40:43]
    v_mul_f32 v78, v70, v78
    v_mul_f32 v79, v71, v79
    ds_read_b128 v[16:19], v5 offset:36864
    v_mfma_f32_16x16x32_bf16 v[44:47], v[148:151], v[20:23], v[44:47]
    v_add_f32 v8, 1.0, v8
    v_add_f32 v9, 1.0, v9
    s_nop 0
    s_waitcnt lgkmcnt(2)
    v_mfma_f32_16x16x32_bf16 v[48:51], v[144:147], v[24:27], v[48:51]
    v_add_f32 v10, 1.0, v10
    v_add_f32 v11, 1.0, v11
    ds_read_b128 v[20:23], v5 offset:37888
    v_mfma_f32_16x16x32_bf16 v[52:55], v[148:151], v[24:27], v[52:55]
    v_rcp_f32 v8, v8
    s_nop 0
    s_waitcnt lgkmcnt(2)
    v_mfma_f32_16x16x32_bf16 v[56:59], v[144:147], v[28:31], v[56:59]
    v_rcp_f32 v9, v9
    ds_read_b128 v[24:27], v5 offset:38912
    s_waitcnt vmcnt(9)
    v_mfma_f32_16x16x32_bf16 v[60:63], v[148:151], v[28:31], v[60:63]
    s_barrier
    s_waitcnt lgkmcnt(2)
    v_mfma_f32_16x16x32_bf16 v[32:35], v[16:19], v[152:155], v[32:35]
    s_add_u32 m0, s32, 106496
    v_rcp_f32 v10, v10
    s_add_u32 s27, s87, 1179648
    ds_read_b128 v[28:31], v5 offset:39936
    v_mfma_f32_16x16x32_bf16 v[36:39], v[16:19], v[156:159], v[36:39]
    buffer_load_dwordx4 v6, s[4:7], s27 offen  lds
    s_waitcnt lgkmcnt(2)
    v_mfma_f32_16x16x32_bf16 v[40:43], v[152:155], v[20:23], v[40:43]
    s_add_u32 m0, s32, 114688
    v_rcp_f32 v11, v11
    s_add_u32 s28, s87, 1179712
    ds_read_b128 v[16:19], v5 offset:40960
    v_mfma_f32_16x16x32_bf16 v[44:47], v[156:159], v[20:23], v[44:47]
    buffer_load_dwordx4 v6, s[4:7], s28 offen  lds
    s_waitcnt lgkmcnt(2)
    v_mfma_f32_16x16x32_bf16 v[48:51], v[152:155], v[24:27], v[48:51]
    v_mul_f32 v76, v76, v8
    v_mul_f32 v77, v77, v9
    s_cmp_eq_u32 s44, 6
    s_cselect_b32 s29, 5308416, 0
    s_sub_u32 s87, s87, s29
    ds_read_b128 v[20:23], v5 offset:41984
    v_mfma_f32_16x16x32_bf16 v[52:55], v[156:159], v[24:27], v[52:55]
    v_mul_f32 v78, v78, v10
    v_mul_f32 v79, v79, v11
    s_nop 0
    s_waitcnt lgkmcnt(2)
    v_mfma_f32_16x16x32_bf16 v[56:59], v[152:155], v[28:31], v[56:59]
    v_cvt_pk_bf16_f32 v68, v76, v77
    v_cvt_pk_bf16_f32 v69, v78, v79
    ds_read_b128 v[24:27], v5 offset:43008
    v_mfma_f32_16x16x32_bf16 v[60:63], v[156:159], v[28:31], v[60:63]
    v_bfe_u32 v2, v4, 6, 4
    v_lshlrev_b32 v2, 7, v2
    s_nop 0
    s_waitcnt lgkmcnt(2)
    v_mfma_f32_16x16x32_bf16 v[32:35], v[16:19], v[160:163], v[32:35]
    v_bfe_u32 v8, v4, 7, 2
    v_lshl_add_u32 v2, v8, 5, v2
    ds_read_b128 v[28:31], v5 offset:44032
    v_mfma_f32_16x16x32_bf16 v[36:39], v[16:19], v[164:167], v[36:39]
    s_waitcnt lgkmcnt(2)
    v_bfe_u32 v8, v4, 4, 2
    v_lshl_add_u32 v2, v8, 3, v2
    s_and_b32 s53, s39, 3
    s_lshl_b32 s53, s53, 5
    s_and_b32 s30, s32, 0x1000
    s_or_b32 s53, s53, s30
    v_mfma_f32_16x16x32_bf16 v[40:43], v[160:163], v[20:23], v[40:43]
    v_xor_b32 v2, s53, v2
    v_add_u32 v2, 49152, v2
    ds_read_b128 v[16:19], v5 offset:45056
    ds_read_b64_tr_b16 v[72:73], v2 offset:0
    v_mfma_f32_16x16x32_bf16 v[44:47], v[164:167], v[20:23], v[44:47]
    ds_read_b64_tr_b16 v[74:75], v2 offset:2048
    ds_read_b64_tr_b16 v[76:77], v2 offset:8192
    s_nop 0
    s_waitcnt lgkmcnt(5)
    v_mfma_f32_16x16x32_bf16 v[48:51], v[160:163], v[24:27], v[48:51]
    ds_read_b128 v[20:23], v5 offset:46080
    ds_read_b64_tr_b16 v[78:79], v2 offset:10240
    s_nop 1
    v_mfma_f32_16x16x32_bf16 v[52:55], v[164:167], v[24:27], v[52:55]
    v_mul_f32 v8, v80, v80
    v_mul_f32 v9, v81, v81
    s_nop 0
    s_waitcnt lgkmcnt(6)
    v_mfma_f32_16x16x32_bf16 v[56:59], v[160:163], v[28:31], v[56:59]
    v_mul_f32 v10, v82, v82
    v_mul_f32 v11, v83, v83
    ds_read_b128 v[24:27], v5 offset:47104
    v_mfma_f32_16x16x32_bf16 v[60:63], v[164:167], v[28:31], v[60:63]
    v_fma_f32 v8, v8, v0, v13
    v_fma_f32 v9, v9, v0, v13
    s_nop 0
    s_waitcnt lgkmcnt(6)
    v_mfma_f32_16x16x32_bf16 v[32:35], v[16:19], v[168:171], v[32:35]
    ds_read_b128 v[28:31], v5 offset:48128
    s_waitcnt lgkmcnt(5)
    buffer_store_dwordx4 v[72:75], v4, s[8:11], s80 offen sc1
    v_mfma_f32_16x16x32_bf16 v[36:39], v[16:19], v[172:175], v[36:39]
    ds_read_b64_tr_b16 v[72:73], v2 offset:16384
    ds_read_b64_tr_b16 v[74:75], v2 offset:18432
    s_nop 0
    s_waitcnt lgkmcnt(5)
    v_mfma_f32_16x16x32_bf16 v[40:43], v[168:171], v[20:23], v[40:43]
    v_fma_f32 v10, v10, v0, v13
    v_fma_f32 v11, v11, v0, v13
    ds_read_b128 v[16:19], v5 offset:49152
    v_mfma_f32_16x16x32_bf16 v[44:47], v[172:175], v[20:23], v[44:47]
    v_mul_f32 v8, v80, v8
    v_mul_f32 v9, v81, v9
    s_nop 0
    s_waitcnt lgkmcnt(4)
    v_mfma_f32_16x16x32_bf16 v[48:51], v[168:171], v[24:27], v[48:51]
    v_mul_f32 v10, v82, v10
    v_mul_f32 v11, v83, v11
    ds_read_b128 v[20:23], v5 offset:50176
    v_mfma_f32_16x16x32_bf16 v[52:55], v[172:175], v[24:27], v[52:55]
    v_exp_f32 v8, v8
    s_nop 0
    s_waitcnt lgkmcnt(4)
    v_mfma_f32_16x16x32_bf16 v[56:59], v[168:171], v[28:31], v[56:59]
    v_exp_f32 v9, v9
    ds_read_b128 v[24:27], v5 offset:51200
    v_mfma_f32_16x16x32_bf16 v[60:63], v[172:175], v[28:31], v[60:63]
    v_exp_f32 v10, v10
    s_nop 0
    s_waitcnt lgkmcnt(2)
    v_mfma_f32_16x16x32_bf16 v[32:35], v[16:19], v[176:179], v[32:35]
    v_exp_f32 v11, v11
    ds_read_b128 v[28:31], v5 offset:52224
    v_mfma_f32_16x16x32_bf16 v[36:39], v[16:19], v[180:183], v[36:39]
    v_mul_f32 v88, v80, v88
    v_mul_f32 v89, v81, v89
    s_nop 0
    s_waitcnt lgkmcnt(2)
    v_mfma_f32_16x16x32_bf16 v[40:43], v[176:179], v[20:23], v[40:43]
    v_mul_f32 v90, v82, v90
    v_mul_f32 v91, v83, v91
    ds_read_b128 v[16:19], v5 offset:53248
    v_mfma_f32_16x16x32_bf16 v[44:47], v[180:183], v[20:23], v[44:47]
    buffer_store_dwordx4 v[76:79], v4, s[8:11], s81 offen sc1
    s_waitcnt lgkmcnt(2)
    v_mfma_f32_16x16x32_bf16 v[48:51], v[176:179], v[24:27], v[48:51]
    v_add_f32 v8, 1.0, v8
    v_add_f32 v9, 1.0, v9
    ds_read_b128 v[20:23], v5 offset:54272
    v_mfma_f32_16x16x32_bf16 v[52:55], v[180:183], v[24:27], v[52:55]
    v_add_f32 v10, 1.0, v10
    v_add_f32 v11, 1.0, v11
    s_nop 0
    s_waitcnt lgkmcnt(2)
    v_mfma_f32_16x16x32_bf16 v[56:59], v[176:179], v[28:31], v[56:59]
    v_rcp_f32 v8, v8
    ds_read_b128 v[24:27], v5 offset:55296
    v_mfma_f32_16x16x32_bf16 v[60:63], v[180:183], v[28:31], v[60:63]
    v_rcp_f32 v9, v9
    s_nop 0
    s_waitcnt lgkmcnt(2)
    v_mfma_f32_16x16x32_bf16 v[32:35], v[16:19], v[184:187], v[32:35]
    v_rcp_f32 v10, v10
    ds_read_b128 v[28:31], v5 offset:56320
    v_mfma_f32_16x16x32_bf16 v[36:39], v[16:19], v[188:191], v[36:39]
    v_rcp_f32 v11, v11
    s_nop 0
    s_waitcnt lgkmcnt(2)
    v_mfma_f32_16x16x32_bf16 v[40:43], v[184:187], v[20:23], v[40:43]
    v_add_u32 v5, 0xfffe8000, v5
    v_mul_f32 v88, v88, v8
    ds_read_b128 v[16:19], v5 offset:0
    v_mfma_f32_16x16x32_bf16 v[44:47], v[188:191], v[20:23], v[44:47]
    v_mul_f32 v89, v89, v9
    v_mul_f32 v90, v90, v10
    s_nop 0
    s_waitcnt lgkmcnt(2)
    v_mfma_f32_16x16x32_bf16 v[48:51], v[184:187], v[24:27], v[48:51]
    v_mul_f32 v91, v91, v11
    v_cvt_pk_bf16_f32 v66, v88, v89
    ds_read_b128 v[20:23], v5 offset:1024
    v_mfma_f32_16x16x32_bf16 v[52:55], v[188:191], v[24:27], v[52:55]
    v_cvt_pk_bf16_f32 v67, v90, v91
    s_nop 1
    s_waitcnt lgkmcnt(2)
    v_mfma_f32_16x16x32_bf16 v[56:59], v[184:187], v[28:31], v[56:59]
    ds_read_b128 v[24:27], v5 offset:2048
    buffer_store_dwordx4 v[72:75], v4, s[8:11], s82 offen sc1
    s_waitcnt vmcnt(12)
    v_mfma_f32_16x16x32_bf16 v[60:63], v[188:191], v[28:31], v[60:63]
    s_barrier
    s_waitcnt lgkmcnt(2)
    v_mfma_f32_16x16x32_bf16 v[32:35], v[16:19], v[192:195], v[32:35]
    s_add_u32 s30, s33, 0
    ds_read_b128 v[28:31], v5 offset:3072
    buffer_store_dwordx4 v[64:67], v4, s[8:11], s30 offen offset:1024 sc1
    v_mfma_f32_16x16x32_bf16 v[36:39], v[16:19], v[196:199], v[36:39]
    v_mul_f32 v8, v84, v84
    v_mul_f32 v9, v85, v85
    s_nop 0
    s_waitcnt lgkmcnt(2)
    v_mfma_f32_16x16x32_bf16 v[40:43], v[192:195], v[20:23], v[40:43]
    s_add_u32 m0, s32, 122880
    v_mul_f32 v10, v86, v86
    v_mul_f32 v11, v87, v87
    s_add_u32 s24, s87, 1769472
    ds_read_b128 v[16:19], v5 offset:4096
    v_mfma_f32_16x16x32_bf16 v[44:47], v[196:199], v[20:23], v[44:47]
    buffer_load_dwordx4 v6, s[4:7], s24 offen  lds
    s_waitcnt lgkmcnt(2)
    v_mfma_f32_16x16x32_bf16 v[48:51], v[192:195], v[24:27], v[48:51]
    v_fma_f32 v8, v8, v7, v15
    v_fma_f32 v9, v9, v7, v15
    ds_read_b128 v[20:23], v5 offset:5120
    v_mfma_f32_16x16x32_bf16 v[52:55], v[196:199], v[24:27], v[52:55]
    v_fma_f32 v10, v10, v7, v15
    v_fma_f32 v11, v11, v7, v15
    s_nop 0
    s_waitcnt lgkmcnt(2)
    v_mfma_f32_16x16x32_bf16 v[56:59], v[192:195], v[28:31], v[56:59]
    v_mul_f32 v8, v84, v8
    v_mul_f32 v9, v85, v9
    ds_read_b128 v[24:27], v5 offset:6144
    v_mfma_f32_16x16x32_bf16 v[60:63], v[196:199], v[28:31], v[60:63]
    s_waitcnt lgkmcnt(2)
    v_mul_f32 v10, v86, v10
    v_mul_f32 v11, v87, v11
    s_add_u32 m0, s32, 131072
    s_add_u32 s25, s87, 1769536
    v_mfma_f32_16x16x32_bf16 v[32:35], v[16:19], v[200:203], v[32:35]
    v_exp_f32 v8, v8
    ds_read_b128 v[28:31], v5 offset:7168
    v_mfma_f32_16x16x32_bf16 v[36:39], v[16:19], v[204:207], v[36:39]
    buffer_load_dwordx4 v6, s[4:7], s25 offen  lds
    s_waitcnt lgkmcnt(2)
    v_mfma_f32_16x16x32_bf16 v[40:43], v[200:203], v[20:23], v[40:43]
    v_exp_f32 v9, v9
    ds_read_b128 v[16:19], v5 offset:8192
    v_mfma_f32_16x16x32_bf16 v[44:47], v[204:207], v[20:23], v[44:47]
    v_exp_f32 v10, v10
    s_nop 0
    s_waitcnt lgkmcnt(2)
    v_mfma_f32_16x16x32_bf16 v[48:51], v[200:203], v[24:27], v[48:51]
    v_exp_f32 v11, v11
    ds_read_b128 v[20:23], v5 offset:9216
    v_mfma_f32_16x16x32_bf16 v[52:55], v[204:207], v[24:27], v[52:55]
    v_mul_f32 v92, v84, v92
    v_mul_f32 v93, v85, v93
    s_nop 0
    s_waitcnt lgkmcnt(2)
    v_mfma_f32_16x16x32_bf16 v[56:59], v[200:203], v[28:31], v[56:59]
    v_mul_f32 v94, v86, v94
    v_mul_f32 v95, v87, v95
    ds_read_b128 v[24:27], v5 offset:10240
    v_mfma_f32_16x16x32_bf16 v[60:63], v[204:207], v[28:31], v[60:63]
    v_add_f32 v8, 1.0, v8
    v_add_f32 v9, 1.0, v9
    s_nop 0
    s_waitcnt lgkmcnt(2)
    v_mfma_f32_16x16x32_bf16 v[32:35], v[16:19], v[208:211], v[32:35]
    v_add_f32 v10, 1.0, v10
    v_add_f32 v11, 1.0, v11
    ds_read_b128 v[28:31], v5 offset:11264
    v_mfma_f32_16x16x32_bf16 v[36:39], v[16:19], v[212:215], v[36:39]
    v_rcp_f32 v8, v8
    s_nop 0
    s_waitcnt lgkmcnt(2)
    v_mfma_f32_16x16x32_bf16 v[40:43], v[208:211], v[20:23], v[40:43]
    v_rcp_f32 v9, v9
    ds_read_b128 v[16:19], v5 offset:12288
    v_mfma_f32_16x16x32_bf16 v[44:47], v[212:215], v[20:23], v[44:47]
    v_rcp_f32 v10, v10
    s_nop 0
    s_waitcnt lgkmcnt(2)
    v_mfma_f32_16x16x32_bf16 v[48:51], v[208:211], v[24:27], v[48:51]
    v_rcp_f32 v11, v11
    ds_read_b128 v[20:23], v5 offset:13312
    v_mfma_f32_16x16x32_bf16 v[52:55], v[212:215], v[24:27], v[52:55]
    v_mul_f32 v92, v92, v8
    v_mul_f32 v93, v93, v9
    s_nop 0
    s_waitcnt lgkmcnt(2)
    v_mfma_f32_16x16x32_bf16 v[56:59], v[208:211], v[28:31], v[56:59]
    v_mul_f32 v94, v94, v10
    v_mul_f32 v95, v95, v11
    ds_read_b128 v[24:27], v5 offset:14336
    v_mfma_f32_16x16x32_bf16 v[60:63], v[212:215], v[28:31], v[60:63]
    s_waitcnt lgkmcnt(2)
    v_cvt_pk_bf16_f32 v70, v92, v93
    v_cvt_pk_bf16_f32 v71, v94, v95
    s_add_u32 m0, s32, 139264
    s_add_u32 s26, s87, 2359296
    v_mfma_f32_16x16x32_bf16 v[32:35], v[16:19], v[216:219], v[32:35]
    s_add_u32 s31, s33, 163840
    ds_read_b128 v[28:31], v5 offset:15360
    s_nop 2
    v_mfma_f32_16x16x32_bf16 v[36:39], v[16:19], v[220:223], v[36:39]
    buffer_load_dwordx4 v6, s[4:7], s26 offen  lds
    s_waitcnt lgkmcnt(2)
    v_mfma_f32_16x16x32_bf16 v[40:43], v[216:219], v[20:23], v[40:43]
    ds_read_b128 v[16:19], v5 offset:16384
    buffer_store_dwordx4 v[68:71], v4, s[8:11], s31 offen offset:1024 sc1
    v_mfma_f32_16x16x32_bf16 v[44:47], v[220:223], v[20:23], v[44:47]
    v_mov_b32 v80, -1
    v_mov_b32 v81, -1
    s_nop 0
    s_waitcnt lgkmcnt(2)
    v_mfma_f32_16x16x32_bf16 v[48:51], v[216:219], v[24:27], v[48:51]
    v_mov_b32 v82, -1
    v_mov_b32 v83, -1
    ds_read_b128 v[20:23], v5 offset:17408
    v_mfma_f32_16x16x32_bf16 v[52:55], v[220:223], v[24:27], v[52:55]
    v_lshrrev_b32 v84, 1, v4
    v_lshrrev_b32 v85, 2, v4
    s_nop 0
    s_waitcnt lgkmcnt(2)
    v_mfma_f32_16x16x32_bf16 v[56:59], v[216:219], v[28:31], v[56:59]
    ds_read_b128 v[24:27], v5 offset:18432
    buffer_store_dword v80, v85, s[8:11], s46 offen sc1
    s_waitcnt vmcnt(17)
    v_mfma_f32_16x16x32_bf16 v[60:63], v[220:223], v[28:31], v[60:63]
    s_barrier
    s_waitcnt lgkmcnt(2)
    v_mfma_f32_16x16x32_bf16 v[32:35], v[16:19], v[224:227], v[32:35]
    s_add_u32 m0, s32, 147456
    v_and_b32 v2, 0x3c0, v4
    v_bfe_u32 v3, v4, 8, 1
    s_add_u32 s27, s87, 2359360
    ds_read_b128 v[28:31], v5 offset:19456
    v_mfma_f32_16x16x32_bf16 v[36:39], v[16:19], v[228:231], v[36:39]
    buffer_load_dwordx4 v6, s[4:7], s27 offen  lds
    s_waitcnt lgkmcnt(2)
    v_mfma_f32_16x16x32_bf16 v[40:43], v[224:227], v[20:23], v[40:43]
    v_lshl_add_u32 v2, v3, 5, v2
    v_bfe_u32 v3, v4, 4, 2
    ds_read_b128 v[16:19], v5 offset:20480
    v_mfma_f32_16x16x32_bf16 v[44:47], v[228:231], v[20:23], v[44:47]
    v_lshl_add_u32 v2, v3, 3, v2
    v_xor_b32 v3, 32, v2
    s_nop 0
    s_waitcnt lgkmcnt(2)
    v_mfma_f32_16x16x32_bf16 v[48:51], v[224:227], v[24:27], v[48:51]
    v_mul_f32 v8, v96, v96
    v_mul_f32 v9, v97, v97
    ds_read_b128 v[20:23], v5 offset:21504
    v_mfma_f32_16x16x32_bf16 v[52:55], v[228:231], v[24:27], v[52:55]
    v_mul_f32 v10, v98, v98
    v_mul_f32 v11, v99, v99
    s_nop 0
    s_waitcnt lgkmcnt(2)
    v_mfma_f32_16x16x32_bf16 v[56:59], v[224:227], v[28:31], v[56:59]
    ds_read_b128 v[24:27], v5 offset:22528
    buffer_store_dwordx2 v[80:81], v84, s[8:11], s37 offen sc1
    v_mfma_f32_16x16x32_bf16 v[60:63], v[228:231], v[28:31], v[60:63]
    v_fma_f32 v8, v8, v0, v13
    v_fma_f32 v9, v9, v0, v13
    s_nop 0
    s_waitcnt lgkmcnt(2)
    v_mfma_f32_16x16x32_bf16 v[32:35], v[16:19], v[232:235], v[32:35]
    v_fma_f32 v10, v10, v0, v13
    v_fma_f32 v11, v11, v0, v13
    ds_read_b128 v[28:31], v5 offset:23552
    v_mfma_f32_16x16x32_bf16 v[36:39], v[16:19], v[236:239], v[36:39]
    v_mul_f32 v8, v96, v8
    v_mul_f32 v9, v97, v9
    s_nop 0
    s_waitcnt lgkmcnt(2)
    v_mfma_f32_16x16x32_bf16 v[40:43], v[232:235], v[20:23], v[40:43]
    v_mul_f32 v10, v98, v10
    v_mul_f32 v11, v99, v11
    ds_read_b128 v[16:19], v5 offset:24576
    v_mfma_f32_16x16x32_bf16 v[44:47], v[236:239], v[20:23], v[44:47]
    v_exp_f32 v8, v8
    s_nop 0
    s_waitcnt lgkmcnt(2)
    v_mfma_f32_16x16x32_bf16 v[48:51], v[232:235], v[24:27], v[48:51]
    v_exp_f32 v9, v9
    ds_read_b128 v[20:23], v5 offset:25600
    v_mfma_f32_16x16x32_bf16 v[52:55], v[236:239], v[24:27], v[52:55]
    v_exp_f32 v10, v10
    s_nop 0
    s_waitcnt lgkmcnt(2)
    v_mfma_f32_16x16x32_bf16 v[56:59], v[232:235], v[28:31], v[56:59]
    v_exp_f32 v11, v11
    ds_read_b128 v[24:27], v5 offset:26624
    v_mfma_f32_16x16x32_bf16 v[60:63], v[236:239], v[28:31], v[60:63]
    v_mul_f32 v104, v96, v104
    v_mul_f32 v105, v97, v105
    s_nop 0
    s_waitcnt lgkmcnt(2)
    v_mfma_f32_16x16x32_bf16 v[32:35], v[16:19], v[240:243], v[32:35]
    s_add_u32 m0, s32, 49152
    v_mul_f32 v106, v98, v106
    v_mul_f32 v107, v99, v107
    s_add_u32 s28, s87, 2949120
    ds_read_b128 v[28:31], v5 offset:27648
    v_mfma_f32_16x16x32_bf16 v[36:39], v[16:19], v[244:247], v[36:39]
    buffer_load_dwordx4 v6, s[4:7], s28 offen  lds
    s_waitcnt lgkmcnt(2)
    v_mfma_f32_16x16x32_bf16 v[40:43], v[240:243], v[20:23], v[40:43]
    s_add_u32 m0, s32, 57344
    v_add_f32 v8, 1.0, v8
    v_add_f32 v9, 1.0, v9
    s_add_u32 s29, s87, 2949184
    ds_read_b128 v[16:19], v5 offset:28672
    v_mfma_f32_16x16x32_bf16 v[44:47], v[244:247], v[20:23], v[44:47]
    buffer_load_dwordx4 v6, s[4:7], s29 offen  lds
    s_waitcnt lgkmcnt(2)
    v_mfma_f32_16x16x32_bf16 v[48:51], v[240:243], v[24:27], v[48:51]
    v_add_f32 v10, 1.0, v10
    v_add_f32 v11, 1.0, v11
    s_cmp_eq_u32 s44, 3
    s_cselect_b32 s24, 5308416, 0
    s_sub_u32 s87, s87, s24
    ds_read_b128 v[20:23], v5 offset:29696
    v_mfma_f32_16x16x32_bf16 v[52:55], v[244:247], v[24:27], v[52:55]
    s_waitcnt lgkmcnt(2)
    s_add_u32 s31, s33, 0
    buffer_store_dwordx4 v[80:83], v4, s[8:11], s31 offen offset:3072 sc1
    v_mfma_f32_16x16x32_bf16 v[56:59], v[240:243], v[28:31], v[56:59]
    v_rcp_f32 v8, v8
    ds_read_b128 v[24:27], v5 offset:30720
    s_waitcnt vmcnt(19)
    v_mfma_f32_16x16x32_bf16 v[60:63], v[244:247], v[28:31], v[60:63]
    s_barrier
    s_waitcnt lgkmcnt(2)
    v_mfma_f32_16x16x32_bf16 v[32:35], v[16:19], v[248:251], v[32:35]
    v_rcp_f32 v9, v9
    ds_read_b128 v[28:31], v5 offset:31744
    v_mfma_f32_16x16x32_bf16 v[36:39], v[16:19], v[252:255], v[36:39]
    v_rcp_f32 v10, v10
    s_nop 0
    s_waitcnt lgkmcnt(2)
    v_mfma_f32_16x16x32_bf16 v[40:43], v[248:251], v[20:23], v[40:43]
    v_bfe_u32 v5, v4, 1, 8
    v_add_u32 v5, 0x18000, v5
    ds_read_b64 v[16:17], v5 offset:59392
    v_mfma_f32_16x16x32_bf16 v[44:47], v[252:255], v[20:23], v[44:47]
    v_rcp_f32 v11, v11
    s_nop 0
    s_waitcnt lgkmcnt(2)
    v_mfma_f32_16x16x32_bf16 v[48:51], v[248:251], v[24:27], v[48:51]
    v_mul_f32 v104, v104, v8
    v_mul_f32 v105, v105, v9
    ds_read_b64 v[20:21], v5 offset:60416
    v_mfma_f32_16x16x32_bf16 v[52:55], v[252:255], v[24:27], v[52:55]
    v_mul_f32 v106, v106, v10
    v_mul_f32 v107, v107, v11
    s_nop 0
    s_waitcnt lgkmcnt(2)
    v_mfma_f32_16x16x32_bf16 v[56:59], v[248:251], v[28:31], v[56:59]
    v_cvt_pk_bf16_f32 v96, v104, v105
    v_cvt_pk_bf16_f32 v97, v106, v107
    ds_read_b64 v[24:25], v5 offset:61440
    v_mfma_f32_16x16x32_bf16 v[60:63], v[252:255], v[28:31], v[60:63]
    v_mul_f32 v8, v100, v100
    v_mul_f32 v9, v101, v101
    s_nop 0
    s_waitcnt lgkmcnt(2)
    v_mfma_f32_16x16x16_bf16 v[32:35], v[16:17], v[12:13], v[32:35]
    v_mul_f32 v10, v102, v102
    v_mul_f32 v11, v103, v103
    ds_read_b64 v[28:29], v5 offset:62464
    v_mfma_f32_16x16x16_bf16 v[36:39], v[16:17], v[14:15], v[36:39]
    v_fma_f32 v8, v8, v7, v15
    v_fma_f32 v9, v9, v7, v15
    s_nop 0
    s_waitcnt lgkmcnt(2)
    v_mfma_f32_16x16x16_bf16 v[40:43], v[12:13], v[20:21], v[40:43]
    s_add_u32 m0, s32, 65536
    v_add_u32 v2, 0x12000, v2
    v_fma_f32 v10, v10, v7, v15
    s_add_u32 s25, s87, 3538944
    ds_read_b64_tr_b16 v[16:17], v2 offset:0
    v_mfma_f32_16x16x16_bf16 v[44:47], v[14:15], v[20:21], v[44:47]
    s_waitcnt lgkmcnt(2)
    v_fma_f32 v11, v11, v7, v15
    v_mul_f32 v8, v100, v8
    ds_read_b64_tr_b16 v[18:19], v2 offset:1024
    v_mfma_f32_16x16x16_bf16 v[48:51], v[12:13], v[24:25], v[48:51]
    ds_read_b64_tr_b16 v[20:21], v2 offset:4096
    ds_read_b64_tr_b16 v[22:23], v2 offset:5120
    buffer_load_dwordx4 v6, s[4:7], s25 offen  lds
    v_mfma_f32_16x16x16_bf16 v[52:55], v[14:15], v[24:25], v[52:55]
    v_mul_f32 v9, v101, v9
    s_nop 1
    s_waitcnt lgkmcnt(4)
    v_mfma_f32_16x16x16_bf16 v[56:59], v[12:13], v[28:29], v[56:59]
    s_add_u32 s30, s33, 163840
    v_add_u32 v3, 0x12000, v3
    ds_read_b64_tr_b16 v[24:25], v3 offset:0
    ds_read_b64_tr_b16 v[26:27], v3 offset:1024
    buffer_store_dwordx4 v[80:83], v4, s[8:11], s30 offen offset:3072 sc1
    v_mul_f32 v10, v102, v10
    v_mul_f32 v11, v103, v11
    v_exp_f32 v8, v8
    v_exp_f32 v9, v9
    v_exp_f32 v10, v10
    v_exp_f32 v11, v11
    v_mul_f32 v108, v100, v108
    v_mul_f32 v109, v101, v109
    v_mul_f32 v110, v102, v110
    v_mul_f32 v111, v103, v111
    v_add_f32 v8, 1.0, v8
    v_add_f32 v9, 1.0, v9
    v_add_f32 v10, 1.0, v10
    v_add_f32 v11, 1.0, v11
    v_rcp_f32 v8, v8
    v_rcp_f32 v9, v9
    v_rcp_f32 v10, v10
    v_rcp_f32 v11, v11
    v_mul_f32 v108, v108, v8
    v_mul_f32 v109, v109, v9
    v_mul_f32 v110, v110, v10
    v_mul_f32 v111, v111, v11
    v_cvt_pk_bf16_f32 v98, v108, v109
    v_cvt_pk_bf16_f32 v99, v110, v111
    s_add_u32 s53, s32, 40960
    v_add_u32 v104, s53, v4
    ds_write_b128 v104, v[96:99]
    v_mov_b32 v96, 0x3f803f80
    v_mov_b32 v97, 0x3f803f80
    v_mov_b32 v98, 0x3f803f80
    v_mov_b32 v99, 0x3f803f80
    s_waitcnt vmcnt(7)
    v_mfma_f32_16x16x16_bf16 v[60:63], v[14:15], v[28:29], v[60:63]
    s_barrier
    s_waitcnt lgkmcnt(5)
    v_mfma_f32_16x16x32_bf16 v[64:67], v[16:19], v[112:115], 0
    s_add_u32 m0, s32, 0
    v_lshlrev_b32 v108, 21, v4
    v_and_b32 v108, s38, v108
    s_add_u32 s26, s87, 3539008
    ds_read_b64_tr_b16 v[28:29], v3 offset:4096
    v_mfma_f32_16x16x32_bf16 v[68:71], v[16:19], v[116:119], 0
    s_waitcnt lgkmcnt(4)
    v_lshrrev_b32 v109, 2, v4
    v_or_b32 v108, v108, v109
    ds_read_b64_tr_b16 v[30:31], v3 offset:5120
    v_mfma_f32_16x16x32_bf16 v[72:75], v[20:23], v[112:115], 0
    ds_read_b64_tr_b16 v[16:17], v2 offset:2048
    ds_read_b64_tr_b16 v[18:19], v2 offset:3072
    buffer_load_dwordx4 v6, s[4:7], s26 offen  lds
    v_mfma_f32_16x16x32_bf16 v[76:79], v[20:23], v[116:119], 0
    v_mov_b32 v109, s54
    s_lshr_b32 s74, s2, 3
    s_and_b32 s73, s74, 3
    s_waitcnt lgkmcnt(5)
    v_mfma_f32_16x16x32_bf16 v[80:83], v[24:27], v[112:115], 0
    s_add_u32 s30, s52, 0
    ds_read_b64_tr_b16 v[20:21], v2 offset:6144
    buffer_store_dword v109, v108, s[8:11], s30 offen sc1
    v_mfma_f32_16x16x32_bf16 v[84:87], v[24:27], v[116:119], 0
    s_waitcnt lgkmcnt(3)
    s_add_u32 s31, s55, 32768
    ds_read_b64_tr_b16 v[22:23], v2 offset:7168
    buffer_store_dword v109, v108, s[8:11], s31 offen sc1
    v_mfma_f32_16x16x32_bf16 v[88:91], v[28:31], v[112:115], 0
    s_lshr_b32 s74, s74, 2
    v_lshrrev_b32 v1, 4, v4
    v_and_b32 v1, 0x30, v1
    s_add_u32 s53, s32, 155648
    s_and_b32 s75, s2, 4
    ds_read_b64_tr_b16 v[24:25], v3 offset:2048
    v_mfma_f32_16x16x32_bf16 v[92:95], v[28:31], v[116:119], 0
    s_waitcnt lgkmcnt(3)
    v_add_u32 v1, s53, v1
    s_lshl_b32 s75, s75, 1
    s_add_u32 s74, s74, s75
    ds_read_b64_tr_b16 v[26:27], v3 offset:3072
    ds_read_b128 v[104:107], v1 offset:512
    v_mfma_f32_16x16x32_bf16 v[64:67], v[16:19], v[120:123], v[64:67]
    s_and_b32 s75, s39, 3
    ds_read_b64_tr_b16 v[28:29], v3 offset:6144
    ds_read_b128 v[108:111], v1 offset:576
    s_nop 1
    v_mfma_f32_16x16x32_bf16 v[68:71], v[16:19], v[124:127], v[68:71]
    s_waitcnt lgkmcnt(5)
    v_mul_f32 v8, 0xbede652a, v13
    v_mul_f32 v9, 0xbede652a, v15
    s_lshr_b32 s76, s39, 2
    s_and_b32 s78, s2, 3
    ds_read_b64_tr_b16 v[30:31], v3 offset:7168
    v_mfma_f32_16x16x32_bf16 v[72:75], v[20:23], v[120:123], v[72:75]
    s_lshl_b32 s77, s74, 3
    v_xor_b32 v5, s34, v2
    v_mul_f32 v32, v32, v8
    s_lshl_b32 s79, s75, 1
    s_add_u32 s77, s77, s79
    ds_read_b64_tr_b16 v[16:17], v5 offset:0
    v_mfma_f32_16x16x32_bf16 v[76:79], v[20:23], v[124:127], v[76:79]
    s_waitcnt lgkmcnt(5)
    v_mul_f32 v33, v33, v8
    v_mul_f32 v34, v34, v8
    s_add_u32 s77, s77, s76
    s_lshl_b32 s70, s77, 11
    ds_read_b64_tr_b16 v[18:19], v5 offset:1024
    v_mfma_f32_16x16x32_bf16 v[80:83], v[24:27], v[120:123], v[80:83]
    s_lshl_b32 s79, s78, 3
    v_mul_f32 v35, v35, v8
    v_mul_f32 v36, v36, v9
    s_lshl_b32 s71, s76, 2
    s_add_u32 s79, s79, s71
    ds_read_b64_tr_b16 v[20:21], v2 offset:16384
    v_mfma_f32_16x16x32_bf16 v[84:87], v[24:27], v[124:127], v[84:87]
    s_waitcnt lgkmcnt(3)
    v_mul_f32 v37, v37, v9
    v_mul_f32 v38, v38, v9
    s_mul_i32 s79, s79, 5120
    s_add_u32 s79, s79, 6291456
    ds_read_b64_tr_b16 v[22:23], v2 offset:17408
    v_mfma_f32_16x16x32_bf16 v[88:91], v[28:31], v[120:123], v[88:91]
    s_mul_i32 s62, s77, 163840
    v_mul_f32 v39, v39, v9
    v_mul_f32 v40, v40, v104
    s_add_u32 s62, s62, s79
    s_xor_b32 s71, s77, 1
    ds_read_b64_tr_b16 v[24:25], v2 offset:20480
    v_mfma_f32_16x16x32_bf16 v[92:95], v[28:31], v[124:127], v[92:95]
    s_waitcnt lgkmcnt(3)
    v_mul_f32 v41, v41, v105
    v_mul_f32 v42, v42, v106
    s_mul_i32 s63, s71, 163840
    s_add_u32 s63, s63, s79
    ds_read_b64_tr_b16 v[26:27], v2 offset:21504
    v_mfma_f32_16x16x32_bf16 v[100:103], v[96:99], v[16:19], 0
    s_waitcnt lgkmcnt(2)
    v_mul_f32 v43, v43, v107
    v_mul_f32 v48, v48, v104
    s_add_u32 m0, s32, 8192
    s_add_u32 s27, s87, 4128768
    ds_read_b64_tr_b16 v[28:29], v3 offset:16384
    ds_read_b64_tr_b16 v[30:31], v3 offset:17408
    v_mfma_f32_16x16x32_bf16 v[64:67], v[20:23], v[128:131], v[64:67]
    s_lshl_b32 s79, s78, 2
    ds_read_b64_tr_b16 v[16:17], v3 offset:20480
    ds_read_b64_tr_b16 v[18:19], v3 offset:21504
    buffer_load_dwordx4 v6, s[4:7], s27 offen  lds
    v_mfma_f32_16x16x32_bf16 v[68:71], v[20:23], v[132:135], v[68:71]
    s_waitcnt lgkmcnt(4)
    v_mul_f32 v49, v49, v105
    v_mul_f32 v50, v50, v106
    s_add_u32 m0, s32, 16384
    s_add_u32 s28, s87, 4128832
    v_mfma_f32_16x16x32_bf16 v[72:75], v[24:27], v[128:131], v[72:75]
    s_add_u32 s79, s79, s73
    ds_read_b64_tr_b16 v[20:21], v2 offset:18432
    ds_read_b64_tr_b16 v[22:23], v2 offset:19456
    buffer_load_dwordx4 v6, s[4:7], s28 offen  lds
    v_mfma_f32_16x16x32_bf16 v[76:79], v[24:27], v[132:135], v[76:79]
    s_waitcnt lgkmcnt(4)
    v_mul_f32 v51, v51, v107
    v_mul_f32 v56, v56, v104
    s_lshl_b32 s79, s79, 1
    s_add_u32 s79, s79, s76
    v_mfma_f32_16x16x32_bf16 v[80:83], v[28:31], v[128:131], v[80:83]
    s_mul_i32 s79, s79, 196608
    v_mul_f32 v57, v57, v105
    v_mul_f32 v58, v58, v106
    s_lshl_b32 s71, s75, 10
    s_add_u32 s79, s79, s71
    ds_read_b64_tr_b16 v[24:25], v2 offset:22528
    v_mfma_f32_16x16x32_bf16 v[84:87], v[28:31], v[132:135], v[84:87]
    s_waitcnt lgkmcnt(3)
    v_mul_f32 v59, v59, v107
    v_mul_f32 v44, v44, v108
    s_add_u32 s64, s79, 36700160
    s_mul_i32 s79, s76, 196608
    ds_read_b64_tr_b16 v[26:27], v2 offset:23552
    v_mfma_f32_16x16x32_bf16 v[88:91], v[16:19], v[128:131], v[88:91]
    s_sub_u32 s65, s64, s79
    v_mul_f32 v45, v45, v109
    v_mul_f32 v46, v46, v110
    s_lshr_b32 s79, s77, 1
    s_lshl_b32 s79, s79, 2
    ds_read_b64_tr_b16 v[28:29], v3 offset:18432
    v_mfma_f32_16x16x32_bf16 v[92:95], v[16:19], v[132:135], v[92:95]
    s_waitcnt lgkmcnt(3)
    v_mul_f32 v47, v47, v111
    v_mul_f32 v52, v52, v108
    s_add_u32 s79, s79, s78
    s_lshl_b32 s79, s79, 10
    ds_read_b64_tr_b16 v[30:31], v3 offset:19456
    v_mfma_f32_16x16x32_bf16 v[64:67], v[20:23], v[136:139], v[64:67]
    s_lshl_b32 s71, s76, 6
    v_mul_f32 v53, v53, v109
    v_mul_f32 v54, v54, v110
    s_add_u32 s79, s79, s71
    s_add_u32 s61, s79, 27262976
    ds_read_b64_tr_b16 v[16:17], v3 offset:22528
    v_mfma_f32_16x16x32_bf16 v[68:71], v[20:23], v[140:143], v[68:71]
    s_waitcnt lgkmcnt(3)
    v_mul_f32 v55, v55, v111
    v_mul_f32 v60, v60, v108
    s_mul_i32 s79, s77, 18432
    s_mul_i32 s71, s73, 288
    ds_read_b64_tr_b16 v[18:19], v3 offset:23552
    v_mfma_f32_16x16x32_bf16 v[72:75], v[24:27], v[136:139], v[72:75]
    s_add_u32 s79, s79, s71
    v_mul_f32 v61, v61, v109
    v_mul_f32 v62, v62, v110
    s_lshl_b32 s71, s78, 6
    s_add_u32 s59, s79, s71
    ds_read_b64_tr_b16 v[20:21], v5 offset:16384
    v_mfma_f32_16x16x32_bf16 v[76:79], v[24:27], v[140:143], v[76:79]
    s_waitcnt lgkmcnt(3)
    v_mul_f32 v63, v63, v111
    v_cvt_pk_bf16_f32 v48, v48, v49
    s_add_u32 s60, s79, 256
    s_add_u32 s79, s78, 1
    ds_read_b64_tr_b16 v[22:23], v5 offset:17408
    v_mfma_f32_16x16x32_bf16 v[80:83], v[28:31], v[136:139], v[80:83]
    s_and_b32 s79, s79, 3
    v_cvt_pk_bf16_f32 v49, v50, v51
    v_cvt_pk_bf16_f32 v50, v52, v53
    s_sub_u32 s79, s79, s78
    s_mul_i32 s79, s79, 24576
    ds_read_b64_tr_b16 v[24:25], v2 offset:32768
    v_mfma_f32_16x16x32_bf16 v[84:87], v[28:31], v[140:143], v[84:87]
    s_waitcnt lgkmcnt(3)
    v_cvt_pk_bf16_f32 v51, v54, v55
    v_cvt_pk_bf16_f32 v52, v56, v57
    s_add_u32 s79, s79, s49
    s_add_u32 s66, s79, 2048
    ds_read_b64_tr_b16 v[26:27], v2 offset:33792
    v_mfma_f32_16x16x32_bf16 v[88:91], v[16:19], v[136:139], v[88:91]
    s_add_u32 s79, s78, 2
    v_cvt_pk_bf16_f32 v53, v58, v59
    v_cvt_pk_bf16_f32 v54, v60, v61
    s_and_b32 s79, s79, 3
    s_sub_u32 s79, s79, s78
    ds_read_b64_tr_b16 v[28:29], v2 offset:36864
    v_mfma_f32_16x16x32_bf16 v[92:95], v[16:19], v[140:143], v[92:95]
    s_waitcnt lgkmcnt(3)
    v_cvt_pk_bf16_f32 v55, v62, v63
    v_mov_b32 v109, 0x3f803f80
    s_mul_i32 s79, s79, 24576
    s_add_u32 s79, s79, s49
    ds_read_b64_tr_b16 v[30:31], v2 offset:37888
    v_mfma_f32_16x16x32_bf16 v[100:103], v[96:99], v[20:23], v[100:103]
    s_barrier
    s_waitcnt lgkmcnt(2)
    ds_read_b64_tr_b16 v[16:17], v3 offset:32768
    ds_read_b64_tr_b16 v[18:19], v3 offset:33792
    v_mfma_f32_16x16x32_bf16 v[64:67], v[24:27], v[144:147], v[64:67]
    s_add_u32 s67, s79, 1024
    v_add_u32 v108, s32, v4
    v_cndmask_b32 v52, v52, v109, s[40:41]
    s_add_u32 m0, s32, 24576
    s_add_u32 s29, s87, 4718592
    ds_read_b64_tr_b16 v[20:21], v3 offset:36864
    v_mfma_f32_16x16x32_bf16 v[68:71], v[24:27], v[148:151], v[68:71]
    s_waitcnt lgkmcnt(3)
    v_cndmask_b32 v53, v53, v109, s[40:41]
    v_cndmask_b32 v54, v54, v109, s[40:41]
    s_add_u32 s79, s78, 3
    s_and_b32 s79, s79, 3
    ds_read_b64_tr_b16 v[22:23], v3 offset:37888
    v_mfma_f32_16x16x32_bf16 v[72:75], v[28:31], v[144:147], v[72:75]
    s_sub_u32 s79, s79, s78
    ds_read_b64_tr_b16 v[24:25], v2 offset:34816
    ds_read_b64_tr_b16 v[26:27], v2 offset:35840
    buffer_load_dwordx4 v6, s[4:7], s29 offen  lds
    v_mfma_f32_16x16x32_bf16 v[76:79], v[28:31], v[148:151], v[76:79]
    s_waitcnt lgkmcnt(4)
    v_cndmask_b32 v55, v55, v109, s[40:41]
    v_mul_f32 v8, s35, v40
    s_add_u32 m0, s32, 73728
    s_add_u32 s24, s87, 4718656
    v_mfma_f32_16x16x32_bf16 v[80:83], v[16:19], v[144:147], v[80:83]
    s_mul_i32 s79, s79, 24576
    ds_read_b64_tr_b16 v[28:29], v2 offset:38912
    ds_read_b64_tr_b16 v[30:31], v2 offset:39936
    buffer_load_dwordx4 v6, s[4:7], s24 offen  lds
    v_mfma_f32_16x16x32_bf16 v[84:87], v[16:19], v[148:151], v[84:87]
    s_waitcnt lgkmcnt(4)
    v_mul_f32 v9, s35, v41
    v_mul_f32 v10, s35, v42
    s_mul_i32 s87, s44, 589824
    s_add_u32 s79, s79, s49
    v_mfma_f32_16x16x32_bf16 v[88:91], v[20:23], v[144:147], v[88:91]
    s_add_u32 s68, s79, 0
    v_mul_f32 v11, s35, v43
    v_max_f32 v40, s36, v40
    s_lshr_b32 s79, s2, 2
    s_lshl_b32 s79, s79, 3
    ds_read_b64_tr_b16 v[16:17], v3 offset:34816
    v_mfma_f32_16x16x32_bf16 v[92:95], v[20:23], v[148:151], v[92:95]
    s_waitcnt lgkmcnt(3)
    v_exp_f32 v8, v8 clamp
    s_add_u32 s79, s79, s39
    s_lshl_b32 s79, s79, 11
    ds_read_b64_tr_b16 v[18:19], v3 offset:35840
    v_mfma_f32_16x16x32_bf16 v[64:67], v[24:27], v[152:155], v[64:67]
    s_add_u32 s79, s79, 35651584
    v_exp_f32 v9, v9 clamp
    s_sub_u32 s71, s78, s75
    s_sub_u32 s71, s71, 1
    ds_read_b64_tr_b16 v[20:21], v3 offset:38912
    v_mfma_f32_16x16x32_bf16 v[68:71], v[24:27], v[156:159], v[68:71]
    s_waitcnt lgkmcnt(3)
    v_exp_f32 v10, v10 clamp
    s_and_b32 s71, s71, 3
    s_lshl_b32 s71, s71, 9
    ds_read_b64_tr_b16 v[22:23], v3 offset:39936
    v_mfma_f32_16x16x32_bf16 v[72:75], v[28:31], v[152:155], v[72:75]
    s_add_u32 s79, s79, s71
    v_exp_f32 v11, v11 clamp
    ds_read_b64_tr_b16 v[24:25], v5 offset:32768
    v_mfma_f32_16x16x32_bf16 v[76:79], v[28:31], v[156:159], v[76:79]
    s_waitcnt lgkmcnt(3)
    v_max_f32 v41, s36, v41
    v_max_f32 v42, s36, v42
    s_cmp_eq_u32 s78, s75
    s_cselect_b32 s69, s38, s79
    s_cselect_b32 s60, s60, s38
    ds_read_b64_tr_b16 v[26:27], v5 offset:33792
    v_mfma_f32_16x16x32_bf16 v[80:83], v[16:19], v[152:155], v[80:83]
    v_max_f32 v43, s36, v43
    v_add_f32 v40, v40, v8
    ds_read_b64_tr_b16 v[28:29], v2 offset:49152
    v_mfma_f32_16x16x32_bf16 v[84:87], v[16:19], v[156:159], v[84:87]
    s_waitcnt lgkmcnt(3)
    v_add_f32 v41, v41, v9
    v_add_f32 v42, v42, v10
    ds_read_b64_tr_b16 v[30:31], v2 offset:50176
    v_mfma_f32_16x16x32_bf16 v[88:91], v[20:23], v[152:155], v[88:91]
    v_add_f32 v43, v43, v11
    v_mul_f32 v8, s35, v44
    ds_read_b64_tr_b16 v[16:17], v2 offset:53248
    v_mfma_f32_16x16x32_bf16 v[92:95], v[20:23], v[156:159], v[92:95]
    s_waitcnt lgkmcnt(3)
    v_mul_f32 v9, s35, v45
    v_mul_f32 v10, s35, v46
    ds_read_b64_tr_b16 v[18:19], v2 offset:54272
    v_mfma_f32_16x16x32_bf16 v[100:103], v[96:99], v[24:27], v[100:103]
    s_waitcnt lgkmcnt(2)
    v_mul_f32 v11, s35, v47
    v_max_f32 v44, s36, v44
    ds_read_b64_tr_b16 v[20:21], v3 offset:49152
    ds_read_b64_tr_b16 v[22:23], v3 offset:50176
    v_mfma_f32_16x16x32_bf16 v[64:67], v[28:31], v[160:163], v[64:67]
    v_exp_f32 v8, v8 clamp
    ds_read_b64_tr_b16 v[24:25], v3 offset:53248
    v_mfma_f32_16x16x32_bf16 v[68:71], v[28:31], v[164:167], v[68:71]
    s_waitcnt lgkmcnt(3)
    v_exp_f32 v9, v9 clamp
    ds_read_b64_tr_b16 v[26:27], v3 offset:54272
    v_mfma_f32_16x16x32_bf16 v[72:75], v[16:19], v[160:163], v[72:75]
    v_exp_f32 v10, v10 clamp
    ds_read_b64_tr_b16 v[28:29], v2 offset:51200
    v_mfma_f32_16x16x32_bf16 v[76:79], v[16:19], v[164:167], v[76:79]
    s_waitcnt lgkmcnt(3)
    v_exp_f32 v11, v11 clamp
    ds_read_b64_tr_b16 v[30:31], v2 offset:52224
    v_mfma_f32_16x16x32_bf16 v[80:83], v[20:23], v[160:163], v[80:83]
    v_max_f32 v45, s36, v45
    v_max_f32 v46, s36, v46
    ds_read_b64_tr_b16 v[16:17], v2 offset:55296
    v_mfma_f32_16x16x32_bf16 v[84:87], v[20:23], v[164:167], v[84:87]
    s_waitcnt lgkmcnt(3)
    v_max_f32 v47, s36, v47
    v_add_f32 v44, v44, v8
    ds_read_b64_tr_b16 v[18:19], v2 offset:56320
    v_mfma_f32_16x16x32_bf16 v[88:91], v[24:27], v[160:163], v[88:91]
    v_add_f32 v45, v45, v9
    v_add_f32 v46, v46, v10
    ds_read_b64_tr_b16 v[20:21], v3 offset:51200
    v_mfma_f32_16x16x32_bf16 v[92:95], v[24:27], v[164:167], v[92:95]
    s_waitcnt lgkmcnt(3)
    v_add_f32 v47, v47, v11
    v_cvt_pk_bf16_f32 v40, v40, v41
    ds_read_b64_tr_b16 v[22:23], v3 offset:52224
    v_mfma_f32_16x16x32_bf16 v[64:67], v[28:31], v[168:171], v[64:67]
    v_cvt_pk_bf16_f32 v41, v42, v43
    v_cvt_pk_bf16_f32 v42, v44, v45
    ds_read_b64_tr_b16 v[24:25], v3 offset:55296
    v_mfma_f32_16x16x32_bf16 v[68:71], v[28:31], v[172:175], v[68:71]
    s_waitcnt lgkmcnt(3)
    v_cvt_pk_bf16_f32 v43, v46, v47
    v_mul_f32 v8, s35, v56
    ds_read_b64_tr_b16 v[26:27], v3 offset:56320
    v_mfma_f32_16x16x32_bf16 v[72:75], v[16:19], v[168:171], v[72:75]
    v_mul_f32 v9, s35, v57
    v_mul_f32 v10, s35, v58
    ds_read_b64_tr_b16 v[28:29], v5 offset:49152
    v_mfma_f32_16x16x32_bf16 v[76:79], v[16:19], v[172:175], v[76:79]
    s_waitcnt lgkmcnt(3)
    v_mul_f32 v11, s35, v59
    v_max_f32 v56, s36, v56
    ds_read_b64_tr_b16 v[30:31], v5 offset:50176
    v_mfma_f32_16x16x32_bf16 v[80:83], v[20:23], v[168:171], v[80:83]
    v_add_u32 v5, 0x6000, v5
    v_max_f32 v57, s36, v57
    ds_read_b64_tr_b16 v[16:17], v5 offset:40960
    v_mfma_f32_16x16x32_bf16 v[84:87], v[20:23], v[172:175], v[84:87]
    s_waitcnt lgkmcnt(3)
    v_exp_f32 v8, v8 clamp
    ds_read_b64_tr_b16 v[18:19], v5 offset:41984
    v_mfma_f32_16x16x32_bf16 v[88:91], v[24:27], v[168:171], v[88:91]
    v_add_u32 v2, 0x6000, v2
    v_max_f32 v58, s36, v58
    ds_read_b64_tr_b16 v[20:21], v2 offset:40960
    v_mfma_f32_16x16x32_bf16 v[92:95], v[24:27], v[172:175], v[92:95]
    s_waitcnt lgkmcnt(3)
    v_exp_f32 v9, v9 clamp
    ds_read_b64_tr_b16 v[22:23], v2 offset:41984
    s_waitcnt vmcnt(1)
    v_mfma_f32_16x16x32_bf16 v[100:103], v[96:99], v[28:31], v[100:103]
    s_barrier
    s_waitcnt lgkmcnt(2)
    ds_read_b64_tr_b16 v[24:25], v2 offset:45056
    ds_read_b64_tr_b16 v[26:27], v2 offset:46080
    v_mfma_f32_16x16x32_bf16 v[100:103], v[96:99], v[16:19], v[100:103]
    s_waitcnt lgkmcnt(2)
    v_add_u32 v5, 0xffff4000, v5
    v_max_f32 v59, s36, v59
    ds_read_b64_tr_b16 v[28:29], v5 offset:0
    ds_read_b64_tr_b16 v[30:31], v5 offset:1024
    v_mfma_f32_16x16x32_bf16 v[64:67], v[20:23], v[176:179], v[64:67]
    v_exp_f32 v10, v10 clamp
    ds_read_b64_tr_b16 v[16:17], v2 offset:43008
    v_mfma_f32_16x16x32_bf16 v[68:71], v[20:23], v[180:183], v[68:71]
    s_waitcnt lgkmcnt(3)
    v_exp_f32 v11, v11 clamp
    ds_read_b64_tr_b16 v[18:19], v2 offset:44032
    v_mfma_f32_16x16x32_bf16 v[72:75], v[24:27], v[176:179], v[72:75]
    v_add_f32 v56, v56, v8
    v_add_f32 v57, v57, v9
    ds_read_b64_tr_b16 v[20:21], v2 offset:47104
    v_mfma_f32_16x16x32_bf16 v[76:79], v[24:27], v[180:183], v[76:79]
    s_waitcnt lgkmcnt(3)
    v_add_f32 v58, v58, v10
    v_add_f32 v59, v59, v11
    ds_read_b64_tr_b16 v[22:23], v2 offset:48128
    v_mfma_f32_16x16x32_bf16 v[100:103], v[96:99], v[28:31], v[100:103]
    s_waitcnt lgkmcnt(2)
    v_mul_f32 v8, s35, v60
    v_mul_f32 v9, s35, v61
    ds_read_b64_tr_b16 v[24:25], v5 offset:16384
    ds_read_b64_tr_b16 v[26:27], v5 offset:17408
    v_mfma_f32_16x16x32_bf16 v[64:67], v[16:19], v[184:187], v[64:67]
    v_add_u32 v2, 0xffff4000, v2
    v_mul_f32 v10, s35, v62
    ds_read_b64_tr_b16 v[28:29], v2 offset:0
    v_mfma_f32_16x16x32_bf16 v[68:71], v[16:19], v[188:191], v[68:71]
    s_waitcnt lgkmcnt(3)
    v_mul_f32 v11, s35, v63
    v_max_f32 v60, s36, v60
    ds_read_b64_tr_b16 v[30:31], v2 offset:1024
    v_mfma_f32_16x16x32_bf16 v[72:75], v[20:23], v[184:187], v[72:75]
    v_exp_f32 v8, v8 clamp
    ds_read_b64_tr_b16 v[16:17], v2 offset:4096
    v_mfma_f32_16x16x32_bf16 v[76:79], v[20:23], v[188:191], v[76:79]
    s_waitcnt lgkmcnt(3)
    v_exp_f32 v9, v9 clamp
    ds_read_b64_tr_b16 v[18:19], v2 offset:5120
    v_mfma_f32_16x16x32_bf16 v[100:103], v[96:99], v[24:27], v[100:103]
    s_waitcnt lgkmcnt(2)
    v_add_u32 v5, 0xffff6000, v5
    v_max_f32 v61, s36, v61
    ds_read_b64_tr_b16 v[20:21], v5 offset:0
    ds_read_b64_tr_b16 v[22:23], v5 offset:1024
    v_mfma_f32_16x16x32_bf16 v[64:67], v[28:31], v[192:195], v[64:67]
    v_exp_f32 v10, v10 clamp
    ds_read_b64_tr_b16 v[24:25], v2 offset:2048
    v_mfma_f32_16x16x32_bf16 v[68:71], v[28:31], v[196:199], v[68:71]
    s_waitcnt lgkmcnt(3)
    v_exp_f32 v11, v11 clamp
    ds_read_b64_tr_b16 v[26:27], v2 offset:3072
    v_mfma_f32_16x16x32_bf16 v[72:75], v[16:19], v[192:195], v[72:75]
    v_max_f32 v62, s36, v62
    v_max_f32 v63, s36, v63
    ds_read_b64_tr_b16 v[28:29], v2 offset:6144
    v_mfma_f32_16x16x32_bf16 v[76:79], v[16:19], v[196:199], v[76:79]
    s_waitcnt lgkmcnt(3)
    v_add_f32 v60, v60, v8
    v_add_f32 v61, v61, v9
    ds_read_b64_tr_b16 v[30:31], v2 offset:7168
    v_mfma_f32_16x16x32_bf16 v[100:103], v[96:99], v[20:23], v[100:103]
    s_waitcnt lgkmcnt(2)
    v_add_f32 v62, v62, v10
    v_add_f32 v63, v63, v11
    ds_read_b64_tr_b16 v[16:17], v5 offset:16384
    ds_read_b64_tr_b16 v[18:19], v5 offset:17408
    v_mfma_f32_16x16x32_bf16 v[64:67], v[24:27], v[200:203], v[64:67]
    v_cvt_pk_bf16_f32 v56, v56, v57
    v_cvt_pk_bf16_f32 v57, v58, v59
    ds_read_b64_tr_b16 v[20:21], v2 offset:16384
    v_mfma_f32_16x16x32_bf16 v[68:71], v[24:27], v[204:207], v[68:71]
    s_waitcnt lgkmcnt(3)
    v_cvt_pk_bf16_f32 v58, v60, v61
    v_cvt_pk_bf16_f32 v59, v62, v63
    ds_read_b64_tr_b16 v[22:23], v2 offset:17408
    v_mfma_f32_16x16x32_bf16 v[72:75], v[28:31], v[200:203], v[72:75]
    v_add_u32 v108, 32768, v108
    v_bfe_u32 v110, v4, 6, 2
    ds_read_b64_tr_b16 v[24:25], v2 offset:20480
    v_mfma_f32_16x16x32_bf16 v[44:47], v[40:43], v[48:51], 0
    s_nop 4
    v_mfma_f32_16x16x32_bf16 v[60:63], v[40:43], v[52:55], 0
    ds_write_b128 v108, v[56:59]
    s_nop 2
    v_mfma_f32_16x16x32_bf16 v[76:79], v[28:31], v[204:207], v[76:79]
    s_waitcnt lgkmcnt(4)
    v_lshlrev_b32 v110, 8, v110
    v_bfe_u32 v109, v4, 4, 2
    ds_read_b64_tr_b16 v[26:27], v2 offset:21504
    v_mfma_f32_16x16x32_bf16 v[40:43], v[56:59], v[48:51], 0
    v_lshl_add_u32 v110, v109, 1, v110
    v_add_u32 v110, s32, v110
    s_nop 1
    v_mfma_f32_16x16x32_bf16 v[48:51], v[56:59], v[52:55], 0
    v_add_u32 v110, 32768, v110
    v_bfe_u32 v111, v4, 8, 2
    ds_read_u16 v104, v110 offset:64
    ds_read_u16 v105, v110 offset:80
    v_mfma_f32_16x16x32_bf16 v[100:103], v[96:99], v[16:19], v[100:103]
    ds_read_b64_tr_b16 v[28:29], v2 offset:18432
    ds_read_b64_tr_b16 v[30:31], v2 offset:19456
    s_nop 0
    s_waitcnt lgkmcnt(7)
    v_mfma_f32_16x16x32_bf16 v[64:67], v[20:23], v[208:211], v[64:67]
    ds_read_b64_tr_b16 v[16:17], v2 offset:22528
    ds_read_u16 v106, v110 offset:72
    s_nop 1
    v_mfma_f32_16x16x32_bf16 v[68:71], v[20:23], v[212:215], v[68:71]
    ds_read_b64_tr_b16 v[18:19], v2 offset:23552
    ds_read_u16 v107, v110 offset:88
    s_nop 0
    s_waitcnt lgkmcnt(8)
    v_mfma_f32_16x16x32_bf16 v[72:75], v[24:27], v[208:211], v[72:75]
    v_add_u32 v2, 0xffff6000, v2
    ds_read_b64_tr_b16 v[20:21], v2 offset:0
    ds_read_b64_tr_b16 v[22:23], v2 offset:1024
    ds_write_b128 v108, v[44:47]
    v_bfe_u32 v109, v4, 4, 4
    v_mad_u32_u24 v108, v111, 3, v109
    v_lshlrev_b32 v108, 4, v108
    v_mov_b32 v110, 0xc0
    v_cmp_gt_u32 vcc, 3, v109
    v_lshlrev_b32 v109, 4, v109
    s_nop 0
    v_cndmask_b32 v108, v110, v108, vcc
    v_add_u32 v109, 0x100, v109
    s_add_u32 s53, s32, 155648
    v_cndmask_b32 v109, v110, v109, s[42:43]
    v_add_u32 v108, s53, v108
    v_add_u32 v109, s53, v109
    ds_write_b128 v108, v[60:63]
    ds_write_b64 v109, v[40:41]
    ds_write_b64 v109, v[48:49] offset:8
    s_waitcnt lgkmcnt(0)
    v_mfma_f32_16x16x32_bf16 v[76:79], v[24:27], v[212:215], v[76:79]
    s_barrier
    v_mfma_f32_16x16x32_bf16 v[64:67], v[28:31], v[216:219], v[64:67]
    v_lshrrev_b32 v1, 2, v4
    v_add_u32 v1, s3, v1
    ds_read_b64_tr_b16 v[24:25], v2 offset:4096
    ds_read_b32 v40, v1 offset:0
    v_mfma_f32_16x16x32_bf16 v[68:71], v[28:31], v[220:223], v[68:71]
    ds_read_b64_tr_b16 v[26:27], v2 offset:5120
    ds_read_b32 v41, v1 offset:1024
    s_nop 0
    v_mfma_f32_16x16x32_bf16 v[72:75], v[16:19], v[216:219], v[72:75]
    ds_read_b64_tr_b16 v[28:29], v2 offset:2048
    ds_read_b32 v42, v1 offset:2048
    s_nop 1
    v_mfma_f32_16x16x32_bf16 v[76:79], v[16:19], v[220:223], v[76:79]
    ds_read_b64_tr_b16 v[30:31], v2 offset:3072
    ds_read_b32 v43, v1 offset:3072
    s_nop 0
    v_mfma_f32_16x16x32_bf16 v[64:67], v[20:23], v[224:227], v[64:67]
    v_cvt_pk_bf16_f32 v96, v100, v100
    v_and_b32 v96, 0xffff0000, v96
    ds_read_b64_tr_b16 v[16:17], v2 offset:6144
    v_mfma_f32_16x16x32_bf16 v[68:71], v[20:23], v[228:231], v[68:71]
    s_waitcnt lgkmcnt(6)
    v_sub_f32 v96, v100, v96
    v_cvt_pk_bf16_f32 v96, v100, v96
    ds_read_b64_tr_b16 v[18:19], v2 offset:7168
    v_mfma_f32_16x16x32_bf16 v[72:75], v[24:27], v[224:227], v[72:75]
    v_mov_b32 v97, 0
    v_bfe_u32 v98, v4, 1, 7
    s_and_b32 s72, s32, 0xc00
    s_lshr_b32 s83, s32, 12
    ds_read_b64_tr_b16 v[20:21], v2 offset:16384
    v_mfma_f32_16x16x32_bf16 v[76:79], v[24:27], v[228:231], v[76:79]
    s_lshl_b32 s83, s83, 7
    s_add_u32 s72, s72, s83
    ds_read_b64_tr_b16 v[22:23], v2 offset:17408
    s_nop 0
    s_waitcnt lgkmcnt(5)
    v_mfma_f32_16x16x32_bf16 v[64:67], v[28:31], v[232:235], v[64:67]
    s_add_u32 s72, s72, 156416
    v_add_u32 v98, s72, v98
    ds_read_b64_tr_b16 v[24:25], v2 offset:20480
    ds_write_b64 v98, v[96:97]
    v_mfma_f32_16x16x32_bf16 v[68:71], v[28:31], v[236:239], v[68:71]
    ds_read_b64_tr_b16 v[26:27], v2 offset:21504
    ds_read_b32 v44, v1 offset:4096
    s_nop 0
    s_waitcnt lgkmcnt(6)
    v_mfma_f32_16x16x32_bf16 v[72:75], v[16:19], v[232:235], v[72:75]
    ds_read_b64_tr_b16 v[28:29], v2 offset:18432
    ds_read_b32 v45, v1 offset:5120
    s_nop 1
    v_mfma_f32_16x16x32_bf16 v[76:79], v[16:19], v[236:239], v[76:79]
    ds_read_b64_tr_b16 v[30:31], v2 offset:19456
    ds_read_b32 v46, v1 offset:6144
    s_nop 0
    s_waitcnt lgkmcnt(8)
    v_mfma_f32_16x16x32_bf16 v[64:67], v[20:23], v[240:243], v[64:67]
    ds_read_b64_tr_b16 v[16:17], v2 offset:22528
    ds_read_b32 v47, v1 offset:7168
    s_nop 1
    v_mfma_f32_16x16x32_bf16 v[68:71], v[20:23], v[244:247], v[68:71]
    ds_read_b64_tr_b16 v[18:19], v2 offset:23552
    s_nop 1
    s_waitcnt lgkmcnt(8)
    v_mfma_f32_16x16x32_bf16 v[72:75], v[24:27], v[240:243], v[72:75]
    v_add_u32 v3, 0x6000, v3
    ds_read_b64_tr_b16 v[20:21], v3 offset:40960
    v_mfma_f32_16x16x32_bf16 v[76:79], v[24:27], v[244:247], v[76:79]
    s_waitcnt lgkmcnt(5)
    v_add_f32 v40, v40, v41
    v_add_f32 v42, v42, v43
    ds_read_b64_tr_b16 v[22:23], v3 offset:41984
    v_mfma_f32_16x16x32_bf16 v[64:67], v[28:31], v[248:251], v[64:67]
    v_add_f32 v44, v44, v45
    s_waitcnt lgkmcnt(3)
    v_add_f32 v46, v46, v47
    ds_read_b64_tr_b16 v[24:25], v3 offset:45056
    v_mfma_f32_16x16x32_bf16 v[68:71], v[28:31], v[252:255], v[68:71]
    s_waitcnt lgkmcnt(3)
    v_add_f32 v40, v40, v42
    v_add_f32 v44, v44, v46
    ds_read_b64_tr_b16 v[26:27], v3 offset:46080
    v_mfma_f32_16x16x32_bf16 v[72:75], v[16:19], v[248:251], v[72:75]
    v_add_f32 v40, v40, v44
    v_min_u32 v40, -2, v40
    ds_read_b64_tr_b16 v[28:29], v3 offset:43008
    ds_read_b64_tr_b16 v[30:31], v3 offset:44032
    v_mfma_f32_16x16x32_bf16 v[76:79], v[16:19], v[252:255], v[76:79]
    s_barrier
    s_waitcnt lgkmcnt(4)
    v_mfma_f32_16x16x32_bf16 v[80:83], v[20:23], v[176:179], v[80:83]
    v_lshrrev_b32 v1, 2, v4
    ds_read_b64_tr_b16 v[16:17], v3 offset:47104
    v_mfma_f32_16x16x32_bf16 v[84:87], v[20:23], v[180:183], v[84:87]
    s_waitcnt lgkmcnt(3)
    ds_read_b64_tr_b16 v[18:19], v3 offset:48128
    buffer_store_dword v40, v1, s[8:11], s46 offen sc1
    v_mfma_f32_16x16x32_bf16 v[88:91], v[24:27], v[176:179], v[88:91]
    v_bfe_u32 v5, v4, 1, 8
    v_add_u32 v5, 0x18000, v5
    ds_read_b64 v[20:21], v5 offset:58112
    v_mfma_f32_16x16x32_bf16 v[92:95], v[24:27], v[180:183], v[92:95]
    v_mov_b32 v40, 0x3f803f80
    v_mov_b32 v41, 0x3f803f80
    s_nop 0
    s_waitcnt lgkmcnt(3)
    v_mfma_f32_16x16x32_bf16 v[80:83], v[28:31], v[184:187], v[80:83]
    v_mov_b32 v42, 0x3f803f80
    v_mov_b32 v43, 0x3f803f80
    ds_read_b64 v[24:25], v5 offset:60160
    v_mfma_f32_16x16x32_bf16 v[84:87], v[28:31], v[188:191], v[84:87]
    v_mul_f32 v8, s35, v32
    v_mul_f32 v9, s35, v33
    s_nop 0
    s_waitcnt lgkmcnt(2)
    v_mfma_f32_16x16x32_bf16 v[88:91], v[16:19], v[184:187], v[88:91]
    v_mul_f32 v10, s35, v34
    v_mul_f32 v11, s35, v35
    ds_read_b64 v[28:29], v5 offset:59136
    v_mfma_f32_16x16x32_bf16 v[92:95], v[16:19], v[188:191], v[92:95]
    v_exp_f32 v8, v8 clamp
    s_nop 0
    s_waitcnt lgkmcnt(2)
    v_mfma_f32_16x16x16_bf16 v[64:67], v[20:21], v[12:13], v[64:67]
    v_exp_f32 v9, v9 clamp
    ds_read_b64 v[16:17], v5 offset:61184
    v_mfma_f32_16x16x16_bf16 v[68:71], v[20:21], v[14:15], v[68:71]
    v_exp_f32 v10, v10 clamp
    s_nop 0
    s_waitcnt lgkmcnt(2)
    v_mfma_f32_16x16x16_bf16 v[72:75], v[24:25], v[12:13], v[72:75]
    v_add_u32 v3, 0xffff4000, v3
    v_max_f32 v32, s36, v32
    ds_read_b64_tr_b16 v[20:21], v3 offset:0
    v_mfma_f32_16x16x16_bf16 v[76:79], v[24:25], v[14:15], v[76:79]
    s_waitcnt lgkmcnt(2)
    v_exp_f32 v11, v11 clamp
    ds_read_b64_tr_b16 v[22:23], v3 offset:1024
    v_mfma_f32_16x16x16_bf16 v[80:83], v[28:29], v[12:13], v[80:83]
    v_max_f32 v33, s36, v33
    v_max_f32 v34, s36, v34
    ds_read_b64_tr_b16 v[24:25], v3 offset:4096
    v_mfma_f32_16x16x16_bf16 v[84:87], v[28:29], v[14:15], v[84:87]
    s_waitcnt lgkmcnt(3)
    v_max_f32 v35, s36, v35
    v_add_f32 v32, v32, v8
    ds_read_b64_tr_b16 v[26:27], v3 offset:5120
    v_mfma_f32_16x16x16_bf16 v[88:91], v[16:17], v[12:13], v[88:91]
    v_add_f32 v33, v33, v9
    v_add_f32 v34, v34, v10
    ds_read_b64_tr_b16 v[28:29], v3 offset:2048
    v_mfma_f32_16x16x16_bf16 v[92:95], v[16:17], v[14:15], v[92:95]
    s_waitcnt lgkmcnt(3)
    v_add_f32 v35, v35, v11
    v_cvt_pk_bf16_f32 v32, v32, v33
    ds_read_b64_tr_b16 v[30:31], v3 offset:3072
    v_mfma_f32_16x16x32_bf16 v[80:83], v[20:23], v[192:195], v[80:83]
    v_cvt_pk_bf16_f32 v33, v34, v35
    v_lshl_or_b32 v34, v105, 16, v104
    ds_read_b64_tr_b16 v[16:17], v3 offset:6144
    v_mfma_f32_16x16x32_bf16 v[84:87], v[20:23], v[196:199], v[84:87]
    s_waitcnt lgkmcnt(3)
    v_mov_b32 v35, 0
    v_lshrrev_b32 v108, 7, v4
    ds_read_b64_tr_b16 v[18:19], v3 offset:7168
    v_mfma_f32_16x16x32_bf16 v[88:91], v[24:27], v[192:195], v[88:91]
    v_lshlrev_b32 v108, 7, v108
    ds_read_b64_tr_b16 v[20:21], v3 offset:16384
    v_mfma_f32_16x16x32_bf16 v[92:95], v[24:27], v[196:199], v[92:95]
    s_waitcnt lgkmcnt(3)
    s_add_u32 s58, s51, 0
    ds_read_b64_tr_b16 v[22:23], v3 offset:17408
    buffer_load_dword v109, v108, s[8:11], s58 offen sc1
    v_mfma_f32_16x16x32_bf16 v[80:83], v[28:31], v[200:203], v[80:83]
    v_lshrrev_b32 v110, 7, v4
    v_lshlrev_b32 v110, 7, v110
    s_and_b32 s80, s2, 3
    s_lshl_b32 s80, s80, 13
    ds_read_b64_tr_b16 v[24:25], v3 offset:20480
    v_mfma_f32_16x16x32_bf16 v[84:87], v[28:31], v[204:207], v[84:87]
    s_add_u32 s80, s80, s32
    ds_read_b64_tr_b16 v[26:27], v3 offset:21504
    s_nop 1
    s_waitcnt lgkmcnt(4)
    v_mfma_f32_16x16x32_bf16 v[88:91], v[16:19], v[200:203], v[88:91]
    s_add_u32 s80, s80, 43024384
    ds_read_b64_tr_b16 v[28:29], v3 offset:18432
    buffer_load_dword v111, v110, s[8:11], s80 offen sc1
    v_mfma_f32_16x16x32_bf16 v[92:95], v[16:19], v[204:207], v[92:95]
    s_waitcnt lgkmcnt(3)
    v_mul_f32 v8, s35, v36
    v_mul_f32 v9, s35, v37
    ds_read_b64_tr_b16 v[30:31], v3 offset:19456
    v_mfma_f32_16x16x32_bf16 v[80:83], v[20:23], v[208:211], v[80:83]
    v_mul_f32 v10, s35, v38
    v_mul_f32 v11, s35, v39
    ds_read_b64_tr_b16 v[16:17], v3 offset:22528
    v_mfma_f32_16x16x32_bf16 v[84:87], v[20:23], v[212:215], v[84:87]
    s_waitcnt lgkmcnt(3)
    v_exp_f32 v8, v8 clamp
    ds_read_b64_tr_b16 v[18:19], v3 offset:23552
    v_mfma_f32_16x16x32_bf16 v[88:91], v[24:27], v[208:211], v[88:91]
    v_add_u32 v3, 0xffff6000, v3
    v_max_f32 v36, s36, v36
    ds_read_b64_tr_b16 v[20:21], v3 offset:0
    v_mfma_f32_16x16x32_bf16 v[92:95], v[24:27], v[212:215], v[92:95]
    s_waitcnt lgkmcnt(3)
    v_exp_f32 v9, v9 clamp
    ds_read_b64_tr_b16 v[22:23], v3 offset:1024
    v_mfma_f32_16x16x32_bf16 v[80:83], v[28:31], v[216:219], v[80:83]
    v_exp_f32 v10, v10 clamp
    ds_read_b64_tr_b16 v[24:25], v3 offset:4096
    v_mfma_f32_16x16x32_bf16 v[84:87], v[28:31], v[220:223], v[84:87]
    s_waitcnt lgkmcnt(3)
    v_exp_f32 v11, v11 clamp
    ds_read_b64_tr_b16 v[26:27], v3 offset:5120
    v_mfma_f32_16x16x32_bf16 v[88:91], v[16:19], v[216:219], v[88:91]
    v_max_f32 v37, s36, v37
    v_max_f32 v38, s36, v38
    ds_read_b64_tr_b16 v[28:29], v3 offset:2048
    v_mfma_f32_16x16x32_bf16 v[92:95], v[16:19], v[220:223], v[92:95]
    s_waitcnt lgkmcnt(3)
    v_max_f32 v39, s36, v39
    v_add_f32 v36, v36, v8
    ds_read_b64_tr_b16 v[30:31], v3 offset:3072
    v_mfma_f32_16x16x32_bf16 v[80:83], v[20:23], v[224:227], v[80:83]
    v_add_f32 v37, v37, v9
    v_add_f32 v38, v38, v10
    ds_read_b64_tr_b16 v[16:17], v3 offset:6144
    v_mfma_f32_16x16x32_bf16 v[84:87], v[20:23], v[228:231], v[84:87]
    s_waitcnt lgkmcnt(3)
    v_add_f32 v39, v39, v11
    v_cvt_pk_bf16_f32 v36, v36, v37
    ds_read_b64_tr_b16 v[18:19], v3 offset:7168
    v_mfma_f32_16x16x32_bf16 v[88:91], v[24:27], v[224:227], v[88:91]
    v_cvt_pk_bf16_f32 v37, v38, v39
    v_lshl_or_b32 v38, v107, 16, v106
    ds_read_b64_tr_b16 v[20:21], v3 offset:16384
    v_mfma_f32_16x16x32_bf16 v[92:95], v[24:27], v[228:231], v[92:95]
    s_waitcnt lgkmcnt(3)
    v_mov_b32 v39, 0
    v_mov_b32 v48, -1
    ds_read_b64_tr_b16 v[22:23], v3 offset:17408
    v_mfma_f32_16x16x32_bf16 v[80:83], v[28:31], v[232:235], v[80:83]
    v_mov_b32 v49, -1
    v_mov_b32 v50, -1
    ds_read_b64_tr_b16 v[24:25], v3 offset:20480
    v_mfma_f32_16x16x32_bf16 v[84:87], v[28:31], v[236:239], v[84:87]
    s_waitcnt lgkmcnt(3)
    v_mov_b32 v51, -1
    v_mul_f32 v8, v64, v64
    ds_read_b64_tr_b16 v[26:27], v3 offset:21504
    v_mfma_f32_16x16x32_bf16 v[88:91], v[16:19], v[232:235], v[88:91]
    v_mul_f32 v9, v65, v65
    ds_read_b64_tr_b16 v[28:29], v3 offset:18432
    v_mfma_f32_16x16x32_bf16 v[92:95], v[16:19], v[236:239], v[92:95]
    s_waitcnt lgkmcnt(3)
    ds_read_b64_tr_b16 v[30:31], v3 offset:19456
    buffer_store_dwordx4 v[48:51], v4, s[8:11], s49 offen offset:0 sc1
    v_mfma_f32_16x16x32_bf16 v[80:83], v[20:23], v[240:243], v[80:83]
    v_mul_f32 v10, v66, v66
    v_mul_f32 v11, v67, v67
    ds_read_b64_tr_b16 v[16:17], v3 offset:22528
    v_mfma_f32_16x16x32_bf16 v[84:87], v[20:23], v[244:247], v[84:87]
    s_waitcnt lgkmcnt(3)
    v_fma_f32 v8, v8, v0, v13
    v_fma_f32 v9, v9, v0, v13
    ds_read_b64_tr_b16 v[18:19], v3 offset:23552
    v_mfma_f32_16x16x32_bf16 v[88:91], v[24:27], v[240:243], v[88:91]
    v_add_u32 v2, 0x12000, v2
    v_fma_f32 v10, v10, v0, v13
    ds_read_b64_tr_b16 v[20:21], v2 offset:0
    v_mfma_f32_16x16x32_bf16 v[92:95], v[24:27], v[244:247], v[92:95]
    s_waitcnt lgkmcnt(3)
    v_fma_f32 v11, v11, v0, v13
    v_mul_f32 v8, v64, v8
    ds_read_b64_tr_b16 v[22:23], v2 offset:1024
    v_mfma_f32_16x16x32_bf16 v[80:83], v[28:31], v[248:251], v[80:83]
    v_mul_f32 v9, v65, v9
    v_mul_f32 v10, v66, v10
    ds_read_b64_tr_b16 v[24:25], v2 offset:4096
    v_mfma_f32_16x16x32_bf16 v[84:87], v[28:31], v[252:255], v[84:87]
    s_waitcnt lgkmcnt(3)
    v_mul_f32 v11, v67, v11
    v_mul_f32 v72, v64, v72
    ds_read_b64_tr_b16 v[26:27], v2 offset:5120
    v_mfma_f32_16x16x32_bf16 v[88:91], v[16:19], v[248:251], v[88:91]
    v_add_u32 v3, 0x12000, v3
    v_mul_f32 v73, v65, v73
    ds_read_b64_tr_b16 v[28:29], v3 offset:0
    ds_read_b64_tr_b16 v[30:31], v3 offset:1024
    v_exp_f32 v8, v8
    v_exp_f32 v9, v9
    v_exp_f32 v10, v10
    v_exp_f32 v11, v11
    v_mul_f32 v74, v66, v74
    v_mul_f32 v75, v67, v75
    v_add_f32 v8, 1.0, v8
    v_add_f32 v9, 1.0, v9
    v_add_f32 v10, 1.0, v10
    v_add_f32 v11, 1.0, v11
    buffer_store_dwordx4 v[48:51], v4, s[8:11], s49 offen offset:1024 sc1
    v_rcp_f32 v8, v8
    v_rcp_f32 v9, v9
    v_rcp_f32 v10, v10
    v_rcp_f32 v11, v11
    v_mul_f32 v72, v72, v8
    v_mul_f32 v73, v73, v9
    v_mul_f32 v74, v74, v10
    v_mul_f32 v75, v75, v11
    v_cvt_pk_bf16_f32 v64, v72, v73
    v_cvt_pk_bf16_f32 v65, v74, v75
    v_mul_f32 v8, v68, v68
    v_mul_f32 v9, v69, v69
    v_mul_f32 v10, v70, v70
    v_mul_f32 v11, v71, v71
    v_fma_f32 v8, v8, v7, v15
    v_fma_f32 v9, v9, v7, v15
    v_fma_f32 v10, v10, v7, v15
    v_fma_f32 v11, v11, v7, v15
    v_mul_f32 v8, v68, v8
    v_mul_f32 v9, v69, v9
    v_mul_f32 v10, v70, v10
    v_mul_f32 v11, v71, v11
    buffer_store_dwordx4 v[48:51], v4, s[8:11], s49 offen offset:2048 sc1
    v_exp_f32 v8, v8
    v_exp_f32 v9, v9
    v_exp_f32 v10, v10
    v_exp_f32 v11, v11
    v_mul_f32 v76, v68, v76
    v_mul_f32 v77, v69, v77
    v_mul_f32 v78, v70, v78
    v_mul_f32 v79, v71, v79
    v_add_f32 v8, 1.0, v8
    v_add_f32 v9, 1.0, v9
    v_add_f32 v10, 1.0, v10
    v_add_f32 v11, 1.0, v11
    v_rcp_f32 v8, v8
    v_rcp_f32 v9, v9
    v_rcp_f32 v10, v10
    v_rcp_f32 v11, v11
    v_mul_f32 v76, v76, v8
    v_mul_f32 v77, v77, v9
    v_mul_f32 v78, v78, v10
    v_mul_f32 v79, v79, v11
    v_cvt_pk_bf16_f32 v68, v76, v77
    v_cvt_pk_bf16_f32 v69, v78, v79
    s_waitcnt vmcnt(3)
    v_cmp_ne_u32 vcc, s54, v111
    s_nop 4
    s_cbranch_vccnz L_sl2
L_bk2:
    v_cmp_ne_u32 vcc, s54, v109
    s_nop 4
    s_cbranch_vccnz L_sl3
L_bk3:
    v_mfma_f32_16x16x32_bf16 v[92:95], v[16:19], v[252:255], v[92:95]
    s_barrier
    s_waitcnt lgkmcnt(4)
    v_mfma_f32_16x16x32_bf16 v[96:99], v[20:23], v[112:115], 0
    s_add_u32 m0, s32, 90112
    v_mul_f32 v8, v80, v80
    v_mul_f32 v9, v81, v81
    s_add_u32 s25, s64, 0
    ds_read_b64_tr_b16 v[16:17], v3 offset:4096
    v_mfma_f32_16x16x32_bf16 v[100:103], v[20:23], v[116:119], 0
    s_waitcnt lgkmcnt(3)
    v_mul_f32 v10, v82, v82
    v_mul_f32 v11, v83, v83
    ds_read_b64_tr_b16 v[18:19], v3 offset:5120
    v_mfma_f32_16x16x32_bf16 v[104:107], v[24:27], v[112:115], 0
    v_xor_b32 v5, s34, v2
    ds_read_b64_tr_b16 v[20:21], v5 offset:0
    ds_read_b64_tr_b16 v[22:23], v5 offset:1024
    buffer_load_dwordx4 v4, s[8:11], s25 offen sc1 lds
    v_mfma_f32_16x16x32_bf16 v[108:111], v[24:27], v[116:119], 0
    s_waitcnt lgkmcnt(4)
    v_fma_f32 v8, v8, v0, v13
    v_fma_f32 v9, v9, v0, v13
    s_add_u32 m0, s32, 106496
    s_add_u32 s26, s64, 4096
    v_mfma_f32_16x16x32_bf16 v[48:51], v[28:31], v[112:115], 0
    ds_read_b64_tr_b16 v[24:25], v2 offset:2048
    ds_read_b64_tr_b16 v[26:27], v2 offset:3072
    buffer_load_dwordx4 v4, s[8:11], s26 offen sc1 lds
    v_mfma_f32_16x16x32_bf16 v[52:55], v[28:31], v[116:119], 0
    s_waitcnt lgkmcnt(4)
    v_fma_f32 v10, v10, v0, v13
    v_fma_f32 v11, v11, v0, v13
    s_add_u32 m0, s32, 122880
    s_add_u32 s27, s64, 8192
    v_mfma_f32_16x16x32_bf16 v[56:59], v[16:19], v[112:115], 0
    ds_read_b64_tr_b16 v[28:29], v2 offset:6144
    ds_read_b64_tr_b16 v[30:31], v2 offset:7168
    buffer_load_dwordx4 v4, s[8:11], s27 offen sc1 lds
    v_mfma_f32_16x16x32_bf16 v[60:63], v[16:19], v[116:119], 0
    v_mul_f32 v8, v80, v8
    v_mul_f32 v9, v81, v9
    s_nop 0
    s_waitcnt lgkmcnt(4)
    v_mfma_f32_16x16x32_bf16 v[44:47], v[40:43], v[20:23], 0
    s_waitcnt lgkmcnt(2)
    v_mul_f32 v10, v82, v10
    v_mul_f32 v11, v83, v11
    ds_read_b64_tr_b16 v[16:17], v3 offset:2048
    ds_read_b64_tr_b16 v[18:19], v3 offset:3072
    v_mfma_f32_16x16x32_bf16 v[96:99], v[24:27], v[120:123], v[96:99]
    s_add_u32 m0, s32, 139264
    v_exp_f32 v8, v8
    s_add_u32 s28, s64, 12288
    ds_read_b64_tr_b16 v[20:21], v3 offset:6144
    v_mfma_f32_16x16x32_bf16 v[100:103], v[24:27], v[124:127], v[100:103]
    s_waitcnt lgkmcnt(3)
    v_exp_f32 v9, v9
    ds_read_b64_tr_b16 v[22:23], v3 offset:7168
    v_mfma_f32_16x16x32_bf16 v[104:107], v[28:31], v[120:123], v[104:107]
    ds_read_b64_tr_b16 v[24:25], v2 offset:16384
    ds_read_b64_tr_b16 v[26:27], v2 offset:17408
    buffer_load_dwordx4 v4, s[8:11], s28 offen sc1 lds
    v_mfma_f32_16x16x32_bf16 v[108:111], v[28:31], v[124:127], v[108:111]
    v_exp_f32 v10, v10
    s_nop 0
    s_waitcnt lgkmcnt(4)
    v_mfma_f32_16x16x32_bf16 v[48:51], v[16:19], v[120:123], v[48:51]
    s_add_u32 m0, s32, 49152
    v_exp_f32 v11, v11
    s_add_u32 s29, s64, 16384
    ds_read_b64_tr_b16 v[28:29], v2 offset:20480
    v_mfma_f32_16x16x32_bf16 v[52:55], v[16:19], v[124:127], v[52:55]
    s_waitcnt lgkmcnt(3)
    v_mul_f32 v88, v80, v88
    v_mul_f32 v89, v81, v89
    ds_read_b64_tr_b16 v[30:31], v2 offset:21504
    v_mfma_f32_16x16x32_bf16 v[56:59], v[20:23], v[120:123], v[56:59]
    ds_read_b64_tr_b16 v[16:17], v3 offset:16384
    ds_read_b64_tr_b16 v[18:19], v3 offset:17408
    buffer_load_dwordx4 v4, s[8:11], s29 offen sc1 lds
    v_mfma_f32_16x16x32_bf16 v[60:63], v[20:23], v[124:127], v[60:63]
    v_mul_f32 v90, v82, v90
    v_mul_f32 v91, v83, v91
    s_nop 0
    s_waitcnt lgkmcnt(4)
    v_mfma_f32_16x16x32_bf16 v[96:99], v[24:27], v[128:131], v[96:99]
    s_add_u32 m0, s32, 65536
    v_add_f32 v8, 1.0, v8
    v_add_f32 v9, 1.0, v9
    s_add_u32 s24, s64, 20480
    ds_read_b64_tr_b16 v[20:21], v3 offset:20480
    v_mfma_f32_16x16x32_bf16 v[100:103], v[24:27], v[132:135], v[100:103]
    s_waitcnt lgkmcnt(3)
    v_add_f32 v10, 1.0, v10
    v_add_f32 v11, 1.0, v11
    ds_read_b64_tr_b16 v[22:23], v3 offset:21504
    v_mfma_f32_16x16x32_bf16 v[104:107], v[28:31], v[128:131], v[104:107]
    ds_read_b64_tr_b16 v[24:25], v5 offset:16384
    ds_read_b64_tr_b16 v[26:27], v5 offset:17408
    buffer_load_dwordx4 v4, s[8:11], s24 offen sc1 lds
    v_mfma_f32_16x16x32_bf16 v[108:111], v[28:31], v[132:135], v[108:111]
    v_rcp_f32 v8, v8
    s_nop 0
    s_waitcnt lgkmcnt(4)
    v_mfma_f32_16x16x32_bf16 v[48:51], v[16:19], v[128:131], v[48:51]
    s_add_u32 m0, s32, 8192
    v_rcp_f32 v9, v9
    s_add_u32 s25, s64, 24576
    ds_read_b64_tr_b16 v[28:29], v2 offset:18432
    v_mfma_f32_16x16x32_bf16 v[52:55], v[16:19], v[132:135], v[52:55]
    s_waitcnt lgkmcnt(3)
    v_rcp_f32 v10, v10
    ds_read_b64_tr_b16 v[30:31], v2 offset:19456
    v_mfma_f32_16x16x32_bf16 v[56:59], v[20:23], v[128:131], v[56:59]
    ds_read_b64_tr_b16 v[16:17], v2 offset:22528
    ds_read_b64_tr_b16 v[18:19], v2 offset:23552
    buffer_load_dwordx4 v4, s[8:11], s25 offen sc1 lds
    v_mfma_f32_16x16x32_bf16 v[60:63], v[20:23], v[132:135], v[60:63]
    v_rcp_f32 v11, v11
    s_nop 0
    s_waitcnt lgkmcnt(4)
    v_mfma_f32_16x16x32_bf16 v[44:47], v[40:43], v[24:27], v[44:47]
    s_waitcnt lgkmcnt(2)
    v_mul_f32 v88, v88, v8
    v_mul_f32 v89, v89, v9
    s_add_u32 s26, s62, 8192
    ds_read_b64_tr_b16 v[20:21], v3 offset:18432
    ds_read_b64_tr_b16 v[22:23], v3 offset:19456
    v_mfma_f32_16x16x32_bf16 v[96:99], v[28:31], v[136:139], v[96:99]
    ds_read_b64_tr_b16 v[24:25], v3 offset:22528
    ds_read_b64_tr_b16 v[26:27], v3 offset:23552
    buffer_load_dwordx4 v[128:131], v4, s[8:11], s26 offen offset:2048 sc1
    v_mfma_f32_16x16x32_bf16 v[100:103], v[28:31], v[140:143], v[100:103]
    v_mul_f32 v90, v90, v10
    v_mul_f32 v91, v91, v11
    s_nop 0
    s_waitcnt lgkmcnt(4)
    v_mfma_f32_16x16x32_bf16 v[104:107], v[16:19], v[136:139], v[104:107]
    v_cvt_pk_bf16_f32 v66, v88, v89
    v_cvt_pk_bf16_f32 v67, v90, v91
    ds_read_b64_tr_b16 v[28:29], v2 offset:32768
    v_mfma_f32_16x16x32_bf16 v[108:111], v[16:19], v[140:143], v[108:111]
    s_waitcnt lgkmcnt(3)
    s_add_u32 s30, s33, 0
    ds_read_b64_tr_b16 v[30:31], v2 offset:33792
    buffer_store_dwordx4 v[64:67], v4, s[8:11], s30 offen offset:2048 sc1
    v_mfma_f32_16x16x32_bf16 v[48:51], v[20:23], v[136:139], v[48:51]
    v_lshrrev_b32 v120, 2, v4
    ds_read_b64_tr_b16 v[16:17], v2 offset:36864
    v_mfma_f32_16x16x32_bf16 v[52:55], v[20:23], v[140:143], v[52:55]
    s_waitcnt lgkmcnt(3)
    s_add_u32 s30, s47, 0
    ds_read_b64_tr_b16 v[18:19], v2 offset:37888
    buffer_load_dword v112, v120, s[8:11], s30 offen offset:0 sc1
    v_mfma_f32_16x16x32_bf16 v[56:59], v[24:27], v[136:139], v[56:59]
    ds_read_b64_tr_b16 v[20:21], v3 offset:32768
    ds_read_b64_tr_b16 v[22:23], v3 offset:33792
    buffer_load_dword v113, v120, s[8:11], s30 offen offset:1536 sc1
    v_mfma_f32_16x16x32_bf16 v[60:63], v[24:27], v[140:143], v[60:63]
    s_barrier
    s_waitcnt lgkmcnt(4)
    v_mfma_f32_16x16x32_bf16 v[96:99], v[28:31], v[144:147], v[96:99]
    ds_read_b64_tr_b16 v[24:25], v3 offset:36864
    buffer_load_dword v114, v120, s[8:11], s30 offen offset:3072 sc1
    v_mfma_f32_16x16x32_bf16 v[100:103], v[28:31], v[148:151], v[100:103]
    s_waitcnt lgkmcnt(3)
    s_add_u32 s31, s47, 4608
    ds_read_b64_tr_b16 v[26:27], v3 offset:37888
    buffer_load_dword v115, v120, s[8:11], s31 offen offset:0 sc1
    v_mfma_f32_16x16x32_bf16 v[104:107], v[16:19], v[144:147], v[104:107]
    ds_read_b64_tr_b16 v[28:29], v5 offset:32768
    buffer_load_dword v116, v120, s[8:11], s31 offen offset:1536 sc1
    v_mfma_f32_16x16x32_bf16 v[108:111], v[16:19], v[148:151], v[108:111]
    s_waitcnt lgkmcnt(3)
    ds_read_b64_tr_b16 v[30:31], v5 offset:33792
    buffer_load_dword v117, v120, s[8:11], s31 offen offset:3072 sc1
    v_mfma_f32_16x16x32_bf16 v[48:51], v[20:23], v[144:147], v[48:51]
    s_add_u32 s30, s47, 9216
    ds_read_b64_tr_b16 v[16:17], v2 offset:34816
    buffer_load_dword v118, v120, s[8:11], s30 offen offset:0 sc1
    v_mfma_f32_16x16x32_bf16 v[52:55], v[20:23], v[148:151], v[52:55]
    s_waitcnt lgkmcnt(3)
    ds_read_b64_tr_b16 v[18:19], v2 offset:35840
    buffer_load_dword v119, v120, s[8:11], s30 offen offset:1536 sc1
    v_mfma_f32_16x16x32_bf16 v[56:59], v[24:27], v[144:147], v[56:59]
    v_mul_f32 v8, v84, v84
    v_mul_f32 v9, v85, v85
    ds_read_b64_tr_b16 v[20:21], v2 offset:38912
    v_mfma_f32_16x16x32_bf16 v[60:63], v[24:27], v[148:151], v[60:63]
    s_waitcnt lgkmcnt(3)
    v_mul_f32 v10, v86, v86
    v_mul_f32 v11, v87, v87
    ds_read_b64_tr_b16 v[22:23], v2 offset:39936
    v_mfma_f32_16x16x32_bf16 v[44:47], v[40:43], v[28:31], v[44:47]
    s_waitcnt lgkmcnt(2)
    v_fma_f32 v8, v8, v7, v15
    v_fma_f32 v9, v9, v7, v15
    ds_read_b64_tr_b16 v[24:25], v3 offset:34816
    ds_read_b64_tr_b16 v[26:27], v3 offset:35840
    v_mfma_f32_16x16x32_bf16 v[96:99], v[16:19], v[152:155], v[96:99]
    v_fma_f32 v10, v10, v7, v15
    v_fma_f32 v11, v11, v7, v15
    ds_read_b64_tr_b16 v[28:29], v3 offset:38912
    v_mfma_f32_16x16x32_bf16 v[100:103], v[16:19], v[156:159], v[100:103]
    s_waitcnt lgkmcnt(3)
    v_mul_f32 v8, v84, v8
    v_mul_f32 v9, v85, v9
    ds_read_b64_tr_b16 v[30:31], v3 offset:39936
    v_mfma_f32_16x16x32_bf16 v[104:107], v[20:23], v[152:155], v[104:107]
    v_mul_f32 v10, v86, v10
    v_mul_f32 v11, v87, v11
    ds_read_b64_tr_b16 v[16:17], v2 offset:49152
    v_mfma_f32_16x16x32_bf16 v[108:111], v[20:23], v[156:159], v[108:111]
    s_waitcnt lgkmcnt(3)
    v_exp_f32 v8, v8
    ds_read_b64_tr_b16 v[18:19], v2 offset:50176
    v_mfma_f32_16x16x32_bf16 v[48:51], v[24:27], v[152:155], v[48:51]
    v_exp_f32 v9, v9
    ds_read_b64_tr_b16 v[20:21], v2 offset:53248
    v_mfma_f32_16x16x32_bf16 v[52:55], v[24:27], v[156:159], v[52:55]
    s_waitcnt lgkmcnt(3)
    v_exp_f32 v10, v10
    ds_read_b64_tr_b16 v[22:23], v2 offset:54272
    v_mfma_f32_16x16x32_bf16 v[56:59], v[28:31], v[152:155], v[56:59]
    s_add_u32 s27, s63, 8192
    v_exp_f32 v11, v11
    ds_read_b64_tr_b16 v[24:25], v3 offset:49152
    v_mfma_f32_16x16x32_bf16 v[60:63], v[28:31], v[156:159], v[60:63]
    s_waitcnt lgkmcnt(3)
    v_mul_f32 v92, v84, v92
    v_mul_f32 v93, v85, v93
    ds_read_b64_tr_b16 v[26:27], v3 offset:50176
    v_mfma_f32_16x16x32_bf16 v[96:99], v[16:19], v[160:163], v[96:99]
    ds_read_b64_tr_b16 v[28:29], v3 offset:53248
    ds_read_b64_tr_b16 v[30:31], v3 offset:54272
    buffer_load_dwordx4 v[132:135], v4, s[8:11], s27 offen offset:2048 sc1
    v_mfma_f32_16x16x32_bf16 v[100:103], v[16:19], v[164:167], v[100:103]
    v_mul_f32 v94, v86, v94
    v_mul_f32 v95, v87, v95
    s_nop 0
    s_waitcnt lgkmcnt(4)
    v_mfma_f32_16x16x32_bf16 v[104:107], v[20:23], v[160:163], v[104:107]
    s_add_u32 s28, s62, 12288
    v_add_f32 v8, 1.0, v8
    v_add_f32 v9, 1.0, v9
    ds_read_b64_tr_b16 v[16:17], v5 offset:49152
    v_mfma_f32_16x16x32_bf16 v[108:111], v[20:23], v[164:167], v[108:111]
    s_waitcnt lgkmcnt(3)
    v_add_f32 v10, 1.0, v10
    v_add_f32 v11, 1.0, v11
    ds_read_b64_tr_b16 v[18:19], v5 offset:50176
    v_mfma_f32_16x16x32_bf16 v[48:51], v[24:27], v[160:163], v[48:51]
    ds_read_b64_tr_b16 v[20:21], v2 offset:51200
    ds_read_b64_tr_b16 v[22:23], v2 offset:52224
    buffer_load_dwordx4 v[136:139], v4, s[8:11], s28 offen offset:3072 sc1
    v_mfma_f32_16x16x32_bf16 v[52:55], v[24:27], v[164:167], v[52:55]
    v_rcp_f32 v8, v8
    s_nop 0
    s_waitcnt lgkmcnt(4)
    v_mfma_f32_16x16x32_bf16 v[56:59], v[28:31], v[160:163], v[56:59]
    s_add_u32 s29, s63, 12288
    v_rcp_f32 v9, v9
    ds_read_b64_tr_b16 v[24:25], v2 offset:55296
    v_mfma_f32_16x16x32_bf16 v[60:63], v[28:31], v[164:167], v[60:63]
    s_waitcnt lgkmcnt(3)
    v_rcp_f32 v10, v10
    ds_read_b64_tr_b16 v[26:27], v2 offset:56320
    v_mfma_f32_16x16x32_bf16 v[44:47], v[40:43], v[16:19], v[44:47]
    s_waitcnt lgkmcnt(2)
    v_rcp_f32 v11, v11
    ds_read_b64_tr_b16 v[28:29], v3 offset:51200
    ds_read_b64_tr_b16 v[30:31], v3 offset:52224
    v_mfma_f32_16x16x32_bf16 v[96:99], v[20:23], v[168:171], v[96:99]
    ds_read_b64_tr_b16 v[16:17], v3 offset:55296
    ds_read_b64_tr_b16 v[18:19], v3 offset:56320
    buffer_load_dwordx4 v[140:143], v4, s[8:11], s29 offen offset:3072 sc1
    v_mfma_f32_16x16x32_bf16 v[100:103], v[20:23], v[172:175], v[100:103]
    s_waitcnt lgkmcnt(4)
    v_mul_f32 v92, v92, v8
    v_mul_f32 v93, v93, v9
    s_add_u32 m0, s32, 24576
    s_add_u32 s24, s64, 28672
    v_mfma_f32_16x16x32_bf16 v[104:107], v[24:27], v[168:171], v[104:107]
    v_add_u32 v5, 0x4000, v5
    ds_read_b64_tr_b16 v[20:21], v5 offset:49152
    ds_read_b64_tr_b16 v[22:23], v5 offset:50176
    buffer_load_dwordx4 v4, s[8:11], s24 offen sc1 lds
    v_mfma_f32_16x16x32_bf16 v[108:111], v[24:27], v[172:175], v[108:111]
    v_mul_f32 v94, v94, v10
    v_mul_f32 v95, v95, v11
    s_nop 0
    s_waitcnt lgkmcnt(4)
    v_mfma_f32_16x16x32_bf16 v[48:51], v[28:31], v[168:171], v[48:51]
    v_add_u32 v2, 0x4000, v2
    v_cvt_pk_bf16_f32 v70, v92, v93
    ds_read_b64_tr_b16 v[24:25], v2 offset:49152
    v_mfma_f32_16x16x32_bf16 v[52:55], v[28:31], v[172:175], v[52:55]
    s_waitcnt lgkmcnt(3)
    v_cvt_pk_bf16_f32 v71, v94, v95
    ds_read_b64_tr_b16 v[26:27], v2 offset:50176
    v_mfma_f32_16x16x32_bf16 v[56:59], v[16:19], v[168:171], v[56:59]
    s_add_u32 s30, s33, 163840
    ds_read_b64_tr_b16 v[28:29], v2 offset:53248
    buffer_store_dwordx4 v[68:71], v4, s[8:11], s30 offen offset:2048 sc1
    v_mfma_f32_16x16x32_bf16 v[60:63], v[16:19], v[172:175], v[60:63]
    s_waitcnt lgkmcnt(3)
    s_waitcnt vmcnt(10)
    v_max3_u32 v121, v112, v113, v114
    s_waitcnt vmcnt(7)
    v_max3_u32 v122, v115, v116, v117
    ds_read_b64_tr_b16 v[30:31], v2 offset:54272
    v_mfma_f32_16x16x32_bf16 v[44:47], v[40:43], v[20:23], v[44:47]
    s_waitcnt lgkmcnt(2)
    v_add_u32 v5, 0xffff6000, v5
    s_waitcnt vmcnt(5)
    v_max3_u32 v121, v121, v118, v119
    ds_read_b64_tr_b16 v[16:17], v5 offset:0
    ds_read_b64_tr_b16 v[18:19], v5 offset:1024
    v_mfma_f32_16x16x32_bf16 v[96:99], v[24:27], v[176:179], v[96:99]
    s_add_u32 m0, s32, 81920
    v_max_u32 v121, v121, v122
    v_cmp_eq_u32 vcc, -1, v121
    s_add_u32 s25, s64, 32768
    ds_read_b64_tr_b16 v[20:21], v2 offset:51200
    v_mfma_f32_16x16x32_bf16 v[100:103], v[24:27], v[180:183], v[100:103]
    ds_read_b64_tr_b16 v[22:23], v2 offset:52224
    s_nop 0
    s_cbranch_vccnz L_sl8
L_bk8:
    s_nop 0
    s_waitcnt lgkmcnt(4)
    v_mfma_f32_16x16x32_bf16 v[104:107], v[28:31], v[176:179], v[104:107]
    ds_read_b64_tr_b16 v[24:25], v2 offset:55296
    ds_read_b64_tr_b16 v[26:27], v2 offset:56320
    buffer_load_dwordx4 v4, s[8:11], s25 offen sc1 lds
    v_mfma_f32_16x16x32_bf16 v[108:111], v[28:31], v[180:183], v[108:111]
    v_add_f32 v112, v112, v113
    v_add_f32 v114, v114, v115
    s_nop 0
    s_waitcnt lgkmcnt(4)
    v_mfma_f32_16x16x32_bf16 v[44:47], v[40:43], v[16:19], v[44:47]
    s_waitcnt lgkmcnt(2)
    v_add_u32 v5, 0xffff2000, v5
    v_add_f32 v116, v116, v117
    s_add_u32 s26, s62, 0
    ds_read_b64_tr_b16 v[28:29], v5 offset:0
    ds_read_b64_tr_b16 v[30:31], v5 offset:1024
    v_mfma_f32_16x16x32_bf16 v[96:99], v[20:23], v[184:187], v[96:99]
    v_add_u32 v2, 0xffff6000, v2
    ds_read_b64_tr_b16 v[16:17], v2 offset:0
    ds_read_b64_tr_b16 v[18:19], v2 offset:1024
    buffer_load_dwordx4 v[144:147], v4, s[8:11], s26 offen offset:1024 sc1
    v_mfma_f32_16x16x32_bf16 v[100:103], v[20:23], v[188:191], v[100:103]
    v_add_f32 v118, v118, v119
    v_add_f32 v112, v112, v114
    s_nop 0
    s_waitcnt lgkmcnt(4)
    v_mfma_f32_16x16x32_bf16 v[104:107], v[24:27], v[184:187], v[104:107]
    v_add_f32 v116, v116, v118
    v_add_f32 v112, v112, v116
    s_lshr_b32 s53, s32, 2
    s_add_u32 s53, s53, 32768
    ds_read_b64_tr_b16 v[20:21], v2 offset:4096
    v_mfma_f32_16x16x32_bf16 v[108:111], v[24:27], v[188:191], v[108:111]
    s_waitcnt lgkmcnt(3)
    v_add_u32 v121, s53, v120
    s_add_u32 s27, s63, 0
    ds_read_b64_tr_b16 v[22:23], v2 offset:5120
    ds_write_b32 v121, v112
    v_mfma_f32_16x16x32_bf16 v[44:47], v[40:43], v[28:31], v[44:47]
    ds_read_b64_tr_b16 v[24:25], v5 offset:16384
    ds_read_b64_tr_b16 v[26:27], v5 offset:17408
    s_nop 0
    s_waitcnt lgkmcnt(5)
    v_mfma_f32_16x16x32_bf16 v[96:99], v[16:19], v[192:195], v[96:99]
    ds_read_b64_tr_b16 v[28:29], v2 offset:2048
    ds_read_b64_tr_b16 v[30:31], v2 offset:3072
    buffer_load_dwordx4 v[148:151], v4, s[8:11], s27 offen offset:1024 sc1
    v_mfma_f32_16x16x32_bf16 v[100:103], v[16:19], v[196:199], v[100:103]
    s_nop 3
    s_waitcnt lgkmcnt(5)
    v_mfma_f32_16x16x32_bf16 v[104:107], v[20:23], v[192:195], v[104:107]
    s_add_u32 s28, s62, 0
    ds_read_b64_tr_b16 v[16:17], v2 offset:6144
    ds_read_b64_tr_b16 v[18:19], v2 offset:7168
    s_nop 1
    s_waitcnt lgkmcnt(6)
    v_mfma_f32_16x16x32_bf16 v[108:111], v[20:23], v[196:199], v[108:111]
    s_barrier
    s_waitcnt lgkmcnt(4)
    v_mfma_f32_16x16x32_bf16 v[44:47], v[40:43], v[24:27], v[44:47]
    s_waitcnt lgkmcnt(2)
    v_add_u32 v5, 0x12000, v5
    v_add_u32 v8, 32768, v4
    ds_read_b64_tr_b16 v[20:21], v5 offset:0
    ds_read_b64_tr_b16 v[22:23], v5 offset:1024
    v_mfma_f32_16x16x32_bf16 v[96:99], v[28:31], v[200:203], v[96:99]
    v_add_u32 v2, 0xffff2000, v2
    ds_read_b64_tr_b16 v[24:25], v2 offset:0
    ds_read_b64_tr_b16 v[26:27], v2 offset:1024
    buffer_load_dwordx4 v[112:115], v4, s[8:11], s28 offen offset:0 sc1
    v_mfma_f32_16x16x32_bf16 v[100:103], v[28:31], v[204:207], v[100:103]
    s_waitcnt lgkmcnt(4)
    v_bfe_u32 v9, v4, 8, 2
    s_add_u32 s29, s63, 0
    ds_read_b128 v[64:67], v8
    v_mfma_f32_16x16x32_bf16 v[104:107], v[16:19], v[200:203], v[104:107]
    ds_read_b64_tr_b16 v[28:29], v2 offset:4096
    ds_read_b64_tr_b16 v[30:31], v2 offset:5120
    buffer_load_dwordx4 v[116:119], v4, s[8:11], s29 offen offset:0 sc1
    v_mfma_f32_16x16x32_bf16 v[108:111], v[16:19], v[204:207], v[108:111]
    v_bfe_u32 v10, v4, 4, 2
    v_mad_u32_u24 v9, v9, 3, v10
    s_nop 0
    s_waitcnt lgkmcnt(5)
    v_mfma_f32_16x16x32_bf16 v[44:47], v[40:43], v[20:23], v[44:47]
    s_waitcnt lgkmcnt(3)
    v_lshlrev_b32 v9, 4, v9
    v_add_u32 v9, 32768, v9
    ds_read_b64_tr_b16 v[16:17], v2 offset:2048
    ds_read_b64_tr_b16 v[18:19], v2 offset:3072
    v_mfma_f32_16x16x32_bf16 v[96:99], v[24:27], v[208:211], v[96:99]
    s_add_u32 s24, s62, 4096
    ds_read_b64_tr_b16 v[20:21], v2 offset:6144
    ds_read_b128 v[68:71], v9 offset:1024
    s_nop 1
    v_mfma_f32_16x16x32_bf16 v[100:103], v[24:27], v[212:215], v[100:103]
    s_waitcnt lgkmcnt(4)
    v_and_b32 v11, 0xf0, v4
    v_add_u32 v11, 32768, v11
    ds_read_b64_tr_b16 v[22:23], v2 offset:7168
    ds_read_b64 v[72:73], v11 offset:1280
    v_mfma_f32_16x16x32_bf16 v[104:107], v[28:31], v[208:211], v[104:107]
    ds_read_b64_tr_b16 v[24:25], v2 offset:16384
    ds_read_b64_tr_b16 v[26:27], v2 offset:17408
    buffer_load_dwordx4 v[120:123], v4, s[8:11], s24 offen offset:1024 sc1
    v_mfma_f32_16x16x32_bf16 v[108:111], v[28:31], v[212:215], v[108:111]
    s_waitcnt lgkmcnt(6)
    v_and_b32 v10, 0x30, v4
    v_add_u32 v10, 32768, v10
    ds_read_b64 v[74:75], v10 offset:1288
    v_mfma_f32_16x16x32_bf16 v[96:99], v[16:19], v[216:219], v[96:99]
    s_add_u32 s25, s63, 4096
    v_mul_f32 v76, 0xbede652a, v13
    v_mul_f32 v77, 0xbede652a, v15
    ds_read_b64_tr_b16 v[28:29], v2 offset:20480
    v_mfma_f32_16x16x32_bf16 v[100:103], v[16:19], v[220:223], v[100:103]
    s_waitcnt lgkmcnt(5)
    v_mul_f32 v76, v76, v76
    v_mul_f32 v77, v77, v77
    s_add_u32 s53, s32, 40960
    ds_read_b64_tr_b16 v[30:31], v2 offset:21504
    v_mfma_f32_16x16x32_bf16 v[104:107], v[20:23], v[216:219], v[104:107]
    ds_read_b64_tr_b16 v[16:17], v2 offset:18432
    ds_read_b64_tr_b16 v[18:19], v2 offset:19456
    buffer_load_dwordx4 v[124:127], v4, s[8:11], s25 offen offset:1024 sc1
    v_mfma_f32_16x16x32_bf16 v[108:111], v[20:23], v[220:223], v[108:111]
    v_add_u32 v78, s53, v4
    v_lshrrev_b32 v79, 2, v4
    s_nop 0
    s_waitcnt lgkmcnt(5)
    v_mfma_f32_16x16x32_bf16 v[96:99], v[24:27], v[224:227], v[96:99]
    s_add_u32 m0, s32, 98304
    v_cvt_pk_bf16_f32 v40, v44, v44
    v_and_b32 v40, 0xffff0000, v40
    s_add_u32 s26, s64, 36864
    ds_read_b64_tr_b16 v[20:21], v2 offset:22528
    v_mfma_f32_16x16x32_bf16 v[100:103], v[24:27], v[228:231], v[100:103]
    s_waitcnt lgkmcnt(3)
    v_sub_f32 v40, v44, v40
    v_cvt_pk_bf16_f32 v40, v44, v40
    ds_read_b64_tr_b16 v[22:23], v2 offset:23552
    v_mfma_f32_16x16x32_bf16 v[104:107], v[28:31], v[224:227], v[104:107]
    v_add_u32 v2, 0x12000, v2
    ds_read_b64_tr_b16 v[24:25], v2 offset:0
    ds_read_b64_tr_b16 v[26:27], v2 offset:1024
    buffer_load_dwordx4 v4, s[8:11], s26 offen sc1 lds
    v_mfma_f32_16x16x32_bf16 v[108:111], v[28:31], v[228:231], v[108:111]
    s_waitcnt lgkmcnt(4)
    v_mov_b32 v41, 0
    v_bfe_u32 v42, v4, 1, 7
    s_and_b32 s72, s32, 0xc00
    s_lshr_b32 s83, s32, 12
    v_mfma_f32_16x16x32_bf16 v[96:99], v[16:19], v[232:235], v[96:99]
    s_lshl_b32 s83, s83, 7
    s_add_u32 s72, s72, s83
    s_add_u32 s72, s72, 160512
    s_add_u32 m0, s32, 114688
    s_add_u32 s27, s64, 40960
    ds_read_b64_tr_b16 v[28:29], v2 offset:4096
    v_mfma_f32_16x16x32_bf16 v[100:103], v[16:19], v[236:239], v[100:103]
    s_waitcnt lgkmcnt(3)
    v_add_u32 v42, s72, v42
    ds_read_b64_tr_b16 v[30:31], v2 offset:5120
    ds_write_b64 v42, v[40:41]
    v_mfma_f32_16x16x32_bf16 v[104:107], v[20:23], v[232:235], v[104:107]
    ds_read_b64_tr_b16 v[16:17], v2 offset:2048
    ds_read_b64_tr_b16 v[18:19], v2 offset:3072
    buffer_load_dwordx4 v4, s[8:11], s27 offen sc1 lds
    v_mfma_f32_16x16x32_bf16 v[108:111], v[20:23], v[236:239], v[108:111]
    v_cvt_pk_bf16_f32 v64, v64, v65
    v_cvt_pk_bf16_f32 v65, v66, v67
    s_nop 0
    s_waitcnt lgkmcnt(5)
    v_mfma_f32_16x16x32_bf16 v[96:99], v[24:27], v[240:243], v[96:99]
    s_add_u32 s28, s62, 4096
    v_cvt_pk_bf16_f32 v66, v72, v73
    v_mov_b32 v67, 0
    ds_read_b64_tr_b16 v[20:21], v2 offset:6144
    v_mfma_f32_16x16x32_bf16 v[100:103], v[24:27], v[244:247], v[100:103]
    s_waitcnt lgkmcnt(4)
    v_cvt_pk_bf16_f32 v68, v68, v69
    v_cvt_pk_bf16_f32 v69, v70, v71
    ds_read_b64_tr_b16 v[22:23], v2 offset:7168
    v_mfma_f32_16x16x32_bf16 v[104:107], v[28:31], v[240:243], v[104:107]
    v_add_u32 v3, 0x4000, v3
    ds_read_b64_tr_b16 v[24:25], v3 offset:49152
    ds_read_b64_tr_b16 v[26:27], v3 offset:50176
    buffer_load_dwordx4 v[152:155], v4, s[8:11], s28 offen offset:2048 sc1
    v_mfma_f32_16x16x32_bf16 v[108:111], v[28:31], v[244:247], v[108:111]
    v_cvt_pk_bf16_f32 v70, v74, v75
    v_mov_b32 v71, 0
    s_nop 0
    s_waitcnt lgkmcnt(4)
    v_mfma_f32_16x16x32_bf16 v[96:99], v[16:19], v[248:251], v[96:99]
    s_add_u32 s29, s63, 4096
    v_cndmask_b32 v66, 0, v66, s[42:43]
    v_cndmask_b32 v70, 0, v70, s[42:43]
    ds_read_b64_tr_b16 v[28:29], v3 offset:53248
    v_mfma_f32_16x16x32_bf16 v[100:103], v[16:19], v[252:255], v[100:103]
    s_waitcnt lgkmcnt(3)
    v_mov_b32 v72, s38
    v_cmp_gt_u32 vcc, 0x80, v79
    ds_read_b64_tr_b16 v[30:31], v3 offset:54272
    v_mfma_f32_16x16x32_bf16 v[88:91], v[68:71], v[32:35], 0
    buffer_load_dwordx4 v[156:159], v4, s[8:11], s29 offen offset:2048 sc1
    s_nop 0
    v_mfma_f32_16x16x32_bf16 v[80:83], v[64:67], v[32:35], 0
    s_nop 4
    v_mfma_f32_16x16x32_bf16 v[92:95], v[68:71], v[36:39], 0
    s_add_u32 m0, s32, 131072
    s_add_u32 s24, s64, 45056
    s_nop 2
    v_mfma_f32_16x16x32_bf16 v[84:87], v[64:67], v[36:39], 0
    buffer_load_dwordx4 v4, s[8:11], s24 offen sc1 lds
    s_nop 0
    v_mfma_f32_16x16x32_bf16 v[104:107], v[20:23], v[248:251], v[104:107]
    v_cndmask_b32 v79, v72, v79, vcc
    v_cmp_gt_u32 vcc, 0x100, v4
    ds_read_b64_tr_b16 v[16:17], v3 offset:51200
    ds_read_b64_tr_b16 v[18:19], v3 offset:52224
    v_mfma_f32_16x16x32_bf16 v[108:111], v[20:23], v[252:255], v[108:111]
    s_barrier
    s_waitcnt lgkmcnt(4)
    v_mfma_f32_16x16x32_bf16 v[48:51], v[24:27], v[176:179], v[48:51]
    s_add_u32 m0, s32, 32768
    v_lshlrev_b32 v1, 21, v4
    v_and_b32 v1, s38, v1
    s_add_u32 s25, s64, 49152
    ds_read_b64_tr_b16 v[20:21], v3 offset:55296
    v_mfma_f32_16x16x32_bf16 v[52:55], v[24:27], v[180:183], v[52:55]
    s_waitcnt lgkmcnt(3)
    v_lshrrev_b32 v6, 2, v4
    v_or_b32 v1, v1, v6
    ds_read_b64_tr_b16 v[22:23], v3 offset:56320
    v_mfma_f32_16x16x32_bf16 v[56:59], v[28:31], v[176:179], v[56:59]
    v_bfe_u32 v5, v4, 1, 8
    v_add_u32 v5, 0x18000, v5
    ds_read_b64 v[24:25], v5 offset:62208
    v_mfma_f32_16x16x32_bf16 v[60:63], v[28:31], v[180:183], v[60:63]
    buffer_load_dwordx4 v4, s[8:11], s25 offen sc1 lds
    s_waitcnt lgkmcnt(3)
    v_mfma_f32_16x16x32_bf16 v[48:51], v[16:19], v[184:187], v[48:51]
    v_mov_b32 v6, s54
    ds_read_b64 v[28:29], v5 offset:64256
    v_mfma_f32_16x16x32_bf16 v[52:55], v[16:19], v[188:191], v[52:55]
    s_waitcnt lgkmcnt(2)
    s_add_u32 s30, s52, 262144
    s_waitcnt vmcnt(13)
    buffer_store_dword v6, v1, s[8:11], s30 offen sc1
    v_mfma_f32_16x16x32_bf16 v[56:59], v[20:23], v[184:187], v[56:59]
    s_add_u32 s31, s57, 65536
    ds_read_b64 v[16:17], v5 offset:63232
    buffer_store_dword v6, v1, s[8:11], s31 offen sc1
    v_mfma_f32_16x16x32_bf16 v[60:63], v[20:23], v[188:191], v[60:63]
    ds_read_b64 v[64:65], v78 offset:0
    ds_read_b64 v[68:69], v78 offset:8
    s_nop 0
    s_waitcnt lgkmcnt(4)
    v_mfma_f32_16x16x16_bf16 v[96:99], v[24:25], v[12:13], v[96:99]
    s_add_u32 s26, s62, 8192
    v_add_u32 v5, 0x0, v5
    v_add_f32 v90, s36, v90
    ds_read_b64 v[20:21], v5 offset:65280
    v_mfma_f32_16x16x16_bf16 v[100:103], v[24:25], v[14:15], v[100:103]
    buffer_load_dwordx4 v[160:163], v4, s[8:11], s26 offen offset:3072 sc1
    s_waitcnt lgkmcnt(4)
    v_mfma_f32_16x16x16_bf16 v[104:107], v[28:29], v[12:13], v[104:107]
    v_add_u32 v3, 0xffff6000, v3
    v_add_f32 v94, s36, v94
    ds_read_b64_tr_b16 v[24:25], v3 offset:0
    v_mfma_f32_16x16x16_bf16 v[108:111], v[28:29], v[14:15], v[108:111]
    s_waitcnt lgkmcnt(4)
    v_mul_f32 v90, v90, v76
    v_mul_f32 v94, v94, v77
    ds_read_b64_tr_b16 v[26:27], v3 offset:1024
    v_mfma_f32_16x16x16_bf16 v[48:51], v[16:17], v[12:13], v[48:51]
    s_add_u32 s27, s63, 8192
    v_rcp_f32 v90, v90
    ds_read_b64_tr_b16 v[28:29], v3 offset:4096
    v_mfma_f32_16x16x16_bf16 v[52:55], v[16:17], v[14:15], v[52:55]
    s_waitcnt lgkmcnt(3)
    v_rcp_f32 v94, v94
    ds_read_b64_tr_b16 v[30:31], v3 offset:5120
    v_mfma_f32_16x16x16_bf16 v[56:59], v[20:21], v[12:13], v[56:59]
    ds_read_b64_tr_b16 v[16:17], v3 offset:2048
    ds_read_b64_tr_b16 v[18:19], v3 offset:3072
    buffer_load_dwordx4 v[164:167], v4, s[8:11], s27 offen offset:3072 sc1
    v_mfma_f32_16x16x16_bf16 v[60:63], v[20:21], v[14:15], v[60:63]
    v_mul_f32 v80, v80, v90
    v_mul_f32 v81, v81, v90
    s_nop 0
    s_waitcnt lgkmcnt(4)
    v_mfma_f32_16x16x32_bf16 v[48:51], v[24:27], v[192:195], v[48:51]
    s_add_u32 s28, s62, 16384
    v_mul_f32 v82, v82, v90
    v_mul_f32 v83, v83, v90
    ds_read_b64_tr_b16 v[20:21], v3 offset:6144
    v_mfma_f32_16x16x32_bf16 v[52:55], v[24:27], v[196:199], v[52:55]
    s_waitcnt lgkmcnt(3)
    v_mul_f32 v88, v88, v90
    v_mul_f32 v89, v89, v90
    ds_read_b64_tr_b16 v[22:23], v3 offset:7168
    v_mfma_f32_16x16x32_bf16 v[56:59], v[28:31], v[192:195], v[56:59]
    v_add_u32 v3, 0xffff2000, v3
    ds_read_b64_tr_b16 v[24:25], v3 offset:0
    ds_read_b64_tr_b16 v[26:27], v3 offset:1024
    buffer_load_dwordx4 v[168:171], v4, s[8:11], s28 offen offset:0 sc1
    v_mfma_f32_16x16x32_bf16 v[60:63], v[28:31], v[196:199], v[60:63]
    v_cvt_pk_bf16_f32 v66, v80, v81
    v_cvt_pk_bf16_f32 v67, v82, v83
    s_nop 0
    s_waitcnt lgkmcnt(4)
    v_mfma_f32_16x16x32_bf16 v[48:51], v[16:19], v[200:203], v[48:51]
    s_add_u32 s30, s33, 4096
    ds_read_b64_tr_b16 v[28:29], v3 offset:4096
    buffer_store_dwordx4 v[64:67], v4, s[8:11], s30 offen offset:0 sc1
    v_mfma_f32_16x16x32_bf16 v[52:55], v[16:19], v[204:207], v[52:55]
    s_waitcnt lgkmcnt(3)
    v_cvt_pk_bf16_f32 v88, v88, v89
    v_mul_f32 v84, v84, v94
    ds_read_b64_tr_b16 v[30:31], v3 offset:5120
    v_mfma_f32_16x16x32_bf16 v[56:59], v[20:23], v[200:203], v[56:59]
    v_mul_f32 v85, v85, v94
    v_mul_f32 v86, v86, v94
    ds_read_b64_tr_b16 v[16:17], v3 offset:2048
    v_mfma_f32_16x16x32_bf16 v[60:63], v[20:23], v[204:207], v[60:63]
    s_waitcnt lgkmcnt(3)
    v_mul_f32 v87, v87, v94
    v_mul_f32 v92, v92, v94
    ds_read_b64_tr_b16 v[18:19], v3 offset:3072
    v_mfma_f32_16x16x32_bf16 v[48:51], v[24:27], v[208:211], v[48:51]
    s_add_u32 s29, s63, 16384
    v_mul_f32 v93, v93, v94
    v_cvt_pk_bf16_f32 v70, v84, v85
    ds_read_b64_tr_b16 v[20:21], v3 offset:6144
    v_mfma_f32_16x16x32_bf16 v[52:55], v[24:27], v[212:215], v[52:55]
    s_waitcnt lgkmcnt(3)
    v_cvt_pk_bf16_f32 v71, v86, v87
    ds_read_b64_tr_b16 v[22:23], v3 offset:7168
    v_mfma_f32_16x16x32_bf16 v[56:59], v[28:31], v[208:211], v[56:59]
    ds_read_b64_tr_b16 v[24:25], v3 offset:16384
    ds_read_b64_tr_b16 v[26:27], v3 offset:17408
    buffer_load_dwordx4 v[172:175], v4, s[8:11], s29 offen offset:0 sc1
    v_mfma_f32_16x16x32_bf16 v[60:63], v[28:31], v[212:215], v[60:63]
    s_barrier
    s_waitcnt lgkmcnt(4)
    v_mfma_f32_16x16x32_bf16 v[48:51], v[16:19], v[216:219], v[48:51]
    s_add_u32 s31, s33, 167936
    ds_read_b64_tr_b16 v[28:29], v3 offset:20480
    buffer_store_dwordx4 v[68:71], v4, s[8:11], s31 offen offset:0 sc1
    v_mfma_f32_16x16x32_bf16 v[52:55], v[16:19], v[220:223], v[52:55]
    s_waitcnt lgkmcnt(3)
    v_cvt_pk_bf16_f32 v92, v92, v93
    v_cndmask_b32 v88, v92, v88, vcc
    ds_read_b64_tr_b16 v[30:31], v3 offset:21504
    v_mfma_f32_16x16x32_bf16 v[56:59], v[20:23], v[216:219], v[56:59]
    ds_read_b64_tr_b16 v[16:17], v3 offset:18432
    buffer_store_dword v88, v79, s[8:11], s48 offen sc1
    v_mfma_f32_16x16x32_bf16 v[60:63], v[20:23], v[220:223], v[60:63]
    s_waitcnt lgkmcnt(3)
    v_mul_f32 v8, v96, v96
    v_mul_f32 v9, v97, v97
    ds_read_b64_tr_b16 v[18:19], v3 offset:19456
    v_mfma_f32_16x16x32_bf16 v[48:51], v[24:27], v[224:227], v[48:51]
    v_mul_f32 v10, v98, v98
    v_mul_f32 v11, v99, v99
    ds_read_b64_tr_b16 v[20:21], v3 offset:22528
    v_mfma_f32_16x16x32_bf16 v[52:55], v[24:27], v[228:231], v[52:55]
    s_waitcnt lgkmcnt(3)
    v_fma_f32 v8, v8, v0, v13
    v_fma_f32 v9, v9, v0, v13
    ds_read_b64_tr_b16 v[22:23], v3 offset:23552
    v_mfma_f32_16x16x32_bf16 v[56:59], v[28:31], v[224:227], v[56:59]
    s_add_u32 m0, s32, 147456
    v_add_u32 v3, 0x12000, v3
    v_fma_f32 v10, v10, v0, v13
    s_add_u32 s24, s64, 57344
    ds_read_b64_tr_b16 v[24:25], v3 offset:0
    v_mfma_f32_16x16x32_bf16 v[60:63], v[28:31], v[228:231], v[60:63]
    s_waitcnt lgkmcnt(3)
    v_fma_f32 v11, v11, v0, v13
    v_mul_f32 v8, v96, v8
    ds_read_b64_tr_b16 v[26:27], v3 offset:1024
    v_mfma_f32_16x16x32_bf16 v[48:51], v[16:19], v[232:235], v[48:51]
    ds_read_b64_tr_b16 v[28:29], v3 offset:4096
    ds_read_b64_tr_b16 v[30:31], v3 offset:5120
    buffer_load_dwordx4 v4, s[8:11], s24 offen sc1 lds
    v_mfma_f32_16x16x32_bf16 v[52:55], v[16:19], v[236:239], v[52:55]
    v_mul_f32 v9, v97, v9
    v_mul_f32 v10, v98, v10
    s_nop 0
    s_waitcnt lgkmcnt(4)
    v_mfma_f32_16x16x32_bf16 v[56:59], v[20:23], v[232:235], v[56:59]
    s_add_u32 m0, s32, 57344
    v_mul_f32 v11, v99, v11
    v_mul_f32 v104, v96, v104
    s_add_u32 s25, s64, 61440
    ds_read_b64_tr_b16 v[16:17], v3 offset:2048
    v_mfma_f32_16x16x32_bf16 v[60:63], v[20:23], v[236:239], v[60:63]
    s_waitcnt lgkmcnt(3)
    v_exp_f32 v8, v8
    ds_read_b64_tr_b16 v[18:19], v3 offset:3072
    v_mfma_f32_16x16x32_bf16 v[48:51], v[24:27], v[240:243], v[48:51]
    ds_read_b64_tr_b16 v[20:21], v3 offset:6144
    ds_read_b64_tr_b16 v[22:23], v3 offset:7168
    buffer_load_dwordx4 v4, s[8:11], s25 offen sc1 lds
    v_mfma_f32_16x16x32_bf16 v[52:55], v[24:27], v[244:247], v[52:55]
    v_exp_f32 v9, v9
    s_nop 0
    s_waitcnt lgkmcnt(4)
    v_mfma_f32_16x16x32_bf16 v[56:59], v[28:31], v[240:243], v[56:59]
    s_and_b32 s86, s32, 0x1000
    v_or_b32 v5, s86, v4
    v_add_u32 v5, 0x16000, v5
    ds_read_b128 v[24:27], v5 offset:0
    v_mfma_f32_16x16x32_bf16 v[60:63], v[28:31], v[244:247], v[60:63]
    v_exp_f32 v10, v10
    s_nop 0
    s_waitcnt lgkmcnt(3)
    v_mfma_f32_16x16x32_bf16 v[48:51], v[16:19], v[248:251], v[48:51]
    v_exp_f32 v11, v11
    ds_read_b128 v[28:31], v5 offset:1024
    v_mfma_f32_16x16x32_bf16 v[52:55], v[16:19], v[252:255], v[52:55]
    v_mul_f32 v105, v97, v105
    v_mul_f32 v106, v98, v106
    s_nop 0
    s_waitcnt lgkmcnt(2)
    v_mfma_f32_16x16x32_bf16 v[56:59], v[20:23], v[248:251], v[56:59]
    v_mul_f32 v107, v99, v107
    v_add_f32 v8, 1.0, v8
    ds_read_b128 v[16:19], v5 offset:2048
    v_mfma_f32_16x16x32_bf16 v[60:63], v[20:23], v[252:255], v[60:63]
    s_barrier
    s_waitcnt lgkmcnt(2)
    s_waitcnt vmcnt(20)
    v_mfma_f32_16x16x32_bf16 v[32:35], v[24:27], v[112:115], 0
    s_add_u32 m0, s32, 40960
    v_add_f32 v9, 1.0, v9
    v_add_f32 v10, 1.0, v10
    s_add_u32 s26, s64, 53248
    ds_read_b128 v[20:23], v5 offset:3072
    s_waitcnt vmcnt(19)
    v_mfma_f32_16x16x32_bf16 v[36:39], v[24:27], v[116:119], 0
    buffer_load_dwordx4 v4, s[8:11], s26 offen sc1 lds
    s_waitcnt lgkmcnt(2)
    v_mfma_f32_16x16x32_bf16 v[40:43], v[28:31], v[112:115], 0
    s_add_u32 m0, s32, 0
    v_add_f32 v11, 1.0, v11
    s_add_u32 s27, s64, 65536
    ds_read_b128 v[24:27], v5 offset:16384
    v_mfma_f32_16x16x32_bf16 v[44:47], v[28:31], v[116:119], 0
    buffer_load_dwordx4 v4, s[8:11], s27 offen sc1 lds
    s_waitcnt lgkmcnt(2)
    v_mfma_f32_16x16x32_bf16 v[64:67], v[16:19], v[112:115], 0
    s_add_u32 m0, s32, 16384
    v_rcp_f32 v8, v8
    s_add_u32 s28, s64, 69632
    ds_read_b128 v[28:31], v5 offset:17408
    v_mfma_f32_16x16x32_bf16 v[68:71], v[16:19], v[116:119], 0
    buffer_load_dwordx4 v4, s[8:11], s28 offen sc1 lds
    s_waitcnt lgkmcnt(2)
    v_mfma_f32_16x16x32_bf16 v[72:75], v[20:23], v[112:115], 0
    v_rcp_f32 v9, v9
    ds_read_b128 v[16:19], v5 offset:18432
    v_mfma_f32_16x16x32_bf16 v[76:79], v[20:23], v[116:119], 0
    v_rcp_f32 v10, v10
    s_nop 0
    s_waitcnt lgkmcnt(2)
    v_mfma_f32_16x16x32_bf16 v[80:83], v[24:27], v[112:115], 0
    s_add_u32 m0, s32, 73728
    v_rcp_f32 v11, v11
    s_add_u32 s29, s64, 73728
    ds_read_b128 v[20:23], v5 offset:19456
    v_mfma_f32_16x16x32_bf16 v[84:87], v[24:27], v[116:119], 0
    buffer_load_dwordx4 v4, s[8:11], s29 offen sc1 lds
    s_waitcnt lgkmcnt(2)
    v_mfma_f32_16x16x32_bf16 v[88:91], v[28:31], v[112:115], 0
    v_mul_f32 v104, v104, v8
    v_mul_f32 v105, v105, v9
    ds_read_b128 v[24:27], v5 offset:32768
    v_mfma_f32_16x16x32_bf16 v[92:95], v[28:31], v[116:119], 0
    v_mul_f32 v106, v106, v10
    v_mul_f32 v107, v107, v11
    s_nop 0
    s_waitcnt lgkmcnt(2)
    v_mfma_f32_16x16x32_bf16 v[248:251], v[16:19], v[112:115], 0
    v_cvt_pk_bf16_f32 v96, v104, v105
    v_cvt_pk_bf16_f32 v97, v106, v107
    ds_read_b128 v[28:31], v5 offset:33792
    v_mfma_f32_16x16x32_bf16 v[252:255], v[16:19], v[116:119], 0
    v_mul_f32 v8, v100, v100
    v_mul_f32 v9, v101, v101
    s_nop 0
    s_waitcnt lgkmcnt(2)
    s_waitcnt vmcnt(22)
    v_mfma_f32_16x16x32_bf16 v[32:35], v[20:23], v[120:123], v[32:35]
    v_lshlrev_b32 v3, 21, v4
    v_and_b32 v3, s38, v3
    ds_read_b128 v[16:19], v5 offset:34816
    s_waitcnt vmcnt(21)
    v_mfma_f32_16x16x32_bf16 v[36:39], v[20:23], v[124:127], v[36:39]
    v_lshrrev_b32 v6, 2, v4
    v_or_b32 v3, v3, v6
    s_nop 0
    s_waitcnt lgkmcnt(2)
    v_mfma_f32_16x16x32_bf16 v[40:43], v[24:27], v[120:123], v[40:43]
    v_mov_b32 v6, s54
    ds_read_b128 v[20:23], v5 offset:35840
    v_mfma_f32_16x16x32_bf16 v[44:47], v[24:27], v[124:127], v[44:47]
    s_waitcnt lgkmcnt(2)
    s_add_u32 s30, s52, 524288
    s_waitcnt vmcnt(6)
    buffer_store_dword v6, v3, s[8:11], s30 offen sc1
    v_mfma_f32_16x16x32_bf16 v[64:67], v[28:31], v[120:123], v[64:67]
    v_mul_f32 v10, v102, v102
    v_mul_f32 v11, v103, v103
    ds_read_b128 v[24:27], v5 offset:49152
    v_mfma_f32_16x16x32_bf16 v[68:71], v[28:31], v[124:127], v[68:71]
    v_fma_f32 v8, v8, v7, v15
    v_fma_f32 v9, v9, v7, v15
    s_nop 0
    s_waitcnt lgkmcnt(2)
    v_mfma_f32_16x16x32_bf16 v[72:75], v[16:19], v[120:123], v[72:75]
    v_fma_f32 v10, v10, v7, v15
    v_fma_f32 v11, v11, v7, v15
    ds_read_b128 v[28:31], v5 offset:50176
    v_mfma_f32_16x16x32_bf16 v[76:79], v[16:19], v[124:127], v[76:79]
    v_mul_f32 v8, v100, v8
    v_mul_f32 v9, v101, v9
    s_nop 0
    s_waitcnt lgkmcnt(2)
    v_mfma_f32_16x16x32_bf16 v[80:83], v[20:23], v[120:123], v[80:83]
    v_mul_f32 v10, v102, v10
    v_mul_f32 v11, v103, v11
    ds_read_b128 v[16:19], v5 offset:51200
    v_mfma_f32_16x16x32_bf16 v[84:87], v[20:23], v[124:127], v[84:87]
    v_exp_f32 v8, v8
    s_nop 0
    s_waitcnt lgkmcnt(2)
    v_mfma_f32_16x16x32_bf16 v[88:91], v[24:27], v[120:123], v[88:91]
    v_exp_f32 v9, v9
    ds_read_b128 v[20:23], v5 offset:52224
    v_mfma_f32_16x16x32_bf16 v[92:95], v[24:27], v[124:127], v[92:95]
    v_exp_f32 v10, v10
    s_nop 0
    s_waitcnt lgkmcnt(2)
    v_mfma_f32_16x16x32_bf16 v[248:251], v[28:31], v[120:123], v[248:251]
    v_add_u32 v5, 0xffff6000, v5
    v_mul_f32 v108, v100, v108
    ds_read_b128 v[24:27], v5 offset:0
    v_mfma_f32_16x16x32_bf16 v[252:255], v[28:31], v[124:127], v[252:255]
    v_exp_f32 v11, v11
    s_nop 0
    s_waitcnt lgkmcnt(2)
    v_mfma_f32_16x16x32_bf16 v[32:35], v[16:19], v[128:131], v[32:35]
    v_mul_f32 v109, v101, v109
    v_mul_f32 v110, v102, v110
    ds_read_b128 v[28:31], v5 offset:1024
    v_mfma_f32_16x16x32_bf16 v[36:39], v[16:19], v[132:135], v[36:39]
    v_mul_f32 v111, v103, v111
    v_add_f32 v8, 1.0, v8
    s_nop 0
    s_waitcnt lgkmcnt(2)
    v_mfma_f32_16x16x32_bf16 v[40:43], v[20:23], v[128:131], v[40:43]
    v_add_f32 v9, 1.0, v9
    v_add_f32 v10, 1.0, v10
    ds_read_b128 v[16:19], v5 offset:2048
    v_mfma_f32_16x16x32_bf16 v[44:47], v[20:23], v[132:135], v[44:47]
    v_add_f32 v11, 1.0, v11
    s_nop 1
    s_waitcnt lgkmcnt(2)
    v_mfma_f32_16x16x32_bf16 v[64:67], v[24:27], v[128:131], v[64:67]
    v_rcp_f32 v8, v8
    ds_read_b128 v[20:23], v5 offset:3072
    v_mfma_f32_16x16x32_bf16 v[68:71], v[24:27], v[132:135], v[68:71]
    v_rcp_f32 v9, v9
    s_nop 0
    s_waitcnt lgkmcnt(2)
    v_mfma_f32_16x16x32_bf16 v[72:75], v[28:31], v[128:131], v[72:75]
    v_rcp_f32 v10, v10
    ds_read_b128 v[24:27], v5 offset:16384
    v_mfma_f32_16x16x32_bf16 v[76:79], v[28:31], v[132:135], v[76:79]
    v_rcp_f32 v11, v11
    s_nop 0
    s_waitcnt lgkmcnt(2)
    v_mfma_f32_16x16x32_bf16 v[80:83], v[16:19], v[128:131], v[80:83]
    v_mul_f32 v108, v108, v8
    v_mul_f32 v109, v109, v9
    ds_read_b128 v[28:31], v5 offset:17408
    v_mfma_f32_16x16x32_bf16 v[84:87], v[16:19], v[132:135], v[84:87]
    v_mul_f32 v110, v110, v10
    v_mul_f32 v111, v111, v11
    s_nop 0
    s_waitcnt lgkmcnt(2)
    v_mfma_f32_16x16x32_bf16 v[88:91], v[20:23], v[128:131], v[88:91]
    v_cvt_pk_bf16_f32 v100, v108, v109
    v_cvt_pk_bf16_f32 v101, v110, v111
    ds_read_b128 v[16:19], v5 offset:18432
    v_mfma_f32_16x16x32_bf16 v[92:95], v[20:23], v[132:135], v[92:95]
    v_lshrrev_b32 v2, 1, v4
    v_mul_f32 v8, v48, v48
    s_nop 0
    s_waitcnt lgkmcnt(2)
    v_mfma_f32_16x16x32_bf16 v[248:251], v[24:27], v[128:131], v[248:251]
    v_mul_f32 v9, v49, v49
    v_mul_f32 v10, v50, v50
    ds_read_b128 v[20:23], v5 offset:19456
    v_mfma_f32_16x16x32_bf16 v[252:255], v[24:27], v[132:135], v[252:255]
    s_barrier
    s_waitcnt lgkmcnt(2)
    v_mfma_f32_16x16x32_bf16 v[32:35], v[28:31], v[136:139], v[32:35]
    s_add_u32 m0, s32, 90112
    v_add_u32 v5, 0xffff6000, v5
    v_lshrrev_b32 v3, 7, v4
    s_add_u32 s24, s64, 77824
    ds_read_b128 v[24:27], v5 offset:0
    v_mfma_f32_16x16x32_bf16 v[36:39], v[28:31], v[140:143], v[36:39]
    buffer_load_dwordx4 v4, s[8:11], s24 offen sc1 lds
    s_waitcnt lgkmcnt(2)
    v_mfma_f32_16x16x32_bf16 v[40:43], v[16:19], v[136:139], v[40:43]
    v_lshlrev_b32 v3, 7, v3
    ds_read_b128 v[28:31], v5 offset:1024
    v_mfma_f32_16x16x32_bf16 v[44:47], v[16:19], v[140:143], v[44:47]
    s_waitcnt lgkmcnt(2)
    s_add_u32 s58, s51, 262144
    buffer_load_dword v6, v3, s[8:11], s58 offen sc1
    v_mfma_f32_16x16x32_bf16 v[64:67], v[20:23], v[136:139], v[64:67]
    s_add_u32 m0, s32, 106496
    v_mul_f32 v11, v51, v51
    v_fma_f32 v8, v8, v0, v13
    s_add_u32 s25, s64, 81920
    ds_read_b128 v[16:19], v5 offset:2048
    v_mfma_f32_16x16x32_bf16 v[68:71], v[20:23], v[140:143], v[68:71]
    buffer_load_dwordx4 v4, s[8:11], s25 offen sc1 lds
    s_waitcnt lgkmcnt(2)
    v_mfma_f32_16x16x32_bf16 v[72:75], v[24:27], v[136:139], v[72:75]
    s_add_u32 m0, s32, 122880
    v_fma_f32 v9, v9, v0, v13
    v_fma_f32 v10, v10, v0, v13
    s_add_u32 s26, s64, 86016
    ds_read_b128 v[20:23], v5 offset:3072
    v_mfma_f32_16x16x32_bf16 v[76:79], v[24:27], v[140:143], v[76:79]
    buffer_load_dwordx4 v4, s[8:11], s26 offen sc1 lds
    s_waitcnt lgkmcnt(2)
    v_mfma_f32_16x16x32_bf16 v[80:83], v[28:31], v[136:139], v[80:83]
    v_fma_f32 v11, v11, v0, v13
    v_mul_f32 v8, v48, v8
    ds_read_b128 v[24:27], v5 offset:16384
    v_mfma_f32_16x16x32_bf16 v[84:87], v[28:31], v[140:143], v[84:87]
    v_mul_f32 v9, v49, v9
    v_mul_f32 v10, v50, v10
    s_nop 0
    s_waitcnt lgkmcnt(2)
    v_mfma_f32_16x16x32_bf16 v[88:91], v[16:19], v[136:139], v[88:91]
    s_add_u32 m0, s32, 139264
    v_mul_f32 v11, v51, v11
    v_mul_f32 v56, v48, v56
    s_add_u32 s27, s64, 90112
    ds_read_b128 v[28:31], v5 offset:17408
    v_mfma_f32_16x16x32_bf16 v[92:95], v[16:19], v[140:143], v[92:95]
    buffer_load_dwordx4 v4, s[8:11], s27 offen sc1 lds
    s_waitcnt lgkmcnt(2)
    v_mfma_f32_16x16x32_bf16 v[248:251], v[20:23], v[136:139], v[248:251]
    v_exp_f32 v8, v8
    ds_read_b128 v[16:19], v5 offset:18432
    v_mfma_f32_16x16x32_bf16 v[252:255], v[20:23], v[140:143], v[252:255]
    v_exp_f32 v9, v9
    s_nop 0
    s_waitcnt lgkmcnt(2)
    v_mfma_f32_16x16x32_bf16 v[32:35], v[24:27], v[144:147], v[32:35]
    s_add_u32 m0, s32, 49152
    v_exp_f32 v10, v10
    s_add_u32 s28, s64, 94208
    ds_read_b128 v[20:23], v5 offset:19456
    v_mfma_f32_16x16x32_bf16 v[36:39], v[24:27], v[148:151], v[36:39]
    buffer_load_dwordx4 v4, s[8:11], s28 offen sc1 lds
    s_waitcnt lgkmcnt(2)
    v_mfma_f32_16x16x32_bf16 v[40:43], v[28:31], v[144:147], v[40:43]
    v_add_u32 v5, 0x12000, v5
    v_mul_f32 v57, v49, v57
    ds_read_b128 v[24:27], v5 offset:0
    v_mfma_f32_16x16x32_bf16 v[44:47], v[28:31], v[148:151], v[44:47]
    v_exp_f32 v11, v11
    s_nop 0
    s_waitcnt lgkmcnt(2)
    v_mfma_f32_16x16x32_bf16 v[64:67], v[16:19], v[144:147], v[64:67]
    v_mul_f32 v58, v50, v58
    v_mul_f32 v59, v51, v59
    ds_read_b128 v[28:31], v5 offset:1024
    v_mfma_f32_16x16x32_bf16 v[68:71], v[16:19], v[148:151], v[68:71]
    v_add_f32 v8, 1.0, v8
    v_add_f32 v9, 1.0, v9
    s_nop 0
    s_waitcnt lgkmcnt(2)
    v_mfma_f32_16x16x32_bf16 v[72:75], v[20:23], v[144:147], v[72:75]
    v_add_f32 v10, 1.0, v10
    v_add_f32 v11, 1.0, v11
    ds_read_b128 v[16:19], v5 offset:2048
    v_mfma_f32_16x16x32_bf16 v[76:79], v[20:23], v[148:151], v[76:79]
    v_rcp_f32 v8, v8
    s_nop 0
    s_waitcnt lgkmcnt(2)
    v_mfma_f32_16x16x32_bf16 v[80:83], v[24:27], v[144:147], v[80:83]
    v_rcp_f32 v9, v9
    ds_read_b128 v[20:23], v5 offset:3072
    v_mfma_f32_16x16x32_bf16 v[84:87], v[24:27], v[148:151], v[84:87]
    v_rcp_f32 v10, v10
    s_nop 0
    s_waitcnt lgkmcnt(2)
    v_mfma_f32_16x16x32_bf16 v[88:91], v[28:31], v[144:147], v[88:91]
    v_rcp_f32 v11, v11
    ds_read_b128 v[24:27], v5 offset:16384
    v_mfma_f32_16x16x32_bf16 v[92:95], v[28:31], v[148:151], v[92:95]
    v_mul_f32 v56, v56, v8
    v_mul_f32 v57, v57, v9
    s_nop 0
    s_waitcnt lgkmcnt(2)
    v_mfma_f32_16x16x32_bf16 v[248:251], v[16:19], v[144:147], v[248:251]
    v_mul_f32 v58, v58, v10
    v_mul_f32 v59, v59, v11
    ds_read_b128 v[28:31], v5 offset:17408
    v_mfma_f32_16x16x32_bf16 v[252:255], v[16:19], v[148:151], v[252:255]
    v_cvt_pk_bf16_f32 v98, v56, v57
    v_cvt_pk_bf16_f32 v99, v58, v59
    s_nop 0
    s_waitcnt lgkmcnt(2)
    v_mfma_f32_16x16x32_bf16 v[32:35], v[20:23], v[152:155], v[32:35]
    s_waitcnt vmcnt(4)
    v_cmp_ne_u32 vcc, s54, v6
    ds_read_b128 v[16:19], v5 offset:18432
    v_mfma_f32_16x16x32_bf16 v[36:39], v[20:23], v[156:159], v[36:39]
    s_nop 2
    s_cbranch_vccnz L_sl4
L_bk4:
    s_nop 2
    s_waitcnt lgkmcnt(2)
    v_mfma_f32_16x16x32_bf16 v[40:43], v[24:27], v[152:155], v[40:43]
    s_add_u32 s29, s62, 0
    v_min_u32 v96, -2, v96
    v_min_u32 v97, -2, v97
    ds_read_b128 v[20:23], v5 offset:19456
    v_mfma_f32_16x16x32_bf16 v[44:47], v[24:27], v[156:159], v[44:47]
    buffer_load_dwordx4 v[176:179], v4, s[8:11], s29 offen offset:2048 sc1
    s_waitcnt lgkmcnt(2)
    v_mfma_f32_16x16x32_bf16 v[64:67], v[28:31], v[152:155], v[64:67]
    s_add_u32 s24, s63, 0
    v_min_u32 v98, -2, v98
    v_min_u32 v99, -2, v99
    ds_read_b128 v[24:27], v5 offset:32768
    v_mfma_f32_16x16x32_bf16 v[68:71], v[28:31], v[156:159], v[68:71]
    buffer_load_dwordx4 v[180:183], v4, s[8:11], s24 offen offset:2048 sc1
    s_waitcnt lgkmcnt(2)
    v_mfma_f32_16x16x32_bf16 v[72:75], v[16:19], v[152:155], v[72:75]
    s_add_u32 s31, s33, 0
    ds_read_b128 v[28:31], v5 offset:33792
    buffer_store_dwordx4 v[96:99], v4, s[8:11], s31 offen offset:3072 sc1
    v_mfma_f32_16x16x32_bf16 v[76:79], v[16:19], v[156:159], v[76:79]
    v_mul_f32 v8, v52, v52
    v_mul_f32 v9, v53, v53
    s_nop 0
    s_waitcnt lgkmcnt(2)
    v_mfma_f32_16x16x32_bf16 v[80:83], v[20:23], v[152:155], v[80:83]
    v_mul_f32 v10, v54, v54
    v_mul_f32 v11, v55, v55
    ds_read_b128 v[16:19], v5 offset:34816
    v_mfma_f32_16x16x32_bf16 v[84:87], v[20:23], v[156:159], v[84:87]
    v_fma_f32 v8, v8, v7, v15
    v_fma_f32 v9, v9, v7, v15
    s_nop 0
    s_waitcnt lgkmcnt(2)
    v_mfma_f32_16x16x32_bf16 v[88:91], v[24:27], v[152:155], v[88:91]
    s_add_u32 s25, s62, 4096
    v_fma_f32 v10, v10, v7, v15
    v_fma_f32 v11, v11, v7, v15
    ds_read_b128 v[20:23], v5 offset:35840
    v_mfma_f32_16x16x32_bf16 v[92:95], v[24:27], v[156:159], v[92:95]
    buffer_load_dwordx4 v[184:187], v4, s[8:11], s25 offen offset:3072 sc1
    s_waitcnt lgkmcnt(2)
    v_mfma_f32_16x16x32_bf16 v[248:251], v[28:31], v[152:155], v[248:251]
    v_mul_f32 v8, v52, v8
    v_mul_f32 v9, v53, v9
    ds_read_b128 v[24:27], v5 offset:49152
    v_mfma_f32_16x16x32_bf16 v[252:255], v[28:31], v[156:159], v[252:255]
    s_barrier
    s_waitcnt lgkmcnt(2)
    v_mfma_f32_16x16x32_bf16 v[32:35], v[16:19], v[160:163], v[32:35]
    s_add_u32 s26, s63, 4096
    v_mul_f32 v10, v54, v10
    v_mul_f32 v11, v55, v11
    ds_read_b128 v[28:31], v5 offset:50176
    v_mfma_f32_16x16x32_bf16 v[36:39], v[16:19], v[164:167], v[36:39]
    buffer_load_dwordx4 v[188:191], v4, s[8:11], s26 offen offset:3072 sc1
    s_waitcnt lgkmcnt(2)
    v_mfma_f32_16x16x32_bf16 v[40:43], v[20:23], v[160:163], v[40:43]
    v_exp_f32 v8, v8
    ds_read_b128 v[16:19], v5 offset:51200
    v_mfma_f32_16x16x32_bf16 v[44:47], v[20:23], v[164:167], v[44:47]
    v_exp_f32 v9, v9
    s_nop 0
    s_waitcnt lgkmcnt(2)
    v_mfma_f32_16x16x32_bf16 v[64:67], v[24:27], v[160:163], v[64:67]
    s_add_u32 s27, s62, 12288
    v_exp_f32 v10, v10
    ds_read_b128 v[20:23], v5 offset:52224
    v_mfma_f32_16x16x32_bf16 v[68:71], v[24:27], v[164:167], v[68:71]
    buffer_load_dwordx4 v[192:195], v4, s[8:11], s27 offen offset:0 sc1
    s_waitcnt lgkmcnt(2)
    v_mfma_f32_16x16x32_bf16 v[72:75], v[28:31], v[160:163], v[72:75]
    v_add_u32 v5, 0xffff4000, v5
    v_mul_f32 v60, v52, v60
    ds_read_b128 v[24:27], v5 offset:0
    v_mfma_f32_16x16x32_bf16 v[76:79], v[28:31], v[164:167], v[76:79]
    v_exp_f32 v11, v11
    s_nop 0
    s_waitcnt lgkmcnt(2)
    v_mfma_f32_16x16x32_bf16 v[80:83], v[16:19], v[160:163], v[80:83]
    s_add_u32 s28, s63, 12288
    v_mul_f32 v61, v53, v61
    v_mul_f32 v62, v54, v62
    ds_read_b128 v[28:31], v5 offset:1024
    v_mfma_f32_16x16x32_bf16 v[84:87], v[16:19], v[164:167], v[84:87]
    buffer_load_dwordx4 v[196:199], v4, s[8:11], s28 offen offset:0 sc1
    s_waitcnt lgkmcnt(2)
    v_mfma_f32_16x16x32_bf16 v[88:91], v[20:23], v[160:163], v[88:91]
    v_mul_f32 v63, v55, v63
    v_add_f32 v8, 1.0, v8
    ds_read_b128 v[16:19], v5 offset:2048
    v_mfma_f32_16x16x32_bf16 v[92:95], v[20:23], v[164:167], v[92:95]
    v_add_f32 v9, 1.0, v9
    v_add_f32 v10, 1.0, v10
    s_nop 0
    s_waitcnt lgkmcnt(2)
    v_mfma_f32_16x16x32_bf16 v[248:251], v[24:27], v[160:163], v[248:251]
    s_add_u32 s29, s62, 16384
    v_add_f32 v11, 1.0, v11
    ds_read_b128 v[20:23], v5 offset:3072
    buffer_load_dwordx4 v[200:203], v4, s[8:11], s29 offen offset:1024 sc1
    v_mfma_f32_16x16x32_bf16 v[252:255], v[24:27], v[164:167], v[252:255]
    v_rcp_f32 v8, v8
    s_add_u32 s24, s63, 16384
    s_waitcnt lgkmcnt(2)
    v_mfma_f32_16x16x32_bf16 v[32:35], v[28:31], v[168:171], v[32:35]
    v_lshrrev_b32 v3, 7, v4
    v_lshlrev_b32 v3, 7, v3
    ds_read_b128 v[24:27], v5 offset:8192
    v_mfma_f32_16x16x32_bf16 v[36:39], v[28:31], v[172:175], v[36:39]
    buffer_load_dwordx4 v[204:207], v4, s[8:11], s24 offen offset:1024 sc1
    s_waitcnt lgkmcnt(2)
    v_mfma_f32_16x16x32_bf16 v[40:43], v[16:19], v[168:171], v[40:43]
    s_add_u32 s58, s51, 524288
    ds_read_b128 v[28:31], v5 offset:9216
    buffer_load_dword v6, v3, s[8:11], s58 offen sc1
    v_mfma_f32_16x16x32_bf16 v[44:47], v[16:19], v[172:175], v[44:47]
    v_rcp_f32 v9, v9
    s_nop 0
    s_waitcnt lgkmcnt(2)
    v_mfma_f32_16x16x32_bf16 v[64:67], v[20:23], v[168:171], v[64:67]
    s_add_u32 m0, s32, 65536
    v_rcp_f32 v10, v10
    s_add_u32 s25, s64, 98304
    ds_read_b128 v[16:19], v5 offset:10240
    v_mfma_f32_16x16x32_bf16 v[68:71], v[20:23], v[172:175], v[68:71]
    buffer_load_dwordx4 v4, s[8:11], s25 offen sc1 lds
    s_waitcnt lgkmcnt(2)
    v_mfma_f32_16x16x32_bf16 v[72:75], v[24:27], v[168:171], v[72:75]
    v_rcp_f32 v11, v11
    ds_read_b128 v[20:23], v5 offset:11264
    v_mfma_f32_16x16x32_bf16 v[76:79], v[24:27], v[172:175], v[76:79]
    v_mul_f32 v60, v60, v8
    v_mul_f32 v61, v61, v9
    s_nop 0
    s_waitcnt lgkmcnt(2)
    v_mfma_f32_16x16x32_bf16 v[80:83], v[28:31], v[168:171], v[80:83]
    s_add_u32 m0, s32, 8192
    v_add_u32 v5, 0x10000, v5
    v_mul_f32 v62, v62, v10
    s_add_u32 s26, s64, 102400
    ds_read_b128 v[24:27], v5 offset:49152
    v_mfma_f32_16x16x32_bf16 v[84:87], v[28:31], v[172:175], v[84:87]
    buffer_load_dwordx4 v4, s[8:11], s26 offen sc1 lds
    s_waitcnt lgkmcnt(2)
    v_mfma_f32_16x16x32_bf16 v[88:91], v[16:19], v[168:171], v[88:91]
    v_mul_f32 v63, v63, v11
    v_cvt_pk_bf16_f32 v102, v60, v61
    ds_read_b128 v[28:31], v5 offset:50176
    v_mfma_f32_16x16x32_bf16 v[92:95], v[16:19], v[172:175], v[92:95]
    v_cvt_pk_bf16_f32 v103, v62, v63
    v_min_u32 v100, -2, v100
    s_nop 0
    s_waitcnt lgkmcnt(2)
    v_mfma_f32_16x16x32_bf16 v[248:251], v[20:23], v[168:171], v[248:251]
    s_add_u32 m0, s32, 24576
    v_min_u32 v101, -2, v101
    v_min_u32 v102, -2, v102
    s_add_u32 s27, s64, 106496
    ds_read_b128 v[16:19], v5 offset:51200
    v_mfma_f32_16x16x32_bf16 v[252:255], v[20:23], v[172:175], v[252:255]
    buffer_load_dwordx4 v4, s[8:11], s27 offen sc1 lds
    s_waitcnt lgkmcnt(2)
    s_waitcnt vmcnt(12)
    v_mfma_f32_16x16x32_bf16 v[32:35], v[24:27], v[176:179], v[32:35]
    v_min_u32 v103, -2, v103
    ds_read_b128 v[20:23], v5 offset:52224
    s_waitcnt vmcnt(11)
    v_mfma_f32_16x16x32_bf16 v[36:39], v[24:27], v[180:183], v[36:39]
    s_waitcnt lgkmcnt(2)
    s_add_u32 s30, s33, 163840
    buffer_store_dwordx4 v[100:103], v4, s[8:11], s30 offen offset:3072 sc1
    v_mfma_f32_16x16x32_bf16 v[40:43], v[28:31], v[176:179], v[40:43]
    v_add_u32 v5, 0xffff6000, v5
    v_lshrrev_b32 v111, 6, v4
    ds_read_b128 v[24:27], v5 offset:0
    v_mfma_f32_16x16x32_bf16 v[44:47], v[28:31], v[180:183], v[44:47]
    v_mul_u32_u24 v109, 1152, v111
    v_bfe_u32 v110, v4, 4, 2
    s_nop 0
    s_waitcnt lgkmcnt(2)
    v_mfma_f32_16x16x32_bf16 v[64:67], v[16:19], v[176:179], v[64:67]
    v_lshl_add_u32 v108, v110, 4, v109
    v_lshl_add_u32 v109, v110, 3, v109
    ds_read_b128 v[28:31], v5 offset:1024
    v_mfma_f32_16x16x32_bf16 v[68:71], v[16:19], v[180:183], v[68:71]
    v_lshlrev_b32 v111, 7, v111
    v_bfe_u32 v106, v4, 4, 4
    s_nop 0
    s_waitcnt lgkmcnt(2)
    v_mfma_f32_16x16x32_bf16 v[72:75], v[20:23], v[176:179], v[72:75]
    s_add_u32 m0, s32, 81920
    v_and_b32 v110, 0x300, v4
    v_lshl_add_u32 v110, v106, 2, v110
    s_add_u32 s28, s64, 110592
    ds_read_b128 v[16:19], v5 offset:2048
    v_mfma_f32_16x16x32_bf16 v[76:79], v[20:23], v[180:183], v[76:79]
    buffer_load_dwordx4 v4, s[8:11], s28 offen sc1 lds
    s_waitcnt lgkmcnt(2)
    v_mfma_f32_16x16x32_bf16 v[80:83], v[24:27], v[176:179], v[80:83]
    v_mov_b32 v106, 0
    v_mov_b32 v107, 0
    ds_read_b128 v[20:23], v5 offset:3072
    v_mfma_f32_16x16x32_bf16 v[84:87], v[24:27], v[180:183], v[84:87]
    s_nop 3
    s_waitcnt lgkmcnt(2)
    v_mfma_f32_16x16x32_bf16 v[88:91], v[28:31], v[176:179], v[88:91]
    s_add_u32 m0, s32, 98304
    v_add_u32 v5, 0xffff2000, v5
    s_add_u32 s29, s64, 114688
    ds_read_b128 v[24:27], v5 offset:0
    v_mfma_f32_16x16x32_bf16 v[92:95], v[28:31], v[180:183], v[92:95]
    buffer_load_dwordx4 v4, s[8:11], s29 offen sc1 lds
    s_waitcnt lgkmcnt(2)
    v_mfma_f32_16x16x32_bf16 v[248:251], v[16:19], v[176:179], v[248:251]
    ds_read_b128 v[28:31], v5 offset:1024
    s_nop 2
    v_mfma_f32_16x16x32_bf16 v[252:255], v[16:19], v[180:183], v[252:255]
    s_barrier
    s_waitcnt lgkmcnt(2)
    s_waitcnt vmcnt(12)
    v_mfma_f32_16x16x32_bf16 v[32:35], v[20:23], v[184:187], v[32:35]
    s_add_u32 m0, s32, 114688
    s_waitcnt vmcnt(6)
    v_cmp_ne_u32 vcc, s54, v6
    s_add_u32 s24, s64, 118784
    ds_read_b128 v[16:19], v5 offset:2048
    v_mfma_f32_16x16x32_bf16 v[36:39], v[20:23], v[188:191], v[36:39]
    buffer_load_dwordx4 v4, s[8:11], s24 offen sc1 lds
    s_waitcnt lgkmcnt(2)
    v_mfma_f32_16x16x32_bf16 v[40:43], v[24:27], v[184:187], v[40:43]
    ds_read_b128 v[20:23], v5 offset:3072
    s_cbranch_vccnz L_sl5
L_bk5:
    s_nop 1
    v_mfma_f32_16x16x32_bf16 v[44:47], v[24:27], v[188:191], v[44:47]
    s_nop 3
    s_waitcnt lgkmcnt(2)
    v_mfma_f32_16x16x32_bf16 v[64:67], v[28:31], v[184:187], v[64:67]
    s_add_u32 s25, s62, 4096
    ds_read_b128 v[24:27], v5 offset:16384
    s_nop 2
    v_mfma_f32_16x16x32_bf16 v[68:71], v[28:31], v[188:191], v[68:71]
    buffer_load_dwordx4 v[208:211], v4, s[8:11], s25 offen offset:0 sc1
    s_waitcnt lgkmcnt(2)
    v_mfma_f32_16x16x32_bf16 v[72:75], v[16:19], v[184:187], v[72:75]
    ds_read_b128 v[28:31], v5 offset:17408
    s_nop 1
    v_mfma_f32_16x16x32_bf16 v[76:79], v[16:19], v[188:191], v[76:79]
    s_nop 2
    s_waitcnt lgkmcnt(2)
    v_mfma_f32_16x16x32_bf16 v[80:83], v[20:23], v[184:187], v[80:83]
    s_add_u32 s26, s63, 4096
    ds_read_b128 v[16:19], v5 offset:18432
    s_nop 1
    v_mfma_f32_16x16x32_bf16 v[84:87], v[20:23], v[188:191], v[84:87]
    s_waitcnt lgkmcnt(2)
    buffer_load_dwordx4 v[212:215], v4, s[8:11], s26 offen offset:0 sc1
    v_mfma_f32_16x16x32_bf16 v[88:91], v[24:27], v[184:187], v[88:91]
    ds_read_b128 v[20:23], v5 offset:19456
    s_nop 1
    v_mfma_f32_16x16x32_bf16 v[92:95], v[24:27], v[188:191], v[92:95]
    s_nop 2
    s_waitcnt lgkmcnt(2)
    v_mfma_f32_16x16x32_bf16 v[248:251], v[28:31], v[184:187], v[248:251]
    s_add_u32 s27, s62, 8192
    v_add_u32 v5, 0x12000, v5
    ds_read_b128 v[24:27], v5 offset:0
    buffer_load_dwordx4 v[216:219], v4, s[8:11], s27 offen offset:1024 sc1
    v_mfma_f32_16x16x32_bf16 v[252:255], v[28:31], v[188:191], v[252:255]
    s_add_u32 s28, s63, 8192
    s_nop 1
    s_waitcnt lgkmcnt(2)
    v_mfma_f32_16x16x32_bf16 v[32:35], v[16:19], v[192:195], v[32:35]
    v_lshrrev_b32 v3, 8, v4
    v_lshlrev_b32 v3, 7, v3
    s_and_b32 s58, s2, 0xfc
    s_lshl_b32 s58, s58, 7
    ds_read_b128 v[28:31], v5 offset:1024
    v_mfma_f32_16x16x32_bf16 v[36:39], v[16:19], v[196:199], v[36:39]
    buffer_load_dwordx4 v[220:223], v4, s[8:11], s28 offen offset:1024 sc1
    s_waitcnt lgkmcnt(2)
    v_mfma_f32_16x16x32_bf16 v[40:43], v[20:23], v[192:195], v[40:43]
    s_add_u32 s58, s58, 43122688
    ds_read_b128 v[16:19], v5 offset:2048
    buffer_load_dword v6, v3, s[8:11], s58 offen sc1
    v_mfma_f32_16x16x32_bf16 v[44:47], v[20:23], v[196:199], v[44:47]
    s_nop 3
    s_waitcnt lgkmcnt(2)
    v_mfma_f32_16x16x32_bf16 v[64:67], v[24:27], v[192:195], v[64:67]
    s_add_u32 s29, s62, 12288
    ds_read_b128 v[20:23], v5 offset:3072
    s_nop 2
    v_mfma_f32_16x16x32_bf16 v[68:71], v[24:27], v[196:199], v[68:71]
    buffer_load_dwordx4 v[224:227], v4, s[8:11], s29 offen offset:2048 sc1
    s_waitcnt lgkmcnt(2)
    v_mfma_f32_16x16x32_bf16 v[72:75], v[28:31], v[192:195], v[72:75]
    ds_read_b128 v[24:27], v5 offset:16384
    s_nop 1
    v_mfma_f32_16x16x32_bf16 v[76:79], v[28:31], v[196:199], v[76:79]
    s_nop 2
    s_waitcnt lgkmcnt(2)
    v_mfma_f32_16x16x32_bf16 v[80:83], v[16:19], v[192:195], v[80:83]
    s_add_u32 s24, s63, 12288
    ds_read_b128 v[28:31], v5 offset:17408
    s_nop 1
    v_mfma_f32_16x16x32_bf16 v[84:87], v[16:19], v[196:199], v[84:87]
    s_waitcnt lgkmcnt(2)
    buffer_load_dwordx4 v[228:231], v4, s[8:11], s24 offen offset:2048 sc1
    v_mfma_f32_16x16x32_bf16 v[88:91], v[20:23], v[192:195], v[88:91]
    ds_read_b128 v[16:19], v5 offset:18432
    s_nop 1
    v_mfma_f32_16x16x32_bf16 v[92:95], v[20:23], v[196:199], v[92:95]
    s_nop 2
    s_waitcnt lgkmcnt(2)
    v_mfma_f32_16x16x32_bf16 v[248:251], v[24:27], v[192:195], v[248:251]
    s_add_u32 s25, s62, 16384
    ds_read_b128 v[20:23], v5 offset:19456
    s_nop 1
    buffer_load_dwordx4 v[232:235], v4, s[8:11], s25 offen offset:3072 sc1
    v_mfma_f32_16x16x32_bf16 v[252:255], v[24:27], v[196:199], v[252:255]
    s_add_u32 s26, s63, 16384
    s_nop 1
    s_waitcnt lgkmcnt(2)
    v_mfma_f32_16x16x32_bf16 v[32:35], v[28:31], v[200:203], v[32:35]
    ds_read_b128 v[24:27], v5 offset:32768
    s_nop 1
    v_mfma_f32_16x16x32_bf16 v[36:39], v[28:31], v[204:207], v[36:39]
    s_waitcnt lgkmcnt(2)
    buffer_load_dwordx4 v[236:239], v4, s[8:11], s26 offen offset:3072 sc1
    v_mfma_f32_16x16x32_bf16 v[40:43], v[16:19], v[200:203], v[40:43]
    ds_read_b128 v[28:31], v5 offset:33792
    s_nop 1
    v_mfma_f32_16x16x32_bf16 v[44:47], v[16:19], v[204:207], v[44:47]
    s_waitcnt lgkmcnt(2)
    buffer_load_dword v104, v110, s[8:11], s61 offen offset:0 sc1
    v_mfma_f32_16x16x32_bf16 v[64:67], v[20:23], v[200:203], v[64:67]
    ds_read_b128 v[16:19], v5 offset:34816
    s_nop 1
    v_mfma_f32_16x16x32_bf16 v[68:71], v[20:23], v[204:207], v[68:71]
    s_waitcnt lgkmcnt(2)
    buffer_load_dword v105, v110, s[8:11], s61 offen offset:128 sc1
    v_mfma_f32_16x16x32_bf16 v[72:75], v[24:27], v[200:203], v[72:75]
    s_add_u32 m0, s32, 131072
    s_add_u32 s27, s64, 122880
    ds_read_b128 v[20:23], v5 offset:35840
    s_nop 0
    v_mfma_f32_16x16x32_bf16 v[76:79], v[24:27], v[204:207], v[76:79]
    s_waitcnt lgkmcnt(2)
    buffer_load_dwordx4 v4, s[8:11], s27 offen sc1 lds
    v_mfma_f32_16x16x32_bf16 v[80:83], v[28:31], v[200:203], v[80:83]
    ds_read_b128 v[24:27], v5 offset:49152
    s_nop 1
    v_mfma_f32_16x16x32_bf16 v[84:87], v[28:31], v[204:207], v[84:87]
    s_nop 2
    s_waitcnt lgkmcnt(2)
    v_mfma_f32_16x16x32_bf16 v[88:91], v[16:19], v[200:203], v[88:91]
    s_add_u32 m0, s32, 32768
    s_add_u32 s28, s64, 126976
    ds_read_b128 v[28:31], v5 offset:50176
    s_nop 0
    v_mfma_f32_16x16x32_bf16 v[92:95], v[16:19], v[204:207], v[92:95]
    s_waitcnt lgkmcnt(2)
    buffer_load_dwordx4 v4, s[8:11], s28 offen sc1 lds
    v_mfma_f32_16x16x32_bf16 v[248:251], v[20:23], v[200:203], v[248:251]
    ds_read_b128 v[16:19], v5 offset:51200
    s_nop 1
    s_waitcnt vmcnt(17)
    v_mfma_f32_16x16x32_bf16 v[252:255], v[20:23], v[204:207], v[252:255]
    s_barrier
    s_waitcnt lgkmcnt(2)
    s_waitcnt vmcnt(12)
    v_mfma_f32_16x16x32_bf16 v[32:35], v[24:27], v[208:211], v[32:35]
    s_add_u32 m0, s32, 40960
    s_add_u32 s29, s64, 131072
    ds_read_b128 v[20:23], v5 offset:52224
    s_nop 0
    s_waitcnt vmcnt(11)
    v_mfma_f32_16x16x32_bf16 v[36:39], v[24:27], v[212:215], v[36:39]
    s_waitcnt lgkmcnt(2)
    buffer_load_dwordx4 v4, s[8:11], s29 offen sc1 lds
    v_mfma_f32_16x16x32_bf16 v[40:43], v[28:31], v[208:211], v[40:43]
    v_add_u32 v5, 0x6000, v5
    s_waitcnt vmcnt(9)
    v_cmp_ne_u32 vcc, s54, v6
    ds_read_b128 v[24:27], v5 offset:40960
    v_mfma_f32_16x16x32_bf16 v[44:47], v[28:31], v[212:215], v[44:47]
    s_nop 2
    s_cbranch_vccnz L_sl9
L_bk9:
    s_nop 2
    s_waitcnt lgkmcnt(2)
    v_mfma_f32_16x16x32_bf16 v[64:67], v[16:19], v[208:211], v[64:67]
    s_add_u32 m0, s32, 147456
    v_add_u32 v12, s32, v4
    v_add_u32 v13, 98304, v12
    s_add_u32 s24, s64, 135168
    ds_read_b128 v[28:31], v5 offset:41984
    v_mfma_f32_16x16x32_bf16 v[68:71], v[16:19], v[212:215], v[68:71]
    buffer_load_dwordx4 v4, s[8:11], s24 offen sc1 lds
    s_waitcnt lgkmcnt(2)
    v_mfma_f32_16x16x32_bf16 v[72:75], v[20:23], v[208:211], v[72:75]
    v_add_u32 v14, 49152, v12
    ds_read_b128 v[16:19], v5 offset:43008
    v_mfma_f32_16x16x32_bf16 v[76:79], v[20:23], v[212:215], v[76:79]
    s_nop 3
    s_waitcnt lgkmcnt(2)
    v_mfma_f32_16x16x32_bf16 v[80:83], v[24:27], v[208:211], v[80:83]
    s_add_u32 m0, s32, 57344
    s_add_u32 s25, s64, 139264
    ds_read_b128 v[20:23], v5 offset:44032
    s_nop 1
    v_mfma_f32_16x16x32_bf16 v[84:87], v[24:27], v[212:215], v[84:87]
    buffer_load_dwordx4 v4, s[8:11], s25 offen sc1 lds
    s_waitcnt lgkmcnt(2)
    v_mfma_f32_16x16x32_bf16 v[88:91], v[28:31], v[208:211], v[88:91]
    v_add_u32 v5, 0xffff4000, v5
    ds_read_b128 v[24:27], v5 offset:0
    v_mfma_f32_16x16x32_bf16 v[92:95], v[28:31], v[212:215], v[92:95]
    s_nop 3
    s_waitcnt lgkmcnt(2)
    v_mfma_f32_16x16x32_bf16 v[248:251], v[16:19], v[208:211], v[248:251]
    s_add_u32 m0, s32, 0
    s_add_u32 s26, s65, 143360
    ds_read_b128 v[28:31], v5 offset:1024
    s_nop 0
    v_mfma_f32_16x16x32_bf16 v[252:255], v[16:19], v[212:215], v[252:255]
    s_waitcnt lgkmcnt(2)
    buffer_load_dwordx4 v4, s[8:11], s26 offen sc1 lds
    v_mfma_f32_16x16x32_bf16 v[32:35], v[20:23], v[216:219], v[32:35]
    ds_read_b128 v[16:19], v5 offset:2048
    s_nop 1
    v_mfma_f32_16x16x32_bf16 v[36:39], v[20:23], v[220:223], v[36:39]
    s_nop 2
    s_waitcnt lgkmcnt(2)
    v_mfma_f32_16x16x32_bf16 v[40:43], v[24:27], v[216:219], v[40:43]
    s_add_u32 s27, s62, 0
    ds_read_b128 v[20:23], v5 offset:3072
    s_nop 1
    v_mfma_f32_16x16x32_bf16 v[44:47], v[24:27], v[220:223], v[44:47]
    s_waitcnt lgkmcnt(2)
    buffer_load_dwordx4 v[240:243], v4, s[8:11], s27 offen offset:3072 sc1
    v_mfma_f32_16x16x32_bf16 v[64:67], v[28:31], v[216:219], v[64:67]
    ds_read_b128 v[24:27], v5 offset:16384
    s_nop 1
    v_mfma_f32_16x16x32_bf16 v[68:71], v[28:31], v[220:223], v[68:71]
    s_nop 2
    s_waitcnt lgkmcnt(2)
    v_mfma_f32_16x16x32_bf16 v[72:75], v[16:19], v[216:219], v[72:75]
    s_add_u32 s28, s63, 0
    ds_read_b128 v[28:31], v5 offset:17408
    s_nop 1
    v_mfma_f32_16x16x32_bf16 v[76:79], v[16:19], v[220:223], v[76:79]
    s_waitcnt lgkmcnt(2)
    buffer_load_dwordx4 v[244:247], v4, s[8:11], s28 offen offset:3072 sc1
    v_mfma_f32_16x16x32_bf16 v[80:83], v[20:23], v[216:219], v[80:83]
    ds_read_b128 v[16:19], v5 offset:18432
    s_nop 1
    v_mfma_f32_16x16x32_bf16 v[84:87], v[20:23], v[220:223], v[84:87]
    s_nop 2
    s_waitcnt lgkmcnt(2)
    v_mfma_f32_16x16x32_bf16 v[88:91], v[24:27], v[216:219], v[88:91]
    s_add_u32 m0, s32, 16384
    s_add_u32 s29, s65, 147456
    ds_read_b128 v[20:23], v5 offset:19456
    s_nop 0
    v_mfma_f32_16x16x32_bf16 v[92:95], v[24:27], v[220:223], v[92:95]
    s_waitcnt lgkmcnt(2)
    buffer_load_dwordx4 v4, s[8:11], s29 offen sc1 lds
    v_mfma_f32_16x16x32_bf16 v[248:251], v[28:31], v[216:219], v[248:251]
    v_add_u32 v5, 0xffff6000, v5
    ds_read_b128 v[24:27], v5 offset:0
    v_mfma_f32_16x16x32_bf16 v[252:255], v[28:31], v[220:223], v[252:255]
    s_nop 2
    s_waitcnt lgkmcnt(2)
    s_waitcnt vmcnt(14)
    v_mfma_f32_16x16x32_bf16 v[32:35], v[16:19], v[224:227], v[32:35]
    s_add_u32 s24, s62, 8192
    ds_read_b128 v[28:31], v5 offset:1024
    s_nop 1
    s_waitcnt vmcnt(13)
    v_mfma_f32_16x16x32_bf16 v[36:39], v[16:19], v[228:231], v[36:39]
    s_waitcnt lgkmcnt(2)
    buffer_load_dwordx4 v[48:51], v4, s[8:11], s24 offen offset:0 sc1
    v_mfma_f32_16x16x32_bf16 v[40:43], v[20:23], v[224:227], v[40:43]
    ds_read_b128 v[16:19], v5 offset:2048
    s_nop 1
    v_mfma_f32_16x16x32_bf16 v[44:47], v[20:23], v[228:231], v[44:47]
    s_nop 2
    s_waitcnt lgkmcnt(2)
    v_mfma_f32_16x16x32_bf16 v[64:67], v[24:27], v[224:227], v[64:67]
    s_add_u32 s25, s63, 8192
    ds_read_b128 v[20:23], v5 offset:3072
    s_nop 1
    v_mfma_f32_16x16x32_bf16 v[68:71], v[24:27], v[228:231], v[68:71]
    s_waitcnt lgkmcnt(2)
    buffer_load_dwordx4 v[52:55], v4, s[8:11], s25 offen offset:0 sc1
    v_mfma_f32_16x16x32_bf16 v[72:75], v[28:31], v[224:227], v[72:75]
    ds_read_b128 v[24:27], v5 offset:16384
    s_nop 1
    v_mfma_f32_16x16x32_bf16 v[76:79], v[28:31], v[228:231], v[76:79]
    s_nop 2
    s_waitcnt lgkmcnt(2)
    v_mfma_f32_16x16x32_bf16 v[80:83], v[16:19], v[224:227], v[80:83]
    s_add_u32 m0, s32, 73728
    s_add_u32 s26, s64, 151552
    ds_read_b128 v[28:31], v5 offset:17408
    s_nop 0
    v_mfma_f32_16x16x32_bf16 v[84:87], v[16:19], v[228:231], v[84:87]
    s_waitcnt lgkmcnt(2)
    buffer_load_dwordx4 v4, s[8:11], s26 offen sc1 lds
    v_mfma_f32_16x16x32_bf16 v[88:91], v[20:23], v[224:227], v[88:91]
    ds_read_b128 v[16:19], v5 offset:18432
    s_nop 1
    v_mfma_f32_16x16x32_bf16 v[92:95], v[20:23], v[228:231], v[92:95]
    s_nop 2
    s_waitcnt lgkmcnt(2)
    v_mfma_f32_16x16x32_bf16 v[248:251], v[24:27], v[224:227], v[248:251]
    s_add_u32 m0, s32, 90112
    s_add_u32 s27, s64, 155648
    ds_read_b128 v[20:23], v5 offset:19456
    s_nop 0
    s_waitcnt vmcnt(11)
    v_mfma_f32_16x16x32_bf16 v[252:255], v[24:27], v[228:231], v[252:255]
    s_barrier
    s_waitcnt lgkmcnt(2)
    v_mfma_f32_16x16x32_bf16 v[32:35], v[28:31], v[232:235], v[32:35]
    v_add_u32 v5, 0x12000, v5
    ds_read_b128 v[24:27], v5 offset:0
    v_mfma_f32_16x16x32_bf16 v[36:39], v[28:31], v[236:239], v[36:39]
    s_waitcnt lgkmcnt(2)
    buffer_load_dwordx4 v4, s[8:11], s27 offen sc1 lds
    v_mfma_f32_16x16x32_bf16 v[40:43], v[16:19], v[232:235], v[40:43]
    s_add_u32 s28, s62, 12288
    ds_read_b128 v[28:31], v5 offset:1024
    s_nop 1
    v_mfma_f32_16x16x32_bf16 v[44:47], v[16:19], v[236:239], v[44:47]
    s_waitcnt lgkmcnt(2)
    buffer_load_dwordx4 v[56:59], v4, s[8:11], s28 offen offset:1024 sc1
    v_mfma_f32_16x16x32_bf16 v[64:67], v[20:23], v[232:235], v[64:67]
    ds_read_b128 v[16:19], v5 offset:2048
    s_nop 1
    v_mfma_f32_16x16x32_bf16 v[68:71], v[20:23], v[236:239], v[68:71]
    s_nop 2
    s_waitcnt lgkmcnt(2)
    v_mfma_f32_16x16x32_bf16 v[72:75], v[24:27], v[232:235], v[72:75]
    s_add_u32 s29, s63, 12288
    ds_read_b128 v[20:23], v5 offset:3072
    s_nop 1
    v_mfma_f32_16x16x32_bf16 v[76:79], v[24:27], v[236:239], v[76:79]
    s_waitcnt lgkmcnt(2)
    buffer_load_dwordx4 v[60:63], v4, s[8:11], s29 offen offset:1024 sc1
    v_mfma_f32_16x16x32_bf16 v[80:83], v[28:31], v[232:235], v[80:83]
    s_waitcnt vmcnt(8)
    v_max3_u32 v3, v240, v241, v242
    s_waitcnt vmcnt(7)
    v_max3_u32 v6, v243, v244, v245
    ds_read_b128 v[24:27], v5 offset:16384
    v_mfma_f32_16x16x32_bf16 v[84:87], v[28:31], v[236:239], v[84:87]
    v_max3_u32 v3, v3, v246, v247
    v_max_u32 v3, v3, v6
    s_nop 0
    s_waitcnt lgkmcnt(2)
    v_mfma_f32_16x16x32_bf16 v[88:91], v[16:19], v[232:235], v[88:91]
    s_add_u32 m0, s32, 106496
    v_cmp_eq_u32 vcc, -1, v3
    s_add_u32 s24, s64, 159744
    ds_read_b128 v[28:31], v5 offset:17408
    v_mfma_f32_16x16x32_bf16 v[92:95], v[16:19], v[236:239], v[92:95]
    buffer_load_dwordx4 v4, s[8:11], s24 offen sc1 lds
    s_waitcnt lgkmcnt(2)
    v_mfma_f32_16x16x32_bf16 v[248:251], v[20:23], v[232:235], v[248:251]
    ds_read_b128 v[16:19], v5 offset:18432
    s_cbranch_vccnz L_sl10
L_bk10:
    s_nop 1
    v_mfma_f32_16x16x32_bf16 v[252:255], v[20:23], v[236:239], v[252:255]
    s_nop 3
    s_waitcnt lgkmcnt(2)
    v_mfma_f32_16x16x32_bf16 v[32:35], v[24:27], v[240:243], v[32:35]
    s_add_u32 s25, s62, 16384
    ds_read_b128 v[20:23], v5 offset:19456
    s_nop 2
    v_mfma_f32_16x16x32_bf16 v[36:39], v[24:27], v[244:247], v[36:39]
    buffer_load_dwordx4 v[96:99], v4, s[8:11], s25 offen offset:2048 sc1
    s_waitcnt lgkmcnt(2)
    v_mfma_f32_16x16x32_bf16 v[40:43], v[28:31], v[240:243], v[40:43]
    ds_read_b128 v[24:27], v5 offset:32768
    s_nop 1
    v_mfma_f32_16x16x32_bf16 v[44:47], v[28:31], v[244:247], v[44:47]
    s_nop 2
    s_waitcnt lgkmcnt(2)
    v_mfma_f32_16x16x32_bf16 v[64:67], v[16:19], v[240:243], v[64:67]
    s_add_u32 s26, s63, 16384
    ds_read_b128 v[28:31], v5 offset:33792
    s_nop 1
    v_mfma_f32_16x16x32_bf16 v[68:71], v[16:19], v[244:247], v[68:71]
    s_waitcnt lgkmcnt(2)
    buffer_load_dwordx4 v[100:103], v4, s[8:11], s26 offen offset:2048 sc1
    v_mfma_f32_16x16x32_bf16 v[72:75], v[20:23], v[240:243], v[72:75]
    ds_read_b128 v[16:19], v5 offset:34816
    s_nop 1
    v_mfma_f32_16x16x32_bf16 v[76:79], v[20:23], v[244:247], v[76:79]
    s_waitcnt vmcnt(8)
    v_max3_u32 v3, v48, v49, v50
    s_waitcnt vmcnt(7)
    v_max3_u32 v6, v51, v52, v53
    s_nop 0
    s_waitcnt lgkmcnt(2)
    v_mfma_f32_16x16x32_bf16 v[80:83], v[24:27], v[240:243], v[80:83]
    s_add_u32 m0, s32, 122880
    v_max3_u32 v3, v3, v54, v55
    v_max_u32 v3, v3, v6
    s_add_u32 s27, s64, 163840
    ds_read_b128 v[20:23], v5 offset:35840
    v_mfma_f32_16x16x32_bf16 v[84:87], v[24:27], v[244:247], v[84:87]
    buffer_load_dwordx4 v4, s[8:11], s27 offen sc1 lds
    s_waitcnt lgkmcnt(2)
    v_mfma_f32_16x16x32_bf16 v[88:91], v[28:31], v[240:243], v[88:91]
    v_cmp_eq_u32 vcc, -1, v3
    ds_read_b128 v[24:27], v5 offset:49152
    v_mfma_f32_16x16x32_bf16 v[92:95], v[28:31], v[244:247], v[92:95]
    s_nop 2
    s_cbranch_vccnz L_sl11
L_bk11:
    s_nop 2
    s_waitcnt lgkmcnt(2)
    v_mfma_f32_16x16x32_bf16 v[248:251], v[16:19], v[240:243], v[248:251]
    s_add_u32 m0, s32, 139264
    s_add_u32 s28, s64, 167936
    ds_read_b128 v[28:31], v5 offset:50176
    s_nop 1
    v_mfma_f32_16x16x32_bf16 v[252:255], v[16:19], v[244:247], v[252:255]
    s_barrier
    s_waitcnt lgkmcnt(2)
    v_mfma_f32_16x16x32_bf16 v[32:35], v[20:23], v[48:51], v[32:35]
    ds_read_b128 v[16:19], v5 offset:51200
    s_nop 2
    v_mfma_f32_16x16x32_bf16 v[36:39], v[20:23], v[52:55], v[36:39]
    buffer_load_dwordx4 v4, s[8:11], s28 offen sc1 lds
    s_waitcnt lgkmcnt(2)
    v_mfma_f32_16x16x32_bf16 v[40:43], v[24:27], v[48:51], v[40:43]
    s_add_u32 m0, s32, 98304
    s_add_u32 s29, s65, 192512
    ds_read_b128 v[20:23], v5 offset:52224
    s_nop 0
    v_mfma_f32_16x16x32_bf16 v[44:47], v[24:27], v[52:55], v[44:47]
    s_waitcnt lgkmcnt(2)
    buffer_load_dwordx4 v4, s[8:11], s29 offen sc1 lds
    v_mfma_f32_16x16x32_bf16 v[64:67], v[28:31], v[48:51], v[64:67]
    v_add_u32 v5, 0xffff4000, v5
    ds_read_b128 v[24:27], v5 offset:0
    v_mfma_f32_16x16x32_bf16 v[68:71], v[28:31], v[52:55], v[68:71]
    s_nop 2
    s_waitcnt lgkmcnt(2)
    v_mfma_f32_16x16x32_bf16 v[72:75], v[16:19], v[48:51], v[72:75]
    s_add_u32 m0, s32, 49152
    s_add_u32 s24, s64, 172032
    ds_read_b128 v[28:31], v5 offset:1024
    s_nop 0
    v_mfma_f32_16x16x32_bf16 v[76:79], v[16:19], v[52:55], v[76:79]
    s_waitcnt lgkmcnt(2)
    buffer_load_dwordx4 v4, s[8:11], s24 offen sc1 lds
    v_mfma_f32_16x16x32_bf16 v[80:83], v[20:23], v[48:51], v[80:83]
    s_waitcnt vmcnt(8)
    v_max3_u32 v3, v56, v57, v58
    s_waitcnt vmcnt(7)
    v_max3_u32 v6, v59, v60, v61
    ds_read_b128 v[16:19], v5 offset:2048
    v_mfma_f32_16x16x32_bf16 v[84:87], v[20:23], v[52:55], v[84:87]
    v_max3_u32 v3, v3, v62, v63
    v_max_u32 v3, v3, v6
    s_nop 0
    s_waitcnt lgkmcnt(2)
    v_mfma_f32_16x16x32_bf16 v[88:91], v[24:27], v[48:51], v[88:91]
    s_add_u32 m0, s32, 65536
    v_cmp_eq_u32 vcc, -1, v3
    s_add_u32 s25, s64, 176128
    ds_read_b128 v[20:23], v5 offset:3072
    v_mfma_f32_16x16x32_bf16 v[92:95], v[24:27], v[52:55], v[92:95]
    buffer_load_dwordx4 v4, s[8:11], s25 offen sc1 lds
    s_waitcnt lgkmcnt(2)
    v_mfma_f32_16x16x32_bf16 v[248:251], v[28:31], v[48:51], v[248:251]
    ds_read_b128 v[24:27], v5 offset:8192
    s_cbranch_vccnz L_sl12
L_bk12:
    s_nop 1
    v_mfma_f32_16x16x32_bf16 v[252:255], v[28:31], v[52:55], v[252:255]
    s_nop 3
    s_waitcnt lgkmcnt(2)
    v_mfma_f32_16x16x32_bf16 v[32:35], v[16:19], v[56:59], v[32:35]
    s_add_u32 m0, s32, 8192
    s_add_u32 s26, s64, 180224
    ds_read_b128 v[28:31], v5 offset:9216
    s_nop 1
    v_mfma_f32_16x16x32_bf16 v[36:39], v[16:19], v[60:63], v[36:39]
    buffer_load_dwordx4 v4, s[8:11], s26 offen sc1 lds
    s_waitcnt lgkmcnt(2)
    v_mfma_f32_16x16x32_bf16 v[40:43], v[20:23], v[56:59], v[40:43]
    ds_read_b128 v[16:19], v5 offset:10240
    s_nop 1
    v_mfma_f32_16x16x32_bf16 v[44:47], v[20:23], v[60:63], v[44:47]
    s_nop 2
    s_waitcnt lgkmcnt(2)
    v_mfma_f32_16x16x32_bf16 v[64:67], v[24:27], v[56:59], v[64:67]
    s_add_u32 m0, s32, 24576
    s_add_u32 s27, s64, 184320
    ds_read_b128 v[20:23], v5 offset:11264
    s_nop 0
    v_mfma_f32_16x16x32_bf16 v[68:71], v[24:27], v[60:63], v[68:71]
    s_waitcnt lgkmcnt(2)
    buffer_load_dwordx4 v4, s[8:11], s27 offen sc1 lds
    v_mfma_f32_16x16x32_bf16 v[72:75], v[28:31], v[56:59], v[72:75]
    v_add_u32 v5, 0x10000, v5
    ds_read_b128 v[24:27], v5 offset:49152
    v_mfma_f32_16x16x32_bf16 v[76:79], v[28:31], v[60:63], v[76:79]
    s_waitcnt vmcnt(8)
    v_max3_u32 v3, v96, v97, v98
    s_waitcnt vmcnt(7)
    v_max3_u32 v6, v99, v100, v101
    s_nop 0
    s_waitcnt lgkmcnt(2)
    v_mfma_f32_16x16x32_bf16 v[80:83], v[16:19], v[56:59], v[80:83]
    s_add_u32 m0, s32, 81920
    v_max3_u32 v3, v3, v102, v103
    v_max_u32 v3, v3, v6
    s_add_u32 s28, s64, 188416
    ds_read_b128 v[28:31], v5 offset:50176
    v_mfma_f32_16x16x32_bf16 v[84:87], v[16:19], v[60:63], v[84:87]
    buffer_load_dwordx4 v4, s[8:11], s28 offen sc1 lds
    s_waitcnt lgkmcnt(2)
    v_mfma_f32_16x16x32_bf16 v[88:91], v[20:23], v[56:59], v[88:91]
    v_cmp_eq_u32 vcc, -1, v3
    ds_read_b128 v[16:19], v5 offset:51200
    v_mfma_f32_16x16x32_bf16 v[92:95], v[20:23], v[60:63], v[92:95]
    s_nop 2
    s_cbranch_vccnz L_sl13
L_bk13:
    s_nop 2
    s_waitcnt lgkmcnt(2)
    v_mfma_f32_16x16x32_bf16 v[248:251], v[24:27], v[56:59], v[248:251]
    ds_read_b128 v[20:23], v5 offset:52224
    s_nop 2
    v_mfma_f32_16x16x32_bf16 v[252:255], v[24:27], v[60:63], v[252:255]
    s_barrier
    s_waitcnt lgkmcnt(2)
    v_mfma_f32_16x16x32_bf16 v[32:35], v[28:31], v[96:99], v[32:35]
    v_add_u32 v5, 0xffff6000, v5
    ds_read_b128 v[24:27], v5 offset:0
    v_mfma_f32_16x16x32_bf16 v[36:39], v[28:31], v[100:103], v[36:39]
    buffer_load_dwordx4 v[8:11], v108, s[16:19], s59 offen
    s_waitcnt lgkmcnt(2)
    v_mfma_f32_16x16x32_bf16 v[40:43], v[16:19], v[96:99], v[40:43]
    ds_read_b128 v[28:31], v5 offset:1024
    s_nop 1
    v_mfma_f32_16x16x32_bf16 v[44:47], v[16:19], v[100:103], v[44:47]
    s_waitcnt lgkmcnt(2)
    buffer_load_dwordx2 v[0:1], v109, s[16:19], s60 offen
    v_mfma_f32_16x16x32_bf16 v[64:67], v[20:23], v[96:99], v[64:67]
    ds_read_b128 v[16:19], v5 offset:2048
    s_nop 1
    v_mfma_f32_16x16x32_bf16 v[68:71], v[20:23], v[100:103], v[68:71]
    ds_write_b128 v13, v[36:39] offset:16384
    s_nop 0
    s_waitcnt lgkmcnt(3)
    v_mfma_f32_16x16x32_bf16 v[72:75], v[24:27], v[96:99], v[72:75]
    ds_read_b128 v[20:23], v5 offset:3072
    s_nop 1
    v_mfma_f32_16x16x32_bf16 v[76:79], v[24:27], v[100:103], v[76:79]
    s_waitcnt lgkmcnt(3)
    buffer_load_dword v15, v111, s[8:11], s70 offen offset:8 sc1
    v_mfma_f32_16x16x32_bf16 v[80:83], v[28:31], v[96:99], v[80:83]
    v_add_u32 v5, 0xffff2000, v5
    ds_read_b128 v[24:27], v5 offset:0
    ds_write_b128 v13, v[44:47] offset:32768
    v_mfma_f32_16x16x32_bf16 v[84:87], v[28:31], v[100:103], v[84:87]
    s_nop 2
    s_waitcnt lgkmcnt(4)
    v_mfma_f32_16x16x32_bf16 v[88:91], v[16:19], v[96:99], v[88:91]
    ds_read_b128 v[28:31], v5 offset:1024
    s_nop 1
    v_mfma_f32_16x16x32_bf16 v[92:95], v[16:19], v[100:103], v[92:95]
    ds_write_b128 v12, v[68:71] offset:32768
    s_nop 0
    s_waitcnt lgkmcnt(4)
    v_mfma_f32_16x16x32_bf16 v[248:251], v[20:23], v[96:99], v[248:251]
    ds_read_b128 v[16:19], v5 offset:2048
    s_nop 1
    v_mfma_f32_16x16x32_bf16 v[252:255], v[20:23], v[100:103], v[252:255]
    s_nop 2
    s_waitcnt lgkmcnt(4)
    v_mfma_f32_16x16x32_bf16 v[32:35], v[24:27], v[104:107], v[32:35]
    ds_read_b128 v[20:23], v5 offset:3072
    ds_write_b128 v12, v[76:79] offset:40960
    s_waitcnt lgkmcnt(4)
    v_mfma_f32_16x16x32_bf16 v[40:43], v[28:31], v[104:107], v[40:43]
    ds_read_b128 v[24:27], v5 offset:16384
    s_nop 0
    s_waitcnt lgkmcnt(3)
    v_mfma_f32_16x16x32_bf16 v[64:67], v[16:19], v[104:107], v[64:67]
    ds_read_b128 v[28:31], v5 offset:17408
    s_nop 0
    s_waitcnt lgkmcnt(3)
    v_mfma_f32_16x16x32_bf16 v[72:75], v[20:23], v[104:107], v[72:75]
    ds_read_b128 v[16:19], v5 offset:18432
    ds_write_b128 v13, v[84:87] offset:57344
    s_waitcnt lgkmcnt(3)
    v_mfma_f32_16x16x32_bf16 v[80:83], v[24:27], v[104:107], v[80:83]
    s_waitcnt lgkmcnt(2)
    v_add_u32 v5, 0x12000, v5
    ds_read_b128 v[20:23], v5 offset:0
    v_mfma_f32_16x16x32_bf16 v[88:91], v[28:31], v[104:107], v[88:91]
    ds_read_b128 v[24:27], v5 offset:1024
    s_nop 0
    s_waitcnt lgkmcnt(3)
    v_mfma_f32_16x16x32_bf16 v[248:251], v[16:19], v[104:107], v[248:251]
    s_barrier
    s_waitcnt lgkmcnt(1)
    ds_read_b128 v[28:31], v5 offset:2048
    v_mfma_f32_16x16x32_bf16 v[36:39], v[20:23], v[112:115], 0
    ds_read_b128 v[16:19], v5 offset:3072
    ds_write_b128 v13, v[92:95] offset:49152
    s_nop 0
    v_mfma_f32_16x16x32_bf16 v[44:47], v[20:23], v[116:119], 0
    ds_write_b128 v14, v[252:255] offset:8192
    s_nop 0
    s_waitcnt lgkmcnt(4)
    v_mfma_f32_16x16x32_bf16 v[36:39], v[24:27], v[120:123], v[36:39]
    v_xor_b32 v12, 0x1000, v12
    v_xor_b32 v13, 0x1000, v13
    ds_read_b128 v[20:23], v5 offset:16384
    v_xor_b32 v14, 0x1000, v14
    s_waitcnt vmcnt(9) lgkmcnt(1)
    v_mfma_f32_16x16x32_bf16 v[44:47], v[24:27], v[124:127], v[44:47]
    s_barrier
    ds_read_b128 v[84:87], v13 offset:16384
    ds_read_b128 v[92:95], v13 offset:32768
    ds_read_b128 v[252:255], v12 offset:32768
    s_waitcnt lgkmcnt(2)
    v_add_f32 v32, v32, v84
    v_add_f32 v33, v33, v85
    v_add_f32 v34, v34, v86
    v_add_f32 v35, v35, v87
    ds_read_b128 v[84:87], v12 offset:40960
    s_waitcnt lgkmcnt(2)
    v_add_f32 v40, v40, v92
    v_add_f32 v41, v41, v93
    v_add_f32 v42, v42, v94
    v_add_f32 v43, v43, v95
    ds_read_b128 v[92:95], v13 offset:57344
    v_cvt_pk_bf16_f32 v32, v32, v33
    v_cvt_pk_bf16_f32 v33, v34, v35
    v_cvt_pk_bf16_f32 v34, v40, v41
    v_cvt_pk_bf16_f32 v35, v42, v43
    v_min_u32 v32, -2, v32
    v_min_u32 v33, -2, v33
    v_min_u32 v34, -2, v34
    v_min_u32 v35, -2, v35
    buffer_store_dwordx4 v[32:35], v4, s[8:11], s66 offen sc1
    s_waitcnt lgkmcnt(2)
    v_add_f32 v64, v64, v252
    v_add_f32 v65, v65, v253
    v_add_f32 v66, v66, v254
    v_add_f32 v67, v67, v255
    ds_read_b128 v[252:255], v13 offset:49152
    s_waitcnt lgkmcnt(2)
    v_add_f32 v72, v72, v84
    v_add_f32 v73, v73, v85
    v_add_f32 v74, v74, v86
    v_add_f32 v75, v75, v87
    ds_read_b128 v[84:87], v14 offset:8192
    v_cvt_pk_bf16_f32 v64, v64, v65
    v_cvt_pk_bf16_f32 v65, v66, v67
    v_cvt_pk_bf16_f32 v66, v72, v73
    v_cvt_pk_bf16_f32 v67, v74, v75
    v_min_u32 v64, -2, v64
    v_min_u32 v65, -2, v65
    v_min_u32 v66, -2, v66
    v_min_u32 v67, -2, v67
    buffer_store_dwordx4 v[64:67], v4, s[8:11], s67 offen sc1
    s_waitcnt lgkmcnt(2)
    v_add_f32 v80, v80, v92
    v_add_f32 v81, v81, v93
    v_add_f32 v82, v82, v94
    v_add_f32 v83, v83, v95
    s_waitcnt lgkmcnt(1)
    v_add_f32 v88, v88, v252
    v_add_f32 v89, v89, v253
    v_add_f32 v90, v90, v254
    v_add_f32 v91, v91, v255
    v_cvt_pk_bf16_f32 v80, v80, v81
    v_cvt_pk_bf16_f32 v81, v82, v83
    v_cvt_pk_bf16_f32 v82, v88, v89
    v_cvt_pk_bf16_f32 v83, v90, v91
    v_min_u32 v80, -2, v80
    v_min_u32 v81, -2, v81
    v_min_u32 v82, -2, v82
    v_min_u32 v83, -2, v83
    buffer_store_dwordx4 v[80:83], v4, s[8:11], s68 offen sc1
    s_waitcnt lgkmcnt(0)
    v_add_f32 v248, v248, v84
    v_add_f32 v249, v249, v85
    v_add_f32 v250, v250, v86
    v_add_f32 v251, v251, v87
    v_cvt_pk_bf16_f32 v92, v248, v249
    v_cvt_pk_bf16_f32 v93, v250, v251
    v_min_u32 v92, -2, v92
    v_min_u32 v93, -2, v93
    buffer_store_dwordx2 v[92:93], v2, s[8:11], s69 offen sc1
    v_mfma_f32_16x16x32_bf16 v[36:39], v[28:31], v[128:131], v[36:39]
    ds_read_b128 v[24:27], v5 offset:17408
    s_nop 2
    v_mfma_f32_16x16x32_bf16 v[44:47], v[28:31], v[132:135], v[44:47]
    s_nop 3
    v_mfma_f32_16x16x32_bf16 v[36:39], v[16:19], v[136:139], v[36:39]
    ds_read_b128 v[28:31], v5 offset:18432
    s_nop 2
    v_mfma_f32_16x16x32_bf16 v[44:47], v[16:19], v[140:143], v[44:47]
    s_nop 3
    v_mfma_f32_16x16x32_bf16 v[36:39], v[20:23], v[144:147], v[36:39]
    ds_read_b128 v[16:19], v5 offset:19456
    s_nop 1
    v_mfma_f32_16x16x32_bf16 v[44:47], v[20:23], v[148:151], v[44:47]
    s_nop 2
    s_waitcnt lgkmcnt(2)
    v_mfma_f32_16x16x32_bf16 v[36:39], v[24:27], v[152:155], v[36:39]
    ds_read_b128 v[20:23], v5 offset:32768
    s_nop 1
    v_mfma_f32_16x16x32_bf16 v[44:47], v[24:27], v[156:159], v[44:47]
    s_nop 2
    s_waitcnt lgkmcnt(2)
    v_mfma_f32_16x16x32_bf16 v[36:39], v[28:31], v[160:163], v[36:39]
    ds_read_b128 v[24:27], v5 offset:33792
    s_nop 1
    v_mfma_f32_16x16x32_bf16 v[44:47], v[28:31], v[164:167], v[44:47]
    s_nop 2
    s_waitcnt lgkmcnt(2)
    v_mfma_f32_16x16x32_bf16 v[36:39], v[16:19], v[168:171], v[36:39]
    ds_read_b128 v[28:31], v5 offset:34816
    s_nop 1
    v_mfma_f32_16x16x32_bf16 v[44:47], v[16:19], v[172:175], v[44:47]
    s_nop 2
    s_waitcnt lgkmcnt(2)
    v_mfma_f32_16x16x32_bf16 v[36:39], v[20:23], v[176:179], v[36:39]
    ds_read_b128 v[16:19], v5 offset:35840
    s_nop 1
    v_mfma_f32_16x16x32_bf16 v[44:47], v[20:23], v[180:183], v[44:47]
    s_nop 2
    s_waitcnt lgkmcnt(2)
    v_mfma_f32_16x16x32_bf16 v[36:39], v[24:27], v[184:187], v[36:39]
    ds_read_b128 v[20:23], v5 offset:49152
    s_nop 1
    v_mfma_f32_16x16x32_bf16 v[44:47], v[24:27], v[188:191], v[44:47]
    s_nop 2
    s_waitcnt lgkmcnt(2)
    v_mfma_f32_16x16x32_bf16 v[36:39], v[28:31], v[192:195], v[36:39]
    ds_read_b128 v[24:27], v5 offset:50176
    s_nop 1
    v_mfma_f32_16x16x32_bf16 v[44:47], v[28:31], v[196:199], v[44:47]
    s_nop 2
    s_waitcnt lgkmcnt(2)
    v_mfma_f32_16x16x32_bf16 v[36:39], v[16:19], v[200:203], v[36:39]
    ds_read_b128 v[28:31], v5 offset:51200
    s_nop 1
    v_mfma_f32_16x16x32_bf16 v[44:47], v[16:19], v[204:207], v[44:47]
    s_nop 2
    s_waitcnt lgkmcnt(2)
    v_mfma_f32_16x16x32_bf16 v[36:39], v[20:23], v[208:211], v[36:39]
    ds_read_b128 v[16:19], v5 offset:52224
    s_nop 1
    v_mfma_f32_16x16x32_bf16 v[44:47], v[20:23], v[212:215], v[44:47]
    s_nop 2
    s_waitcnt lgkmcnt(2)
    v_mfma_f32_16x16x32_bf16 v[36:39], v[24:27], v[216:219], v[36:39]
    v_add_u32 v5, 0x6000, v5
    ds_read_b128 v[20:23], v5 offset:40960
    s_waitcnt vmcnt(9)
    v_mfma_f32_16x16x32_bf16 v[44:47], v[24:27], v[220:223], v[44:47]
    s_barrier
    s_waitcnt lgkmcnt(2)
    v_mfma_f32_16x16x32_bf16 v[36:39], v[28:31], v[224:227], v[36:39]
    ds_read_b128 v[24:27], v5 offset:41984
    s_nop 1
    v_mfma_f32_16x16x32_bf16 v[44:47], v[28:31], v[228:231], v[44:47]
    s_nop 2
    s_waitcnt lgkmcnt(2)
    v_mfma_f32_16x16x32_bf16 v[36:39], v[16:19], v[232:235], v[36:39]
    ds_read_b128 v[28:31], v5 offset:43008
    s_nop 1
    v_mfma_f32_16x16x32_bf16 v[44:47], v[16:19], v[236:239], v[44:47]
    s_nop 2
    s_waitcnt lgkmcnt(2)
    v_mfma_f32_16x16x32_bf16 v[36:39], v[20:23], v[240:243], v[36:39]
    ds_read_b128 v[16:19], v5 offset:44032
    s_nop 1
    v_mfma_f32_16x16x32_bf16 v[44:47], v[20:23], v[244:247], v[44:47]
    s_nop 2
    s_waitcnt lgkmcnt(2)
    v_mfma_f32_16x16x32_bf16 v[36:39], v[24:27], v[48:51], v[36:39]
    ds_read_b128 v[20:23], v5 offset:0
    s_nop 1
    v_mfma_f32_16x16x32_bf16 v[44:47], v[24:27], v[52:55], v[44:47]
    s_nop 2
    s_waitcnt lgkmcnt(2)
    v_mfma_f32_16x16x32_bf16 v[36:39], v[28:31], v[56:59], v[36:39]
    v_add_u32 v5, 0xffff4000, v5
    ds_read_b128 v[24:27], v5 offset:0
    v_mfma_f32_16x16x32_bf16 v[44:47], v[28:31], v[60:63], v[44:47]
    s_nop 2
    s_waitcnt lgkmcnt(2)
    v_mfma_f32_16x16x32_bf16 v[36:39], v[16:19], v[96:99], v[36:39]
    ds_read_b128 v[28:31], v5 offset:1024
    s_nop 1
    v_mfma_f32_16x16x32_bf16 v[44:47], v[16:19], v[100:103], v[44:47]
    s_nop 2
    s_waitcnt lgkmcnt(2)
    v_mfma_f32_16x16x32_bf16 v[36:39], v[20:23], v[104:107], v[36:39]
    ds_read_b128 v[16:19], v5 offset:2048
    s_nop 0
    s_waitcnt lgkmcnt(2)
    v_mfma_f32_16x16x32_bf16 v[68:71], v[24:27], v[112:115], 0
    ds_read_b128 v[20:23], v5 offset:3072
    s_nop 1
    v_mfma_f32_16x16x32_bf16 v[76:79], v[24:27], v[116:119], 0
    s_nop 2
    s_waitcnt lgkmcnt(2)
    v_mfma_f32_16x16x32_bf16 v[68:71], v[28:31], v[120:123], v[68:71]
    ds_read_b128 v[24:27], v5 offset:16384
    s_nop 1
    v_mfma_f32_16x16x32_bf16 v[76:79], v[28:31], v[124:127], v[76:79]
    s_nop 2
    s_waitcnt lgkmcnt(2)
    v_mfma_f32_16x16x32_bf16 v[68:71], v[16:19], v[128:131], v[68:71]
    v_xor_b32 v32, 0x1000, v12
    ds_read_b128 v[28:31], v5 offset:17408
    ds_write_b128 v32, v[44:47] offset:16384
    v_mfma_f32_16x16x32_bf16 v[76:79], v[16:19], v[132:135], v[76:79]
    s_nop 3
    s_waitcnt lgkmcnt(3)
    v_mfma_f32_16x16x32_bf16 v[68:71], v[20:23], v[136:139], v[68:71]
    ds_read_b128 v[16:19], v5 offset:18432
    s_nop 2
    v_mfma_f32_16x16x32_bf16 v[76:79], v[20:23], v[140:143], v[76:79]
    s_nop 3
    s_waitcnt lgkmcnt(3)
    v_mfma_f32_16x16x32_bf16 v[68:71], v[24:27], v[144:147], v[68:71]
    ds_read_b128 v[20:23], v5 offset:19456
    s_nop 2
    v_mfma_f32_16x16x32_bf16 v[76:79], v[24:27], v[148:151], v[76:79]
    s_nop 3
    s_waitcnt lgkmcnt(3)
    v_mfma_f32_16x16x32_bf16 v[68:71], v[28:31], v[152:155], v[68:71]
    v_add_u32 v5, 0xffff6000, v5
    ds_read_b128 v[24:27], v5 offset:0
    s_waitcnt vmcnt(7) lgkmcnt(3)
    v_mfma_f32_16x16x32_bf16 v[76:79], v[28:31], v[156:159], v[76:79]
    s_barrier
    s_waitcnt lgkmcnt(2)
    v_mfma_f32_16x16x32_bf16 v[68:71], v[16:19], v[160:163], v[68:71]
    ds_read_b128 v[28:31], v5 offset:1024
    ds_read_b128 v[44:47], v12 offset:16384
    s_nop 0
    v_mfma_f32_16x16x32_bf16 v[76:79], v[16:19], v[164:167], v[76:79]
    s_waitcnt vmcnt(4)
    v_mul_f32 v15, v15, v15
    s_nop 1
    s_waitcnt lgkmcnt(3)
    v_mfma_f32_16x16x32_bf16 v[68:71], v[20:23], v[168:171], v[68:71]
    ds_read_b128 v[16:19], v5 offset:2048
    s_nop 2
    v_mfma_f32_16x16x32_bf16 v[76:79], v[20:23], v[172:175], v[76:79]
    s_nop 3
    s_waitcnt lgkmcnt(3)
    v_mfma_f32_16x16x32_bf16 v[68:71], v[24:27], v[176:179], v[68:71]
    s_waitcnt lgkmcnt(1)
    v_add_f32 v36, v36, v44
    v_add_f32 v37, v37, v45
    ds_read_b128 v[20:23], v5 offset:3072
    v_mfma_f32_16x16x32_bf16 v[76:79], v[24:27], v[180:183], v[76:79]
    v_add_f32 v38, v38, v46
    v_add_f32 v39, v39, v47
    s_nop 0
    v_mfma_f32_16x16x32_bf16 v[68:71], v[28:31], v[184:187], v[68:71]
    ds_read_b128 v[24:27], v5 offset:16384
    buffer_load_dwordx4 v[112:115], v4, s[8:11], s49 offen offset:0 sc1
    v_mfma_f32_16x16x32_bf16 v[76:79], v[28:31], v[188:191], v[76:79]
    buffer_load_dwordx4 v[116:119], v4, s[8:11], s49 offen offset:1024 sc1
    s_waitcnt lgkmcnt(2)
    v_mfma_f32_16x16x32_bf16 v[68:71], v[16:19], v[192:195], v[68:71]
    ds_read_b128 v[28:31], v5 offset:17408
    buffer_load_dwordx4 v[120:123], v4, s[8:11], s49 offen offset:2048 sc1
    v_mfma_f32_16x16x32_bf16 v[76:79], v[16:19], v[196:199], v[76:79]
    buffer_load_dwordx2 v[124:125], v2, s[8:11], s50 offen offset:0 sc1
    s_waitcnt lgkmcnt(2)
    v_mfma_f32_16x16x32_bf16 v[68:71], v[20:23], v[200:203], v[68:71]
    ds_read_b128 v[16:19], v5 offset:18432
    buffer_load_dwordx2 v[126:127], v2, s[8:11], s50 offen offset:512 sc1
    v_mfma_f32_16x16x32_bf16 v[76:79], v[20:23], v[204:207], v[76:79]
    s_waitcnt lgkmcnt(2)
    buffer_load_dwordx2 v[128:129], v2, s[8:11], s50 offen offset:1024 sc1
    v_mfma_f32_16x16x32_bf16 v[68:71], v[24:27], v[208:211], v[68:71]
    s_lshl_b32 s53, s32, 2
    s_add_u32 s53, s53, 32768
    ds_read_b128 v[20:23], v5 offset:19456
    s_nop 0
    v_mfma_f32_16x16x32_bf16 v[76:79], v[24:27], v[212:215], v[76:79]
    v_bfe_u32 v40, v4, 4, 4
    v_mul_u32_u24 v40, 208, v40
    s_nop 0
    s_waitcnt lgkmcnt(2)
    v_mfma_f32_16x16x32_bf16 v[68:71], v[28:31], v[216:219], v[68:71]
    v_add_u32 v5, 0x12000, v5
    v_bfe_u32 v43, v4, 8, 2
    ds_read_b128 v[24:27], v5 offset:0
    v_mfma_f32_16x16x32_bf16 v[76:79], v[28:31], v[220:223], v[76:79]
    v_lshl_add_u32 v40, v43, 4, v40
    v_add_u32 v40, s53, v40
    s_nop 0
    s_waitcnt lgkmcnt(2)
    v_mfma_f32_16x16x32_bf16 v[68:71], v[16:19], v[224:227], v[68:71]
    v_lshrrev_b32 v42, 6, v4
    v_mul_u32_u24 v42, 208, v42
    ds_read_b128 v[28:31], v5 offset:1024
    v_mfma_f32_16x16x32_bf16 v[76:79], v[16:19], v[228:231], v[76:79]
    v_add_u32 v42, s53, v42
    v_bfe_u32 v43, v4, 4, 2
    s_nop 0
    s_waitcnt lgkmcnt(2)
    v_mfma_f32_16x16x32_bf16 v[68:71], v[20:23], v[232:235], v[68:71]
    v_lshl_add_u32 v41, v43, 5, v42
    v_lshl_add_u32 v42, v43, 4, v42
    ds_read_b128 v[16:19], v5 offset:2048
    v_mfma_f32_16x16x32_bf16 v[76:79], v[20:23], v[236:239], v[76:79]
    s_nop 3
    s_waitcnt lgkmcnt(2)
    v_mfma_f32_16x16x32_bf16 v[68:71], v[24:27], v[240:243], v[68:71]
    ds_read_b128 v[20:23], v5 offset:3072
    s_nop 2
    v_mfma_f32_16x16x32_bf16 v[76:79], v[24:27], v[244:247], v[76:79]
    s_nop 3
    s_waitcnt lgkmcnt(2)
    v_mfma_f32_16x16x32_bf16 v[68:71], v[28:31], v[48:51], v[68:71]
    ds_read_b128 v[24:27], v5 offset:17408
    s_nop 2
    v_mfma_f32_16x16x32_bf16 v[76:79], v[28:31], v[52:55], v[76:79]
    s_nop 3
    s_waitcnt lgkmcnt(2)
    v_mfma_f32_16x16x32_bf16 v[68:71], v[16:19], v[56:59], v[68:71]
    s_nop 3
    v_mfma_f32_16x16x32_bf16 v[76:79], v[16:19], v[60:63], v[76:79]
    s_nop 2
    s_waitcnt lgkmcnt(1)
    v_mfma_f32_16x16x32_bf16 v[68:71], v[20:23], v[96:99], v[68:71]
    s_nop 3
    v_mfma_f32_16x16x32_bf16 v[76:79], v[20:23], v[100:103], v[76:79]
    s_nop 2
    s_waitcnt lgkmcnt(0)
    v_mfma_f32_16x16x32_bf16 v[68:71], v[24:27], v[104:107], v[68:71]
    s_nop 3
    v_xor_b32 v141, 0x1000, v12
    s_mov_b32 s24, 0xffff0000
    ds_write_b128 v141, v[76:79] offset:0
    s_waitcnt lgkmcnt(0)
    s_barrier
    ds_read_b128 v[76:79], v12 offset:0
    s_waitcnt vmcnt(5)
    v_max3_u32 v142, v112, v113, v114
    s_waitcnt vmcnt(4)
    v_max3_u32 v143, v115, v116, v117
    v_max3_u32 v142, v142, v118, v119
    s_waitcnt vmcnt(3)
    v_max3_u32 v143, v143, v120, v121
    v_max3_u32 v142, v142, v122, v123
    s_waitcnt vmcnt(2)
    v_max3_u32 v143, v143, v124, v125
    s_waitcnt vmcnt(1)
    v_max3_u32 v142, v142, v126, v127
    s_waitcnt vmcnt(0)
    v_max3_u32 v143, v143, v128, v129
    v_max_u32 v142, v142, v143
    v_cmp_eq_u32 vcc, -1, v142
    s_nop 4
    s_cbranch_vccnz L_sl14
L_bk14:
    v_lshlrev_b32 v136, 16, v112
    v_and_b32 v137, s24, v112
    v_lshlrev_b32 v138, 16, v113
    v_and_b32 v139, s24, v113
    v_add_f32 v36, v36, v136
    v_add_f32 v37, v37, v137
    v_add_f32 v38, v38, v138
    v_add_f32 v39, v39, v139
    v_lshlrev_b32 v136, 16, v116
    v_and_b32 v137, s24, v116
    v_lshlrev_b32 v138, 16, v117
    v_and_b32 v139, s24, v117
    v_add_f32 v36, v36, v136
    v_add_f32 v37, v37, v137
    v_add_f32 v38, v38, v138
    v_add_f32 v39, v39, v139
    v_lshlrev_b32 v136, 16, v120
    v_and_b32 v137, s24, v120
    v_lshlrev_b32 v138, 16, v121
    v_and_b32 v139, s24, v121
    v_add_f32 v36, v36, v136
    v_add_f32 v37, v37, v137
    v_add_f32 v38, v38, v138
    v_add_f32 v39, v39, v139
    ds_write_b128 v40, v[36:39] offset:0
    v_lshlrev_b32 v136, 16, v124
    v_and_b32 v137, s24, v124
    v_lshlrev_b32 v138, 16, v125
    v_and_b32 v139, s24, v125
    v_add_f32 v248, v248, v136
    v_add_f32 v249, v249, v137
    v_add_f32 v250, v250, v138
    v_add_f32 v251, v251, v139
    v_lshlrev_b32 v136, 16, v126
    v_and_b32 v137, s24, v126
    v_lshlrev_b32 v138, 16, v127
    v_and_b32 v139, s24, v127
    v_add_f32 v248, v248, v136
    v_add_f32 v249, v249, v137
    v_add_f32 v250, v250, v138
    v_add_f32 v251, v251, v139
    v_lshlrev_b32 v136, 16, v128
    v_and_b32 v137, s24, v128
    v_lshlrev_b32 v138, 16, v129
    v_and_b32 v139, s24, v129
    v_add_f32 v248, v248, v136
    v_add_f32 v249, v249, v137
    v_add_f32 v250, v250, v138
    v_add_f32 v251, v251, v139
    ds_write_b128 v40, v[248:251] offset:128
    s_waitcnt lgkmcnt(2)
    v_add_f32 v68, v68, v76
    v_add_f32 v69, v69, v77
    v_add_f32 v70, v70, v78
    v_add_f32 v71, v71, v79
    v_lshlrev_b32 v136, 16, v114
    v_and_b32 v137, s24, v114
    v_lshlrev_b32 v138, 16, v115
    v_and_b32 v139, s24, v115
    v_add_f32 v68, v68, v136
    v_add_f32 v69, v69, v137
    v_add_f32 v70, v70, v138
    v_add_f32 v71, v71, v139
    v_lshlrev_b32 v136, 16, v118
    v_and_b32 v137, s24, v118
    v_lshlrev_b32 v138, 16, v119
    v_and_b32 v139, s24, v119
    v_add_f32 v68, v68, v136
    v_add_f32 v69, v69, v137
    v_add_f32 v70, v70, v138
    v_add_f32 v71, v71, v139
    v_lshlrev_b32 v136, 16, v122
    v_and_b32 v137, s24, v122
    v_lshlrev_b32 v138, 16, v123
    v_and_b32 v139, s24, v123
    v_add_f32 v68, v68, v136
    v_add_f32 v69, v69, v137
    v_add_f32 v70, v70, v138
    v_add_f32 v71, v71, v139
    ds_write_b128 v40, v[68:71] offset:64
    ds_read_b128 v[160:163], v42 offset:128
    ds_read_b128 v[152:155], v41
    ds_read_b128 v[156:159], v41 offset:16
    v_lshlrev_b32 v136, 16, v0
    v_and_b32 v137, s24, v0
    v_lshlrev_b32 v138, 16, v1
    v_and_b32 v139, s24, v1
    s_waitcnt lgkmcnt(2)
    v_fma_f32 v160, v160, v15, v136
    v_fma_f32 v161, v161, v15, v137
    v_fma_f32 v162, v162, v15, v138
    v_fma_f32 v163, v163, v15, v139
    v_cvt_pk_bf16_f32 v160, v160, v161
    v_cvt_pk_bf16_f32 v161, v162, v163
    buffer_store_dwordx2 v[160:161], v109, s[20:23], s60 offen sc1
    v_lshlrev_b32 v136, 16, v8
    v_and_b32 v137, s24, v8
    v_lshlrev_b32 v138, 16, v9
    v_and_b32 v139, s24, v9
    s_waitcnt lgkmcnt(1)
    v_fma_f32 v152, v152, v15, v136
    v_fma_f32 v153, v153, v15, v137
    v_fma_f32 v154, v154, v15, v138
    v_fma_f32 v155, v155, v15, v139
    v_cvt_pk_bf16_f32 v152, v152, v153
    v_cvt_pk_bf16_f32 v153, v154, v155
    v_lshlrev_b32 v136, 16, v10
    v_and_b32 v137, s24, v10
    v_lshlrev_b32 v138, 16, v11
    v_and_b32 v139, s24, v11
    s_waitcnt lgkmcnt(0)
    v_fma_f32 v156, v156, v15, v136
    v_fma_f32 v157, v157, v15, v137
    v_fma_f32 v158, v158, v15, v138
    v_fma_f32 v159, v159, v15, v139
    v_cvt_pk_bf16_f32 v154, v156, v157
    v_cvt_pk_bf16_f32 v155, v158, v159
    buffer_store_dwordx4 v[152:155], v108, s[20:23], s59 offen sc1
L_done:
    s_endpgm
L_sl1:
    s_nop 7
    s_mov_b32 s1, 100000
L_rt1:
    s_sleep 1
    buffer_load_dword v10, v9, s[8:11], s56 offen sc1
    s_waitcnt vmcnt(0)
    v_cmp_ne_u32 vcc, s54, v10
    s_sub_u32 s1, s1, 1
    s_cmp_eq_u32 s1, 0
    s_cbranch_scc1 L_bk1
    s_nop 4
    s_cbranch_vccnz L_rt1
    s_branch L_bk1
L_sl2:
    s_nop 7
    s_mov_b32 s1, 100000
L_rt2:
    s_sleep 1
    buffer_load_dword v111, v110, s[8:11], s80 offen sc1
    s_waitcnt vmcnt(0)
    v_cmp_ne_u32 vcc, s54, v111
    s_sub_u32 s1, s1, 1
    s_cmp_eq_u32 s1, 0
    s_cbranch_scc1 L_bk2
    s_nop 4
    s_cbranch_vccnz L_rt2
    s_branch L_bk2
L_sl3:
    s_nop 7
    s_mov_b32 s1, 100000
L_rt3:
    s_sleep 1
    buffer_load_dword v109, v108, s[8:11], s58 offen sc1
    s_waitcnt vmcnt(0)
    v_cmp_ne_u32 vcc, s54, v109
    s_sub_u32 s1, s1, 1
    s_cmp_eq_u32 s1, 0
    s_cbranch_scc1 L_bk3
    s_nop 4
    s_cbranch_vccnz L_rt3
    s_branch L_bk3
L_sl4:
    s_nop 7
    s_mov_b32 s1, 100000
L_rt4:
    s_sleep 1
    buffer_load_dword v6, v3, s[8:11], s58 offen sc1
    s_waitcnt vmcnt(0)
    v_cmp_ne_u32 vcc, s54, v6
    s_sub_u32 s1, s1, 1
    s_cmp_eq_u32 s1, 0
    s_cbranch_scc1 L_bk4
    s_nop 4
    s_cbranch_vccnz L_rt4
    s_branch L_bk4
L_sl5:
    s_nop 7
    s_mov_b32 s1, 100000
L_rt5:
    s_sleep 1
    buffer_load_dword v6, v3, s[8:11], s58 offen sc1
    s_waitcnt vmcnt(0)
    v_cmp_ne_u32 vcc, s54, v6
    s_sub_u32 s1, s1, 1
    s_cmp_eq_u32 s1, 0
    s_cbranch_scc1 L_bk5
    s_nop 4
    s_cbranch_vccnz L_rt5
    s_branch L_bk5
L_sl6:
    s_nop 7
    s_mov_b32 s1, 100000
L_rt6:
    s_sleep 1
    buffer_load_dword v245, off, s[20:23], 0 sc1
    s_waitcnt vmcnt(0)
    v_cmp_eq_u32 vcc, 0, v245
    s_sub_u32 s1, s1, 1
    s_cmp_eq_u32 s1, 0
    s_cbranch_scc1 L_bk6
    s_nop 4
    s_cbranch_vccnz L_rt6
    s_branch L_bk6
L_sl7:
    s_nop 7
    s_mov_b32 s1, 100000
L_rt7:
    s_sleep 1
    buffer_load_dwordx4 v[104:107], v8, s[8:11], s58 offen sc1
    s_waitcnt vmcnt(0)
    v_xor_b32 v105, s54, v105
    v_xor_b32 v107, s54, v107
    v_or_b32 v105, v105, v107
    v_cmp_ne_u32 vcc, 0, v105
    s_sub_u32 s1, s1, 1
    s_cmp_eq_u32 s1, 0
    s_cbranch_scc1 L_bk7
    s_nop 4
    s_cbranch_vccnz L_rt7
    s_branch L_bk7
L_sl8:
    s_nop 7
    s_mov_b32 s1, 100000
L_rt8:
    s_sleep 1
    s_add_u32 s31, s47, 0
    buffer_load_dword v112, v120, s[8:11], s31 offen offset:0 sc1
    buffer_load_dword v113, v120, s[8:11], s31 offen offset:1536 sc1
    buffer_load_dword v114, v120, s[8:11], s31 offen offset:3072 sc1
    s_add_u32 s30, s47, 4608
    buffer_load_dword v115, v120, s[8:11], s30 offen offset:0 sc1
    buffer_load_dword v116, v120, s[8:11], s30 offen offset:1536 sc1
    buffer_load_dword v117, v120, s[8:11], s30 offen offset:3072 sc1
    s_add_u32 s31, s47, 9216
    buffer_load_dword v118, v120, s[8:11], s31 offen offset:0 sc1
    buffer_load_dword v119, v120, s[8:11], s31 offen offset:1536 sc1
    s_waitcnt vmcnt(0)
    v_max3_u32 v121, v112, v113, v114
    v_max3_u32 v122, v115, v116, v117
    v_max3_u32 v121, v121, v118, v119
    v_max_u32 v121, v121, v122
    v_cmp_eq_u32 vcc, -1, v121
    s_sub_u32 s1, s1, 1
    s_cmp_eq_u32 s1, 0
    s_cbranch_scc1 L_bk8
    s_nop 4
    s_cbranch_vccnz L_rt8
    s_branch L_bk8
L_sl9:
    s_nop 7
    s_mov_b32 s1, 100000
L_rt9:
    s_sleep 1
    buffer_load_dword v6, v3, s[8:11], s58 offen sc1
    s_waitcnt vmcnt(0)
    v_cmp_ne_u32 vcc, s54, v6
    s_sub_u32 s1, s1, 1
    s_cmp_eq_u32 s1, 0
    s_cbranch_scc1 L_bk9
    s_nop 4
    s_cbranch_vccnz L_rt9
    s_branch L_bk9
L_sl10:
    s_nop 7
    s_mov_b32 s1, 100000
L_rt10:
    s_sleep 1
    s_add_u32 s58, s62, 0
    buffer_load_dwordx4 v[240:243], v4, s[8:11], s58 offen offset:3072 sc1
    s_add_u32 s58, s63, 0
    buffer_load_dwordx4 v[244:247], v4, s[8:11], s58 offen offset:3072 sc1
    s_waitcnt vmcnt(0)
    v_max3_u32 v3, v240, v241, v242
    v_max3_u32 v6, v243, v244, v245
    v_max3_u32 v3, v3, v246, v247
    v_max_u32 v3, v3, v6
    v_cmp_eq_u32 vcc, -1, v3
    s_sub_u32 s1, s1, 1
    s_cmp_eq_u32 s1, 0
    s_cbranch_scc1 L_bk10
    s_nop 4
    s_cbranch_vccnz L_rt10
    s_branch L_bk10
L_sl11:
    s_nop 7
    s_mov_b32 s1, 100000
L_rt11:
    s_sleep 1
    s_add_u32 s58, s62, 8192
    buffer_load_dwordx4 v[48:51], v4, s[8:11], s58 offen offset:0 sc1
    s_add_u32 s58, s63, 8192
    buffer_load_dwordx4 v[52:55], v4, s[8:11], s58 offen offset:0 sc1
    s_waitcnt vmcnt(0)
    v_max3_u32 v3, v48, v49, v50
    v_max3_u32 v6, v51, v52, v53
    v_max3_u32 v3, v3, v54, v55
    v_max_u32 v3, v3, v6
    v_cmp_eq_u32 vcc, -1, v3
    s_sub_u32 s1, s1, 1
    s_cmp_eq_u32 s1, 0
    s_cbranch_scc1 L_bk11
    s_nop 4
    s_cbranch_vccnz L_rt11
    s_branch L_bk11
L_sl12:
    s_nop 7
    s_mov_b32 s1, 100000
L_rt12:
    s_sleep 1
    s_add_u32 s58, s62, 12288
    buffer_load_dwordx4 v[56:59], v4, s[8:11], s58 offen offset:1024 sc1
    s_add_u32 s58, s63, 12288
    buffer_load_dwordx4 v[60:63], v4, s[8:11], s58 offen offset:1024 sc1
    s_waitcnt vmcnt(0)
    v_max3_u32 v3, v56, v57, v58
    v_max3_u32 v6, v59, v60, v61
    v_max3_u32 v3, v3, v62, v63
    v_max_u32 v3, v3, v6
    v_cmp_eq_u32 vcc, -1, v3
    s_sub_u32 s1, s1, 1
    s_cmp_eq_u32 s1, 0
    s_cbranch_scc1 L_bk12
    s_nop 4
    s_cbranch_vccnz L_rt12
    s_branch L_bk12
L_sl13:
    s_nop 7
    s_mov_b32 s1, 100000
L_rt13:
    s_sleep 1
    s_add_u32 s58, s62, 16384
    buffer_load_dwordx4 v[96:99], v4, s[8:11], s58 offen offset:2048 sc1
    s_add_u32 s58, s63, 16384
    buffer_load_dwordx4 v[100:103], v4, s[8:11], s58 offen offset:2048 sc1
    s_waitcnt vmcnt(0)
    v_max3_u32 v3, v96, v97, v98
    v_max3_u32 v6, v99, v100, v101
    v_max3_u32 v3, v3, v102, v103
    v_max_u32 v3, v3, v6
    v_cmp_eq_u32 vcc, -1, v3
    s_sub_u32 s1, s1, 1
    s_cmp_eq_u32 s1, 0
    s_cbranch_scc1 L_bk13
    s_nop 4
    s_cbranch_vccnz L_rt13
    s_branch L_bk13
L_sl14:
    s_nop 7
    s_mov_b32 s1, 100000
L_rt14:
    s_sleep 1
    buffer_load_dwordx4 v[112:115], v4, s[8:11], s49 offen offset:0 sc1
    buffer_load_dwordx4 v[116:119], v4, s[8:11], s49 offen offset:1024 sc1
    buffer_load_dwordx4 v[120:123], v4, s[8:11], s49 offen offset:2048 sc1
    buffer_load_dwordx2 v[124:125], v2, s[8:11], s50 offen offset:0 sc1
    buffer_load_dwordx2 v[126:127], v2, s[8:11], s50 offen offset:512 sc1
    buffer_load_dwordx2 v[128:129], v2, s[8:11], s50 offen offset:1024 sc1
    s_waitcnt vmcnt(0)
    v_max3_u32 v142, v112, v113, v114
    v_max3_u32 v143, v115, v116, v117
    v_max3_u32 v142, v142, v118, v119
    v_max3_u32 v143, v143, v120, v121
    v_max3_u32 v142, v142, v122, v123
    v_max3_u32 v143, v143, v124, v125
    v_max3_u32 v142, v142, v126, v127
    v_max3_u32 v143, v143, v128, v129
    v_max_u32 v142, v142, v143
    v_cmp_eq_u32 vcc, -1, v142
    s_sub_u32 s1, s1, 1
    s_cmp_eq_u32 s1, 0
    s_cbranch_scc1 L_bk14
    s_nop 4
    s_cbranch_vccnz L_rt14
    s_branch L_bk14
.section .rodata,"a"
.p2align 6
.amdhsa_kernel parallel_sum__linear_attn_block__geglu_ffn__prompt_kernel
  .amdhsa_next_free_vgpr 256
  .amdhsa_next_free_sgpr 102
  .amdhsa_accum_offset 256
  .amdhsa_group_segment_fixed_size 0
  .amdhsa_kernarg_size 80
  .amdhsa_user_sgpr_count 2
  .amdhsa_user_sgpr_kernarg_segment_ptr 1
  .amdhsa_system_sgpr_workgroup_id_x 1
  .amdhsa_float_denorm_mode_32 3
.end_amdhsa_kernel
```
